```python
import torch

def _softmax(x, axis=-1):
    return torch.softmax(x, dim=axis)
def _gelu(x):
    return torch.nn.functional.gelu(x, approximate="tanh")
def _silu(x):
    return torch.nn.functional.silu(x)
def _sigmoid(x):
    return torch.sigmoid(x)
def _layernorm(x, axis=-1, eps=1e-5):
    m = x.mean(dim=axis, keepdim=True)
    v = x.var(dim=axis, keepdim=True, unbiased=False)
    return (x - m) / torch.sqrt(v + eps)
def _scatter_add(tgt, idx, src, axis=0):
    return tgt.clone().index_add_(axis, idx, src)
def _segment_sum(src, seg, n):
    out = torch.zeros((n,) + src.shape[1:], dtype=src.dtype)
    return out.index_add_(0, seg, src)
def _pad(x, pw):
    flat = tuple(v for pair in reversed(pw) for v in pair)
    return torch.nn.functional.pad(x, flat)

kernel_name = 'sequential_preLN__sliding_block__dense_activation_relu__prompt'

def setup_inputs():

    _w = (lambda a: (lambda t: t.to(torch.bfloat16) if t.is_floating_point() else t)(torch.as_tensor(a)))
    def _A_setup():
        B, S, D = 1, 2048, 640
        return {
            "x": _w((lambda *s: torch.randn(*s, dtype=torch.bfloat16) * 0.05)(B, S, D)),
            "wqkv": _w((lambda *s: torch.randn(*s, dtype=torch.bfloat16) * 0.05)(D, 3 * D)),
            "wo": _w((lambda *s: torch.randn(*s, dtype=torch.bfloat16) * 0.05)(D, D)),
        }
    _A_in = _A_setup()

    def _B_setup():
        B, S, D, Dff = 1, 2048, 640, 1728
        return {
            "x": _w((lambda *s: torch.randn(*s, dtype=torch.bfloat16) * 0.05)(B, S, D)),
            "w1": _w((lambda *s: torch.randn(*s, dtype=torch.bfloat16) * 0.05)(D, Dff)),
            "w2": _w((lambda *s: torch.randn(*s, dtype=torch.bfloat16) * 0.05)(Dff, D)),
        }
    _B_in = _B_setup()

    return {
        "A_x": _A_in["x"],
        "A_wqkv": _A_in["wqkv"],
        "A_wo": _A_in["wo"],
        "B_x": _B_in["x"],
        "B_w1": _B_in["w1"],
        "B_w2": _B_in["w2"],
    }

def reference(A_x, A_wqkv, A_wo, B_x, B_w1, B_w2):
    def _A_ref(x, wqkv, wo):
        B, S, D = x.shape
        H = 32; Dh = D // H; W = 256
        qkv = (lambda x, *d: x.permute(*d))((x @ wqkv).reshape(B, S, 3, H, Dh), 2, 0, 3, 1, 4)
        q, k, v = qkv[0], qkv[1], qkv[2]
        scores = torch.einsum("bhqd,bhkd->bhqk", q, k) * (Dh ** -0.5)
        idx = torch.arange(S)
        mask = (idx[:, None] - idx[None, :] >= 0) & (idx[:, None] - idx[None, :] < W)
        scores = torch.where(mask[None, None], scores, -1e9)
        p = _softmax(scores, axis=-1)
        o = torch.einsum("bhqk,bhkd->bhqd", p, v)
        return (lambda x, *d: x.permute(*d))(o, 0, 2, 1, 3).reshape(B, S, D) @ wo

    def _B_ref(x, w1, w2):
        h = torch.einsum("bsd,df->bsf", x, w1)
        zero = torch.zeros_like(h)
        h = torch.maximum(h, zero)
        return torch.einsum("bsf,fd->bsd", h, w2)

    x = A_x
    h = x + _A_ref(_layernorm(x, axis=-1), A_wqkv, A_wo)
    h2 = h + _B_ref(_layernorm(h, axis=-1), B_w1, B_w2)
    return h2
```

```asm
; @launch grid=(256,1,1) block=(512,1,1) lds=163840
.amdgcn_target "amdgcn-amd-amdhsa--gfx950"
.text
.globl sequential_preLN__sliding_block__dense_activation_relu__prompt_kernel
.p2align 8
.type sequential_preLN__sliding_block__dense_activation_relu__prompt_kernel,@function
sequential_preLN__sliding_block__dense_activation_relu__prompt_kernel:
    s_cmp_ge_u32 s2, 256
    s_cbranch_scc1 mega_end
    s_load_dwordx4 s[64:67], s[0:1], 0
    s_load_dwordx2 s[68:69], s[0:1], 16
    s_load_dwordx2 s[70:71], s[0:1], 32
    s_load_dwordx2 s[72:73], s[0:1], 40
    s_load_dwordx2 s[74:75], s[0:1], 48
    s_load_dwordx2 s[76:77], s[0:1], 56
    s_load_dwordx2 s[78:79], s[0:1], 64
    s_memrealtime s[82:83]
    v_lshrrev_b32 v1, 6, v0
    v_and_b32 v0, 63, v0
    v_readfirstlane_b32 s80, v1
    s_waitcnt lgkmcnt(0)
    s_add_u32 s84, s78, 0x2000000
    s_addc_u32 s85, s79, 0
    s_and_b32 s85, s85, 0xffff
    s_mov_b32 s86, 0x4000
    s_mov_b32 s87, 0x20000
    s_mov_b32 s4, s76
    s_and_b32 s5, s77, 0xffff
    s_mov_b32 s6, 0x100
    s_mov_b32 s7, 0x20000
    s_or_b32 s82, s82, 1
    s_cmp_lg_u32 s80, 0
    s_cbranch_scc1 mega_nn
    v_mov_b32 v248, s82
    v_mov_b32 v249, 0
    v_mov_b32 v250, 0
    s_mov_b64 exec, 1
    buffer_atomic_cmpswap v[248:249], v250, s[4:7], 0 offen sc0 sc1
    s_mov_b64 exec, -1
mega_nn:
qkv_kernel:
    s_and_b32 s31, s2, 7
    s_lshr_b32 s32, s2, 3
    s_and_b32 s54, s32, 3
    s_lshr_b32 s55, s32, 2
    s_lshr_b32 s28, s31, 1
    s_mul_i32 s28, s28, 4
    s_add_u32 s28, s28, s54
    s_and_b32 s29, s31, 1
    s_mul_i32 s29, s29, 8
    s_cmp_ge_u32 s55, 8
    s_cbranch_scc1 qkv_kernel_end
    s_add_u32 s29, s29, s55
    s_cmp_ge_u32 s29, 15
    s_cbranch_scc1 qkv_kernel_end
    s_mov_b32 s30, s80
    s_mul_i32 s40, s28, 128
    s_mul_i32 s41, s29, 128
    s_cmp_ge_u32 s30, 4
    s_cbranch_scc1 qkv_kernel_loader
    v_lshrrev_b32 v1, 4, v0
    v_and_b32 v2, 15, v0
    s_mov_b32 s38, s30
    s_mov_b32 s39, 0
    s_mul_i32 s31, s38, 4096
    v_lshrrev_b32 v3, 1, v2
    v_lshlrev_b32 v4, 7, v2
    v_add_u32 v4, s31, v4
    v_add_u32 v5, 0, v1
    v_xor_b32 v5, v5, v3
    v_lshl_add_u32 v7, v5, 4, v4
    v_add_u32 v5, 4, v1
    v_xor_b32 v5, v5, v3
    v_lshl_add_u32 v8, v5, 4, v4
    v_lshrrev_b32 v3, 2, v2
    v_and_b32 v4, 1, v1
    v_lshl_add_u32 v3, v4, 2, v3
    v_lshrrev_b32 v4, 1, v1
    v_lshl_add_u32 v4, v4, 4, v3
    v_mul_u32_u24 v4, 256, v4
    v_and_b32 v5, 1, v2
    v_lshl_add_u32 v4, v5, 3, v4
    v_bfe_u32 v5, v2, 1, 1
    v_lshl_add_u32 v4, v5, 4, v4
    v_add_u32 v4, 16384, v4
    v_lshlrev_b32 v3, 1, v3
    s_lshl_b32 s31, s30, 1
    s_add_u32 s31, s31, 0
    s_and_b32 s46, s31, 7
    s_lshl_b32 s31, s46, 1
    v_xor_b32 v5, s31, v3
    v_lshl_add_u32 v11, v5, 4, v4
    s_lshl_b32 s31, s30, 1
    s_add_u32 s31, s31, 1
    s_and_b32 s47, s31, 7
    s_lshl_b32 s31, s47, 1
    v_xor_b32 v5, s31, v3
    v_lshl_add_u32 v12, v5, 4, v4
    s_lshl_b32 s31, s30, 1
    s_add_u32 s31, s31, 2
    s_and_b32 s48, s31, 7
    s_lshl_b32 s31, s48, 1
    v_xor_b32 v5, s31, v3
    v_lshl_add_u32 v13, v5, 4, v4
    s_lshl_b32 s31, s30, 1
    s_add_u32 s31, s31, 3
    s_and_b32 s49, s31, 7
    s_lshl_b32 s31, s49, 1
    v_xor_b32 v5, s31, v3
    v_lshl_add_u32 v14, v5, 4, v4
    s_lshl_b32 s31, s30, 1
    s_add_u32 s31, s31, 4
    s_and_b32 s50, s31, 7
    s_lshl_b32 s31, s50, 1
    v_xor_b32 v5, s31, v3
    v_lshl_add_u32 v15, v5, 4, v4
    s_lshl_b32 s31, s30, 1
    s_add_u32 s31, s31, 5
    s_and_b32 s51, s31, 7
    s_lshl_b32 s31, s51, 1
    v_xor_b32 v5, s31, v3
    v_lshl_add_u32 v16, v5, 4, v4
    s_lshl_b32 s31, s30, 1
    s_add_u32 s31, s31, 6
    s_and_b32 s52, s31, 7
    s_lshl_b32 s31, s52, 1
    v_xor_b32 v5, s31, v3
    v_lshl_add_u32 v17, v5, 4, v4
    s_lshl_b32 s31, s30, 1
    s_add_u32 s31, s31, 7
    s_and_b32 s53, s31, 7
    s_lshl_b32 s31, s53, 1
    v_xor_b32 v5, s31, v3
    v_lshl_add_u32 v18, v5, 4, v4
    s_waitcnt lgkmcnt(0)
    s_mov_b32 s12, s78
    s_and_b32 s13, s79, 0xffff
    s_mov_b32 s14, 0x780000
    s_mov_b32 s15, 0x20000
    v_mov_b32 v172, 0x3f803f80
    v_mov_b32 v173, 0x3f803f80
    v_mov_b32 v174, 0x3f803f80
    v_mov_b32 v175, 0x3f803f80
    s_barrier
    v_add_u32 v9, 0x0, v7
    v_add_u32 v10, 0x0, v8
    v_add_u32 v19, 0x0, v11
    v_add_u32 v20, 0x0, v12
    v_add_u32 v21, 0x0, v13
    v_add_u32 v22, 0x0, v14
    v_add_u32 v23, 0x0, v15
    v_add_u32 v24, 0x0, v16
    v_add_u32 v25, 0x0, v17
    v_add_u32 v26, 0x0, v18
    ds_read_b128 v[92:95], v9 offset:0
    ds_read_b128 v[96:99], v9 offset:2048
    ds_read_b64_tr_b16 v[108:109], v19 offset:0
    ds_read_b64_tr_b16 v[110:111], v19 offset:2048
    ds_read_b64_tr_b16 v[112:113], v20 offset:0
    ds_read_b64_tr_b16 v[114:115], v20 offset:2048
    ds_read_b64_tr_b16 v[116:117], v21 offset:0
    ds_read_b64_tr_b16 v[118:119], v21 offset:2048
    ds_read_b64_tr_b16 v[120:121], v22 offset:0
    ds_read_b64_tr_b16 v[122:123], v22 offset:2048
    ds_read_b64_tr_b16 v[124:125], v23 offset:0
    ds_read_b64_tr_b16 v[126:127], v23 offset:2048
    ds_read_b64_tr_b16 v[128:129], v24 offset:0
    ds_read_b64_tr_b16 v[130:131], v24 offset:2048
    ds_read_b64_tr_b16 v[132:133], v25 offset:0
    ds_read_b64_tr_b16 v[134:135], v25 offset:2048
    ds_read_b64_tr_b16 v[136:137], v26 offset:0
    ds_read_b64_tr_b16 v[138:139], v26 offset:2048
    s_waitcnt lgkmcnt(0)
    v_mfma_f32_16x16x32_bf16 v[28:31], v[108:111], v[92:95], 0
    ds_read_b128 v[100:103], v10 offset:0
    ds_read_b128 v[104:107], v10 offset:2048
    v_mfma_f32_16x16x32_bf16 v[60:63], v[108:111], v[96:99], 0
    ds_read_b64_tr_b16 v[140:141], v19 offset:8192
    v_mfma_f32_16x16x32_bf16 v[176:179], v[108:111], v[172:175], 0
    ds_read_b64_tr_b16 v[142:143], v19 offset:10240
    v_mfma_f32_16x16x32_bf16 v[32:35], v[112:115], v[92:95], 0
    ds_read_b64_tr_b16 v[144:145], v20 offset:8192
    v_mfma_f32_16x16x32_bf16 v[64:67], v[112:115], v[96:99], 0
    ds_read_b64_tr_b16 v[146:147], v20 offset:10240
    v_mfma_f32_16x16x32_bf16 v[180:183], v[112:115], v[172:175], 0
    ds_read_b64_tr_b16 v[148:149], v21 offset:8192
    v_mfma_f32_16x16x32_bf16 v[36:39], v[116:119], v[92:95], 0
    ds_read_b64_tr_b16 v[150:151], v21 offset:10240
    v_mfma_f32_16x16x32_bf16 v[68:71], v[116:119], v[96:99], 0
    ds_read_b64_tr_b16 v[152:153], v22 offset:8192
    v_mfma_f32_16x16x32_bf16 v[184:187], v[172:175], v[92:95], 0
    ds_read_b64_tr_b16 v[154:155], v22 offset:10240
    ds_read_b64_tr_b16 v[156:157], v23 offset:8192
    v_mfma_f32_16x16x32_bf16 v[40:43], v[120:123], v[92:95], 0
    ds_read_b64_tr_b16 v[158:159], v23 offset:10240
    v_mfma_f32_16x16x32_bf16 v[72:75], v[120:123], v[96:99], 0
    ds_read_b64_tr_b16 v[160:161], v24 offset:8192
    v_mfma_f32_16x16x32_bf16 v[188:191], v[172:175], v[96:99], 0
    ds_read_b64_tr_b16 v[162:163], v24 offset:10240
    v_mfma_f32_16x16x32_bf16 v[44:47], v[124:127], v[92:95], 0
    ds_read_b64_tr_b16 v[164:165], v25 offset:8192
    v_mfma_f32_16x16x32_bf16 v[76:79], v[124:127], v[96:99], 0
    ds_read_b64_tr_b16 v[166:167], v25 offset:10240
    v_mfma_f32_16x16x32_bf16 v[192:195], v[92:95], v[92:95], 0
    ds_read_b64_tr_b16 v[168:169], v26 offset:8192
    v_mfma_f32_16x16x32_bf16 v[48:51], v[128:131], v[92:95], 0
    ds_read_b64_tr_b16 v[170:171], v26 offset:10240
    v_mfma_f32_16x16x32_bf16 v[80:83], v[128:131], v[96:99], 0
    v_mfma_f32_16x16x32_bf16 v[196:199], v[96:99], v[96:99], 0
    v_mfma_f32_16x16x32_bf16 v[52:55], v[132:135], v[92:95], 0
    v_mfma_f32_16x16x32_bf16 v[84:87], v[132:135], v[96:99], 0
    v_mfma_f32_16x16x32_bf16 v[56:59], v[136:139], v[92:95], 0
    v_mfma_f32_16x16x32_bf16 v[88:91], v[136:139], v[96:99], 0
    s_waitcnt lgkmcnt(0)
    v_mfma_f32_16x16x32_bf16 v[28:31], v[140:143], v[100:103], v[28:31]
    v_mfma_f32_16x16x32_bf16 v[60:63], v[140:143], v[104:107], v[60:63]
    v_mfma_f32_16x16x32_bf16 v[176:179], v[140:143], v[172:175], v[176:179]
    v_mfma_f32_16x16x32_bf16 v[32:35], v[144:147], v[100:103], v[32:35]
    v_mfma_f32_16x16x32_bf16 v[64:67], v[144:147], v[104:107], v[64:67]
    s_waitcnt lgkmcnt(0)
    s_barrier
    v_mfma_f32_16x16x32_bf16 v[180:183], v[144:147], v[172:175], v[180:183]
    v_add_u32 v9, 0x8000, v7
    v_add_u32 v10, 0x8000, v8
    v_add_u32 v19, 0x8000, v11
    v_mfma_f32_16x16x32_bf16 v[36:39], v[148:151], v[100:103], v[36:39]
    v_add_u32 v20, 0x8000, v12
    v_add_u32 v21, 0x8000, v13
    v_mfma_f32_16x16x32_bf16 v[68:71], v[148:151], v[104:107], v[68:71]
    v_add_u32 v22, 0x8000, v14
    v_add_u32 v23, 0x8000, v15
    v_mfma_f32_16x16x32_bf16 v[184:187], v[172:175], v[100:103], v[184:187]
    v_add_u32 v24, 0x8000, v16
    v_add_u32 v25, 0x8000, v17
    v_add_u32 v26, 0x8000, v18
    v_mfma_f32_16x16x32_bf16 v[40:43], v[152:155], v[100:103], v[40:43]
    ds_read_b128 v[92:95], v9 offset:0
    ds_read_b128 v[96:99], v9 offset:2048
    v_mfma_f32_16x16x32_bf16 v[72:75], v[152:155], v[104:107], v[72:75]
    ds_read_b64_tr_b16 v[108:109], v19 offset:0
    ds_read_b64_tr_b16 v[110:111], v19 offset:2048
    v_mfma_f32_16x16x32_bf16 v[188:191], v[172:175], v[104:107], v[188:191]
    ds_read_b64_tr_b16 v[112:113], v20 offset:0
    ds_read_b64_tr_b16 v[114:115], v20 offset:2048
    ds_read_b64_tr_b16 v[116:117], v21 offset:0
    v_mfma_f32_16x16x32_bf16 v[44:47], v[156:159], v[100:103], v[44:47]
    ds_read_b64_tr_b16 v[118:119], v21 offset:2048
    ds_read_b64_tr_b16 v[120:121], v22 offset:0
    v_mfma_f32_16x16x32_bf16 v[76:79], v[156:159], v[104:107], v[76:79]
    ds_read_b64_tr_b16 v[122:123], v22 offset:2048
    ds_read_b64_tr_b16 v[124:125], v23 offset:0
    v_mfma_f32_16x16x32_bf16 v[192:195], v[100:103], v[100:103], v[192:195]
    ds_read_b64_tr_b16 v[126:127], v23 offset:2048
    ds_read_b64_tr_b16 v[128:129], v24 offset:0
    ds_read_b64_tr_b16 v[130:131], v24 offset:2048
    v_mfma_f32_16x16x32_bf16 v[48:51], v[160:163], v[100:103], v[48:51]
    ds_read_b64_tr_b16 v[132:133], v25 offset:0
    ds_read_b64_tr_b16 v[134:135], v25 offset:2048
    v_mfma_f32_16x16x32_bf16 v[80:83], v[160:163], v[104:107], v[80:83]
    ds_read_b64_tr_b16 v[136:137], v26 offset:0
    ds_read_b64_tr_b16 v[138:139], v26 offset:2048
    v_mfma_f32_16x16x32_bf16 v[196:199], v[104:107], v[104:107], v[196:199]
    v_mfma_f32_16x16x32_bf16 v[52:55], v[164:167], v[100:103], v[52:55]
    v_mfma_f32_16x16x32_bf16 v[84:87], v[164:167], v[104:107], v[84:87]
    v_mfma_f32_16x16x32_bf16 v[56:59], v[168:171], v[100:103], v[56:59]
    v_mfma_f32_16x16x32_bf16 v[88:91], v[168:171], v[104:107], v[88:91]
    s_waitcnt lgkmcnt(0)
    v_mfma_f32_16x16x32_bf16 v[28:31], v[108:111], v[92:95], v[28:31]
    ds_read_b128 v[100:103], v10 offset:0
    ds_read_b128 v[104:107], v10 offset:2048
    v_mfma_f32_16x16x32_bf16 v[60:63], v[108:111], v[96:99], v[60:63]
    ds_read_b64_tr_b16 v[140:141], v19 offset:8192
    v_mfma_f32_16x16x32_bf16 v[176:179], v[108:111], v[172:175], v[176:179]
    ds_read_b64_tr_b16 v[142:143], v19 offset:10240
    v_mfma_f32_16x16x32_bf16 v[32:35], v[112:115], v[92:95], v[32:35]
    ds_read_b64_tr_b16 v[144:145], v20 offset:8192
    v_mfma_f32_16x16x32_bf16 v[64:67], v[112:115], v[96:99], v[64:67]
    ds_read_b64_tr_b16 v[146:147], v20 offset:10240
    v_mfma_f32_16x16x32_bf16 v[180:183], v[112:115], v[172:175], v[180:183]
    ds_read_b64_tr_b16 v[148:149], v21 offset:8192
    v_mfma_f32_16x16x32_bf16 v[36:39], v[116:119], v[92:95], v[36:39]
    ds_read_b64_tr_b16 v[150:151], v21 offset:10240
    v_mfma_f32_16x16x32_bf16 v[68:71], v[116:119], v[96:99], v[68:71]
    ds_read_b64_tr_b16 v[152:153], v22 offset:8192
    v_mfma_f32_16x16x32_bf16 v[184:187], v[172:175], v[92:95], v[184:187]
    ds_read_b64_tr_b16 v[154:155], v22 offset:10240
    ds_read_b64_tr_b16 v[156:157], v23 offset:8192
    v_mfma_f32_16x16x32_bf16 v[40:43], v[120:123], v[92:95], v[40:43]
    ds_read_b64_tr_b16 v[158:159], v23 offset:10240
    v_mfma_f32_16x16x32_bf16 v[72:75], v[120:123], v[96:99], v[72:75]
    ds_read_b64_tr_b16 v[160:161], v24 offset:8192
    v_mfma_f32_16x16x32_bf16 v[188:191], v[172:175], v[96:99], v[188:191]
    ds_read_b64_tr_b16 v[162:163], v24 offset:10240
    v_mfma_f32_16x16x32_bf16 v[44:47], v[124:127], v[92:95], v[44:47]
    ds_read_b64_tr_b16 v[164:165], v25 offset:8192
    v_mfma_f32_16x16x32_bf16 v[76:79], v[124:127], v[96:99], v[76:79]
    ds_read_b64_tr_b16 v[166:167], v25 offset:10240
    v_mfma_f32_16x16x32_bf16 v[192:195], v[92:95], v[92:95], v[192:195]
    ds_read_b64_tr_b16 v[168:169], v26 offset:8192
    v_mfma_f32_16x16x32_bf16 v[48:51], v[128:131], v[92:95], v[48:51]
    ds_read_b64_tr_b16 v[170:171], v26 offset:10240
    v_mfma_f32_16x16x32_bf16 v[80:83], v[128:131], v[96:99], v[80:83]
    v_mfma_f32_16x16x32_bf16 v[196:199], v[96:99], v[96:99], v[196:199]
    v_mfma_f32_16x16x32_bf16 v[52:55], v[132:135], v[92:95], v[52:55]
    v_mfma_f32_16x16x32_bf16 v[84:87], v[132:135], v[96:99], v[84:87]
    v_mfma_f32_16x16x32_bf16 v[56:59], v[136:139], v[92:95], v[56:59]
    v_mfma_f32_16x16x32_bf16 v[88:91], v[136:139], v[96:99], v[88:91]
    s_waitcnt lgkmcnt(0)
    v_mfma_f32_16x16x32_bf16 v[28:31], v[140:143], v[100:103], v[28:31]
    v_mfma_f32_16x16x32_bf16 v[60:63], v[140:143], v[104:107], v[60:63]
    v_mfma_f32_16x16x32_bf16 v[176:179], v[140:143], v[172:175], v[176:179]
    v_mfma_f32_16x16x32_bf16 v[32:35], v[144:147], v[100:103], v[32:35]
    v_mfma_f32_16x16x32_bf16 v[64:67], v[144:147], v[104:107], v[64:67]
    s_waitcnt lgkmcnt(0)
    s_barrier
    v_mfma_f32_16x16x32_bf16 v[180:183], v[144:147], v[172:175], v[180:183]
    v_add_u32 v9, 0x10000, v7
    v_add_u32 v10, 0x10000, v8
    v_add_u32 v19, 0x10000, v11
    v_mfma_f32_16x16x32_bf16 v[36:39], v[148:151], v[100:103], v[36:39]
    v_add_u32 v20, 0x10000, v12
    v_add_u32 v21, 0x10000, v13
    v_mfma_f32_16x16x32_bf16 v[68:71], v[148:151], v[104:107], v[68:71]
    v_add_u32 v22, 0x10000, v14
    v_add_u32 v23, 0x10000, v15
    v_mfma_f32_16x16x32_bf16 v[184:187], v[172:175], v[100:103], v[184:187]
    v_add_u32 v24, 0x10000, v16
    v_add_u32 v25, 0x10000, v17
    v_add_u32 v26, 0x10000, v18
    v_mfma_f32_16x16x32_bf16 v[40:43], v[152:155], v[100:103], v[40:43]
    ds_read_b128 v[92:95], v9 offset:0
    ds_read_b128 v[96:99], v9 offset:2048
    v_mfma_f32_16x16x32_bf16 v[72:75], v[152:155], v[104:107], v[72:75]
    ds_read_b64_tr_b16 v[108:109], v19 offset:0
    ds_read_b64_tr_b16 v[110:111], v19 offset:2048
    v_mfma_f32_16x16x32_bf16 v[188:191], v[172:175], v[104:107], v[188:191]
    ds_read_b64_tr_b16 v[112:113], v20 offset:0
    ds_read_b64_tr_b16 v[114:115], v20 offset:2048
    ds_read_b64_tr_b16 v[116:117], v21 offset:0
    v_mfma_f32_16x16x32_bf16 v[44:47], v[156:159], v[100:103], v[44:47]
    ds_read_b64_tr_b16 v[118:119], v21 offset:2048
    ds_read_b64_tr_b16 v[120:121], v22 offset:0
    v_mfma_f32_16x16x32_bf16 v[76:79], v[156:159], v[104:107], v[76:79]
    ds_read_b64_tr_b16 v[122:123], v22 offset:2048
    ds_read_b64_tr_b16 v[124:125], v23 offset:0
    v_mfma_f32_16x16x32_bf16 v[192:195], v[100:103], v[100:103], v[192:195]
    ds_read_b64_tr_b16 v[126:127], v23 offset:2048
    ds_read_b64_tr_b16 v[128:129], v24 offset:0
    ds_read_b64_tr_b16 v[130:131], v24 offset:2048
    v_mfma_f32_16x16x32_bf16 v[48:51], v[160:163], v[100:103], v[48:51]
    ds_read_b64_tr_b16 v[132:133], v25 offset:0
    ds_read_b64_tr_b16 v[134:135], v25 offset:2048
    v_mfma_f32_16x16x32_bf16 v[80:83], v[160:163], v[104:107], v[80:83]
    ds_read_b64_tr_b16 v[136:137], v26 offset:0
    ds_read_b64_tr_b16 v[138:139], v26 offset:2048
    v_mfma_f32_16x16x32_bf16 v[196:199], v[104:107], v[104:107], v[196:199]
    v_mfma_f32_16x16x32_bf16 v[52:55], v[164:167], v[100:103], v[52:55]
    v_mfma_f32_16x16x32_bf16 v[84:87], v[164:167], v[104:107], v[84:87]
    v_mfma_f32_16x16x32_bf16 v[56:59], v[168:171], v[100:103], v[56:59]
    v_mfma_f32_16x16x32_bf16 v[88:91], v[168:171], v[104:107], v[88:91]
    s_waitcnt lgkmcnt(0)
    v_mfma_f32_16x16x32_bf16 v[28:31], v[108:111], v[92:95], v[28:31]
    ds_read_b128 v[100:103], v10 offset:0
    ds_read_b128 v[104:107], v10 offset:2048
    v_mfma_f32_16x16x32_bf16 v[60:63], v[108:111], v[96:99], v[60:63]
    ds_read_b64_tr_b16 v[140:141], v19 offset:8192
    v_mfma_f32_16x16x32_bf16 v[176:179], v[108:111], v[172:175], v[176:179]
    ds_read_b64_tr_b16 v[142:143], v19 offset:10240
    v_mfma_f32_16x16x32_bf16 v[32:35], v[112:115], v[92:95], v[32:35]
    ds_read_b64_tr_b16 v[144:145], v20 offset:8192
    v_mfma_f32_16x16x32_bf16 v[64:67], v[112:115], v[96:99], v[64:67]
    ds_read_b64_tr_b16 v[146:147], v20 offset:10240
    v_mfma_f32_16x16x32_bf16 v[180:183], v[112:115], v[172:175], v[180:183]
    ds_read_b64_tr_b16 v[148:149], v21 offset:8192
    v_mfma_f32_16x16x32_bf16 v[36:39], v[116:119], v[92:95], v[36:39]
    ds_read_b64_tr_b16 v[150:151], v21 offset:10240
    v_mfma_f32_16x16x32_bf16 v[68:71], v[116:119], v[96:99], v[68:71]
    ds_read_b64_tr_b16 v[152:153], v22 offset:8192
    v_mfma_f32_16x16x32_bf16 v[184:187], v[172:175], v[92:95], v[184:187]
    ds_read_b64_tr_b16 v[154:155], v22 offset:10240
    ds_read_b64_tr_b16 v[156:157], v23 offset:8192
    v_mfma_f32_16x16x32_bf16 v[40:43], v[120:123], v[92:95], v[40:43]
    ds_read_b64_tr_b16 v[158:159], v23 offset:10240
    v_mfma_f32_16x16x32_bf16 v[72:75], v[120:123], v[96:99], v[72:75]
    ds_read_b64_tr_b16 v[160:161], v24 offset:8192
    v_mfma_f32_16x16x32_bf16 v[188:191], v[172:175], v[96:99], v[188:191]
    ds_read_b64_tr_b16 v[162:163], v24 offset:10240
    v_mfma_f32_16x16x32_bf16 v[44:47], v[124:127], v[92:95], v[44:47]
    ds_read_b64_tr_b16 v[164:165], v25 offset:8192
    v_mfma_f32_16x16x32_bf16 v[76:79], v[124:127], v[96:99], v[76:79]
    ds_read_b64_tr_b16 v[166:167], v25 offset:10240
    v_mfma_f32_16x16x32_bf16 v[192:195], v[92:95], v[92:95], v[192:195]
    ds_read_b64_tr_b16 v[168:169], v26 offset:8192
    v_mfma_f32_16x16x32_bf16 v[48:51], v[128:131], v[92:95], v[48:51]
    ds_read_b64_tr_b16 v[170:171], v26 offset:10240
    v_mfma_f32_16x16x32_bf16 v[80:83], v[128:131], v[96:99], v[80:83]
    v_mfma_f32_16x16x32_bf16 v[196:199], v[96:99], v[96:99], v[196:199]
    v_mfma_f32_16x16x32_bf16 v[52:55], v[132:135], v[92:95], v[52:55]
    v_mfma_f32_16x16x32_bf16 v[84:87], v[132:135], v[96:99], v[84:87]
    v_mfma_f32_16x16x32_bf16 v[56:59], v[136:139], v[92:95], v[56:59]
    v_mfma_f32_16x16x32_bf16 v[88:91], v[136:139], v[96:99], v[88:91]
    s_waitcnt lgkmcnt(0)
    v_mfma_f32_16x16x32_bf16 v[28:31], v[140:143], v[100:103], v[28:31]
    v_mfma_f32_16x16x32_bf16 v[60:63], v[140:143], v[104:107], v[60:63]
    v_mfma_f32_16x16x32_bf16 v[176:179], v[140:143], v[172:175], v[176:179]
    v_mfma_f32_16x16x32_bf16 v[32:35], v[144:147], v[100:103], v[32:35]
    v_mfma_f32_16x16x32_bf16 v[64:67], v[144:147], v[104:107], v[64:67]
    s_waitcnt lgkmcnt(0)
    s_barrier
    v_mfma_f32_16x16x32_bf16 v[180:183], v[144:147], v[172:175], v[180:183]
    v_add_u32 v9, 0x18000, v7
    v_add_u32 v10, 0x18000, v8
    v_add_u32 v19, 0x18000, v11
    v_mfma_f32_16x16x32_bf16 v[36:39], v[148:151], v[100:103], v[36:39]
    v_add_u32 v20, 0x18000, v12
    v_add_u32 v21, 0x18000, v13
    v_mfma_f32_16x16x32_bf16 v[68:71], v[148:151], v[104:107], v[68:71]
    v_add_u32 v22, 0x18000, v14
    v_add_u32 v23, 0x18000, v15
    v_mfma_f32_16x16x32_bf16 v[184:187], v[172:175], v[100:103], v[184:187]
    v_add_u32 v24, 0x18000, v16
    v_add_u32 v25, 0x18000, v17
    v_add_u32 v26, 0x18000, v18
    v_mfma_f32_16x16x32_bf16 v[40:43], v[152:155], v[100:103], v[40:43]
    ds_read_b128 v[92:95], v9 offset:0
    ds_read_b128 v[96:99], v9 offset:2048
    v_mfma_f32_16x16x32_bf16 v[72:75], v[152:155], v[104:107], v[72:75]
    ds_read_b64_tr_b16 v[108:109], v19 offset:0
    ds_read_b64_tr_b16 v[110:111], v19 offset:2048
    v_mfma_f32_16x16x32_bf16 v[188:191], v[172:175], v[104:107], v[188:191]
    ds_read_b64_tr_b16 v[112:113], v20 offset:0
    ds_read_b64_tr_b16 v[114:115], v20 offset:2048
    ds_read_b64_tr_b16 v[116:117], v21 offset:0
    v_mfma_f32_16x16x32_bf16 v[44:47], v[156:159], v[100:103], v[44:47]
    ds_read_b64_tr_b16 v[118:119], v21 offset:2048
    ds_read_b64_tr_b16 v[120:121], v22 offset:0
    v_mfma_f32_16x16x32_bf16 v[76:79], v[156:159], v[104:107], v[76:79]
    ds_read_b64_tr_b16 v[122:123], v22 offset:2048
    ds_read_b64_tr_b16 v[124:125], v23 offset:0
    v_mfma_f32_16x16x32_bf16 v[192:195], v[100:103], v[100:103], v[192:195]
    ds_read_b64_tr_b16 v[126:127], v23 offset:2048
    ds_read_b64_tr_b16 v[128:129], v24 offset:0
    ds_read_b64_tr_b16 v[130:131], v24 offset:2048
    v_mfma_f32_16x16x32_bf16 v[48:51], v[160:163], v[100:103], v[48:51]
    ds_read_b64_tr_b16 v[132:133], v25 offset:0
    ds_read_b64_tr_b16 v[134:135], v25 offset:2048
    v_mfma_f32_16x16x32_bf16 v[80:83], v[160:163], v[104:107], v[80:83]
    ds_read_b64_tr_b16 v[136:137], v26 offset:0
    ds_read_b64_tr_b16 v[138:139], v26 offset:2048
    v_mfma_f32_16x16x32_bf16 v[196:199], v[104:107], v[104:107], v[196:199]
    v_mfma_f32_16x16x32_bf16 v[52:55], v[164:167], v[100:103], v[52:55]
    v_mfma_f32_16x16x32_bf16 v[84:87], v[164:167], v[104:107], v[84:87]
    v_mfma_f32_16x16x32_bf16 v[56:59], v[168:171], v[100:103], v[56:59]
    v_mfma_f32_16x16x32_bf16 v[88:91], v[168:171], v[104:107], v[88:91]
    s_waitcnt lgkmcnt(0)
    v_mfma_f32_16x16x32_bf16 v[28:31], v[108:111], v[92:95], v[28:31]
    ds_read_b128 v[100:103], v10 offset:0
    ds_read_b128 v[104:107], v10 offset:2048
    v_mfma_f32_16x16x32_bf16 v[60:63], v[108:111], v[96:99], v[60:63]
    ds_read_b64_tr_b16 v[140:141], v19 offset:8192
    v_mfma_f32_16x16x32_bf16 v[176:179], v[108:111], v[172:175], v[176:179]
    ds_read_b64_tr_b16 v[142:143], v19 offset:10240
    v_mfma_f32_16x16x32_bf16 v[32:35], v[112:115], v[92:95], v[32:35]
    ds_read_b64_tr_b16 v[144:145], v20 offset:8192
    v_mfma_f32_16x16x32_bf16 v[64:67], v[112:115], v[96:99], v[64:67]
    ds_read_b64_tr_b16 v[146:147], v20 offset:10240
    v_mfma_f32_16x16x32_bf16 v[180:183], v[112:115], v[172:175], v[180:183]
    ds_read_b64_tr_b16 v[148:149], v21 offset:8192
    v_mfma_f32_16x16x32_bf16 v[36:39], v[116:119], v[92:95], v[36:39]
    ds_read_b64_tr_b16 v[150:151], v21 offset:10240
    v_mfma_f32_16x16x32_bf16 v[68:71], v[116:119], v[96:99], v[68:71]
    ds_read_b64_tr_b16 v[152:153], v22 offset:8192
    v_mfma_f32_16x16x32_bf16 v[184:187], v[172:175], v[92:95], v[184:187]
    ds_read_b64_tr_b16 v[154:155], v22 offset:10240
    ds_read_b64_tr_b16 v[156:157], v23 offset:8192
    v_mfma_f32_16x16x32_bf16 v[40:43], v[120:123], v[92:95], v[40:43]
    ds_read_b64_tr_b16 v[158:159], v23 offset:10240
    v_mfma_f32_16x16x32_bf16 v[72:75], v[120:123], v[96:99], v[72:75]
    ds_read_b64_tr_b16 v[160:161], v24 offset:8192
    v_mfma_f32_16x16x32_bf16 v[188:191], v[172:175], v[96:99], v[188:191]
    ds_read_b64_tr_b16 v[162:163], v24 offset:10240
    v_mfma_f32_16x16x32_bf16 v[44:47], v[124:127], v[92:95], v[44:47]
    ds_read_b64_tr_b16 v[164:165], v25 offset:8192
    v_mfma_f32_16x16x32_bf16 v[76:79], v[124:127], v[96:99], v[76:79]
    ds_read_b64_tr_b16 v[166:167], v25 offset:10240
    v_mfma_f32_16x16x32_bf16 v[192:195], v[92:95], v[92:95], v[192:195]
    ds_read_b64_tr_b16 v[168:169], v26 offset:8192
    v_mfma_f32_16x16x32_bf16 v[48:51], v[128:131], v[92:95], v[48:51]
    ds_read_b64_tr_b16 v[170:171], v26 offset:10240
    v_mfma_f32_16x16x32_bf16 v[80:83], v[128:131], v[96:99], v[80:83]
    v_mfma_f32_16x16x32_bf16 v[196:199], v[96:99], v[96:99], v[196:199]
    v_mfma_f32_16x16x32_bf16 v[52:55], v[132:135], v[92:95], v[52:55]
    v_mfma_f32_16x16x32_bf16 v[84:87], v[132:135], v[96:99], v[84:87]
    v_mfma_f32_16x16x32_bf16 v[56:59], v[136:139], v[92:95], v[56:59]
    v_mfma_f32_16x16x32_bf16 v[88:91], v[136:139], v[96:99], v[88:91]
    s_waitcnt lgkmcnt(0)
    v_mfma_f32_16x16x32_bf16 v[28:31], v[140:143], v[100:103], v[28:31]
    v_mfma_f32_16x16x32_bf16 v[60:63], v[140:143], v[104:107], v[60:63]
    v_mfma_f32_16x16x32_bf16 v[176:179], v[140:143], v[172:175], v[176:179]
    v_mfma_f32_16x16x32_bf16 v[32:35], v[144:147], v[100:103], v[32:35]
    v_mfma_f32_16x16x32_bf16 v[64:67], v[144:147], v[104:107], v[64:67]
    s_waitcnt lgkmcnt(0)
    s_barrier
    v_mfma_f32_16x16x32_bf16 v[180:183], v[144:147], v[172:175], v[180:183]
    v_add_u32 v9, 0x0, v7
    v_add_u32 v10, 0x0, v8
    v_add_u32 v19, 0x0, v11
    v_mfma_f32_16x16x32_bf16 v[36:39], v[148:151], v[100:103], v[36:39]
    v_add_u32 v20, 0x0, v12
    v_add_u32 v21, 0x0, v13
    v_mfma_f32_16x16x32_bf16 v[68:71], v[148:151], v[104:107], v[68:71]
    v_add_u32 v22, 0x0, v14
    v_add_u32 v23, 0x0, v15
    v_mfma_f32_16x16x32_bf16 v[184:187], v[172:175], v[100:103], v[184:187]
    v_add_u32 v24, 0x0, v16
    v_add_u32 v25, 0x0, v17
    v_add_u32 v26, 0x0, v18
    v_mfma_f32_16x16x32_bf16 v[40:43], v[152:155], v[100:103], v[40:43]
    ds_read_b128 v[92:95], v9 offset:0
    ds_read_b128 v[96:99], v9 offset:2048
    v_mfma_f32_16x16x32_bf16 v[72:75], v[152:155], v[104:107], v[72:75]
    ds_read_b64_tr_b16 v[108:109], v19 offset:0
    ds_read_b64_tr_b16 v[110:111], v19 offset:2048
    v_mfma_f32_16x16x32_bf16 v[188:191], v[172:175], v[104:107], v[188:191]
    ds_read_b64_tr_b16 v[112:113], v20 offset:0
    ds_read_b64_tr_b16 v[114:115], v20 offset:2048
    ds_read_b64_tr_b16 v[116:117], v21 offset:0
    v_mfma_f32_16x16x32_bf16 v[44:47], v[156:159], v[100:103], v[44:47]
    ds_read_b64_tr_b16 v[118:119], v21 offset:2048
    ds_read_b64_tr_b16 v[120:121], v22 offset:0
    v_mfma_f32_16x16x32_bf16 v[76:79], v[156:159], v[104:107], v[76:79]
    ds_read_b64_tr_b16 v[122:123], v22 offset:2048
    ds_read_b64_tr_b16 v[124:125], v23 offset:0
    v_mfma_f32_16x16x32_bf16 v[192:195], v[100:103], v[100:103], v[192:195]
    ds_read_b64_tr_b16 v[126:127], v23 offset:2048
    ds_read_b64_tr_b16 v[128:129], v24 offset:0
    ds_read_b64_tr_b16 v[130:131], v24 offset:2048
    v_mfma_f32_16x16x32_bf16 v[48:51], v[160:163], v[100:103], v[48:51]
    ds_read_b64_tr_b16 v[132:133], v25 offset:0
    ds_read_b64_tr_b16 v[134:135], v25 offset:2048
    v_mfma_f32_16x16x32_bf16 v[80:83], v[160:163], v[104:107], v[80:83]
    ds_read_b64_tr_b16 v[136:137], v26 offset:0
    ds_read_b64_tr_b16 v[138:139], v26 offset:2048
    v_mfma_f32_16x16x32_bf16 v[196:199], v[104:107], v[104:107], v[196:199]
    v_mfma_f32_16x16x32_bf16 v[52:55], v[164:167], v[100:103], v[52:55]
    v_mfma_f32_16x16x32_bf16 v[84:87], v[164:167], v[104:107], v[84:87]
    v_mfma_f32_16x16x32_bf16 v[56:59], v[168:171], v[100:103], v[56:59]
    v_mfma_f32_16x16x32_bf16 v[88:91], v[168:171], v[104:107], v[88:91]
    s_waitcnt lgkmcnt(0)
    v_mfma_f32_16x16x32_bf16 v[28:31], v[108:111], v[92:95], v[28:31]
    ds_read_b128 v[100:103], v10 offset:0
    ds_read_b128 v[104:107], v10 offset:2048
    v_mfma_f32_16x16x32_bf16 v[60:63], v[108:111], v[96:99], v[60:63]
    ds_read_b64_tr_b16 v[140:141], v19 offset:8192
    v_mfma_f32_16x16x32_bf16 v[176:179], v[108:111], v[172:175], v[176:179]
    ds_read_b64_tr_b16 v[142:143], v19 offset:10240
    v_mfma_f32_16x16x32_bf16 v[32:35], v[112:115], v[92:95], v[32:35]
    ds_read_b64_tr_b16 v[144:145], v20 offset:8192
    v_mfma_f32_16x16x32_bf16 v[64:67], v[112:115], v[96:99], v[64:67]
    ds_read_b64_tr_b16 v[146:147], v20 offset:10240
    v_mfma_f32_16x16x32_bf16 v[180:183], v[112:115], v[172:175], v[180:183]
    ds_read_b64_tr_b16 v[148:149], v21 offset:8192
    v_mfma_f32_16x16x32_bf16 v[36:39], v[116:119], v[92:95], v[36:39]
    ds_read_b64_tr_b16 v[150:151], v21 offset:10240
    v_mfma_f32_16x16x32_bf16 v[68:71], v[116:119], v[96:99], v[68:71]
    ds_read_b64_tr_b16 v[152:153], v22 offset:8192
    v_mfma_f32_16x16x32_bf16 v[184:187], v[172:175], v[92:95], v[184:187]
    ds_read_b64_tr_b16 v[154:155], v22 offset:10240
    ds_read_b64_tr_b16 v[156:157], v23 offset:8192
    v_mfma_f32_16x16x32_bf16 v[40:43], v[120:123], v[92:95], v[40:43]
    ds_read_b64_tr_b16 v[158:159], v23 offset:10240
    v_mfma_f32_16x16x32_bf16 v[72:75], v[120:123], v[96:99], v[72:75]
    ds_read_b64_tr_b16 v[160:161], v24 offset:8192
    v_mfma_f32_16x16x32_bf16 v[188:191], v[172:175], v[96:99], v[188:191]
    ds_read_b64_tr_b16 v[162:163], v24 offset:10240
    v_mfma_f32_16x16x32_bf16 v[44:47], v[124:127], v[92:95], v[44:47]
    ds_read_b64_tr_b16 v[164:165], v25 offset:8192
    v_mfma_f32_16x16x32_bf16 v[76:79], v[124:127], v[96:99], v[76:79]
    ds_read_b64_tr_b16 v[166:167], v25 offset:10240
    v_mfma_f32_16x16x32_bf16 v[192:195], v[92:95], v[92:95], v[192:195]
    ds_read_b64_tr_b16 v[168:169], v26 offset:8192
    v_mfma_f32_16x16x32_bf16 v[48:51], v[128:131], v[92:95], v[48:51]
    ds_read_b64_tr_b16 v[170:171], v26 offset:10240
    v_mfma_f32_16x16x32_bf16 v[80:83], v[128:131], v[96:99], v[80:83]
    v_mfma_f32_16x16x32_bf16 v[196:199], v[96:99], v[96:99], v[196:199]
    v_mfma_f32_16x16x32_bf16 v[52:55], v[132:135], v[92:95], v[52:55]
    v_mfma_f32_16x16x32_bf16 v[84:87], v[132:135], v[96:99], v[84:87]
    v_mfma_f32_16x16x32_bf16 v[56:59], v[136:139], v[92:95], v[56:59]
    v_mfma_f32_16x16x32_bf16 v[88:91], v[136:139], v[96:99], v[88:91]
    s_waitcnt lgkmcnt(0)
    v_mfma_f32_16x16x32_bf16 v[28:31], v[140:143], v[100:103], v[28:31]
    v_mfma_f32_16x16x32_bf16 v[60:63], v[140:143], v[104:107], v[60:63]
    v_mfma_f32_16x16x32_bf16 v[176:179], v[140:143], v[172:175], v[176:179]
    v_mfma_f32_16x16x32_bf16 v[32:35], v[144:147], v[100:103], v[32:35]
    v_mfma_f32_16x16x32_bf16 v[64:67], v[144:147], v[104:107], v[64:67]
    s_waitcnt lgkmcnt(0)
    s_barrier
    v_mfma_f32_16x16x32_bf16 v[180:183], v[144:147], v[172:175], v[180:183]
    v_add_u32 v9, 0x8000, v7
    v_add_u32 v10, 0x8000, v8
    v_add_u32 v19, 0x8000, v11
    v_mfma_f32_16x16x32_bf16 v[36:39], v[148:151], v[100:103], v[36:39]
    v_add_u32 v20, 0x8000, v12
    v_add_u32 v21, 0x8000, v13
    v_mfma_f32_16x16x32_bf16 v[68:71], v[148:151], v[104:107], v[68:71]
    v_add_u32 v22, 0x8000, v14
    v_add_u32 v23, 0x8000, v15
    v_mfma_f32_16x16x32_bf16 v[184:187], v[172:175], v[100:103], v[184:187]
    v_add_u32 v24, 0x8000, v16
    v_add_u32 v25, 0x8000, v17
    v_add_u32 v26, 0x8000, v18
    v_mfma_f32_16x16x32_bf16 v[40:43], v[152:155], v[100:103], v[40:43]
    ds_read_b128 v[92:95], v9 offset:0
    ds_read_b128 v[96:99], v9 offset:2048
    v_mfma_f32_16x16x32_bf16 v[72:75], v[152:155], v[104:107], v[72:75]
    ds_read_b64_tr_b16 v[108:109], v19 offset:0
    ds_read_b64_tr_b16 v[110:111], v19 offset:2048
    v_mfma_f32_16x16x32_bf16 v[188:191], v[172:175], v[104:107], v[188:191]
    ds_read_b64_tr_b16 v[112:113], v20 offset:0
    ds_read_b64_tr_b16 v[114:115], v20 offset:2048
    ds_read_b64_tr_b16 v[116:117], v21 offset:0
    v_mfma_f32_16x16x32_bf16 v[44:47], v[156:159], v[100:103], v[44:47]
    ds_read_b64_tr_b16 v[118:119], v21 offset:2048
    ds_read_b64_tr_b16 v[120:121], v22 offset:0
    v_mfma_f32_16x16x32_bf16 v[76:79], v[156:159], v[104:107], v[76:79]
    ds_read_b64_tr_b16 v[122:123], v22 offset:2048
    ds_read_b64_tr_b16 v[124:125], v23 offset:0
    v_mfma_f32_16x16x32_bf16 v[192:195], v[100:103], v[100:103], v[192:195]
    ds_read_b64_tr_b16 v[126:127], v23 offset:2048
    ds_read_b64_tr_b16 v[128:129], v24 offset:0
    ds_read_b64_tr_b16 v[130:131], v24 offset:2048
    v_mfma_f32_16x16x32_bf16 v[48:51], v[160:163], v[100:103], v[48:51]
    ds_read_b64_tr_b16 v[132:133], v25 offset:0
    ds_read_b64_tr_b16 v[134:135], v25 offset:2048
    v_mfma_f32_16x16x32_bf16 v[80:83], v[160:163], v[104:107], v[80:83]
    ds_read_b64_tr_b16 v[136:137], v26 offset:0
    ds_read_b64_tr_b16 v[138:139], v26 offset:2048
    v_mfma_f32_16x16x32_bf16 v[196:199], v[104:107], v[104:107], v[196:199]
    v_mfma_f32_16x16x32_bf16 v[52:55], v[164:167], v[100:103], v[52:55]
    v_mfma_f32_16x16x32_bf16 v[84:87], v[164:167], v[104:107], v[84:87]
    v_mfma_f32_16x16x32_bf16 v[56:59], v[168:171], v[100:103], v[56:59]
    v_mfma_f32_16x16x32_bf16 v[88:91], v[168:171], v[104:107], v[88:91]
    s_waitcnt lgkmcnt(0)
    v_mfma_f32_16x16x32_bf16 v[28:31], v[108:111], v[92:95], v[28:31]
    ds_read_b128 v[100:103], v10 offset:0
    ds_read_b128 v[104:107], v10 offset:2048
    v_mfma_f32_16x16x32_bf16 v[60:63], v[108:111], v[96:99], v[60:63]
    ds_read_b64_tr_b16 v[140:141], v19 offset:8192
    v_mfma_f32_16x16x32_bf16 v[176:179], v[108:111], v[172:175], v[176:179]
    ds_read_b64_tr_b16 v[142:143], v19 offset:10240
    v_mfma_f32_16x16x32_bf16 v[32:35], v[112:115], v[92:95], v[32:35]
    ds_read_b64_tr_b16 v[144:145], v20 offset:8192
    v_mfma_f32_16x16x32_bf16 v[64:67], v[112:115], v[96:99], v[64:67]
    ds_read_b64_tr_b16 v[146:147], v20 offset:10240
    v_mfma_f32_16x16x32_bf16 v[180:183], v[112:115], v[172:175], v[180:183]
    ds_read_b64_tr_b16 v[148:149], v21 offset:8192
    v_mfma_f32_16x16x32_bf16 v[36:39], v[116:119], v[92:95], v[36:39]
    ds_read_b64_tr_b16 v[150:151], v21 offset:10240
    v_mfma_f32_16x16x32_bf16 v[68:71], v[116:119], v[96:99], v[68:71]
    ds_read_b64_tr_b16 v[152:153], v22 offset:8192
    v_mfma_f32_16x16x32_bf16 v[184:187], v[172:175], v[92:95], v[184:187]
    ds_read_b64_tr_b16 v[154:155], v22 offset:10240
    ds_read_b64_tr_b16 v[156:157], v23 offset:8192
    v_mfma_f32_16x16x32_bf16 v[40:43], v[120:123], v[92:95], v[40:43]
    ds_read_b64_tr_b16 v[158:159], v23 offset:10240
    v_mfma_f32_16x16x32_bf16 v[72:75], v[120:123], v[96:99], v[72:75]
    ds_read_b64_tr_b16 v[160:161], v24 offset:8192
    v_mfma_f32_16x16x32_bf16 v[188:191], v[172:175], v[96:99], v[188:191]
    ds_read_b64_tr_b16 v[162:163], v24 offset:10240
    v_mfma_f32_16x16x32_bf16 v[44:47], v[124:127], v[92:95], v[44:47]
    ds_read_b64_tr_b16 v[164:165], v25 offset:8192
    v_mfma_f32_16x16x32_bf16 v[76:79], v[124:127], v[96:99], v[76:79]
    ds_read_b64_tr_b16 v[166:167], v25 offset:10240
    v_mfma_f32_16x16x32_bf16 v[192:195], v[92:95], v[92:95], v[192:195]
    ds_read_b64_tr_b16 v[168:169], v26 offset:8192
    v_mfma_f32_16x16x32_bf16 v[48:51], v[128:131], v[92:95], v[48:51]
    ds_read_b64_tr_b16 v[170:171], v26 offset:10240
    v_mfma_f32_16x16x32_bf16 v[80:83], v[128:131], v[96:99], v[80:83]
    v_mfma_f32_16x16x32_bf16 v[196:199], v[96:99], v[96:99], v[196:199]
    v_mfma_f32_16x16x32_bf16 v[52:55], v[132:135], v[92:95], v[52:55]
    v_mfma_f32_16x16x32_bf16 v[84:87], v[132:135], v[96:99], v[84:87]
    v_mfma_f32_16x16x32_bf16 v[56:59], v[136:139], v[92:95], v[56:59]
    v_mfma_f32_16x16x32_bf16 v[88:91], v[136:139], v[96:99], v[88:91]
    s_waitcnt lgkmcnt(0)
    v_mfma_f32_16x16x32_bf16 v[28:31], v[140:143], v[100:103], v[28:31]
    v_mfma_f32_16x16x32_bf16 v[60:63], v[140:143], v[104:107], v[60:63]
    v_mfma_f32_16x16x32_bf16 v[176:179], v[140:143], v[172:175], v[176:179]
    v_mfma_f32_16x16x32_bf16 v[32:35], v[144:147], v[100:103], v[32:35]
    v_mfma_f32_16x16x32_bf16 v[64:67], v[144:147], v[104:107], v[64:67]
    s_waitcnt lgkmcnt(0)
    s_barrier
    v_mfma_f32_16x16x32_bf16 v[180:183], v[144:147], v[172:175], v[180:183]
    v_add_u32 v9, 0x10000, v7
    v_add_u32 v10, 0x10000, v8
    v_add_u32 v19, 0x10000, v11
    v_mfma_f32_16x16x32_bf16 v[36:39], v[148:151], v[100:103], v[36:39]
    v_add_u32 v20, 0x10000, v12
    v_add_u32 v21, 0x10000, v13
    v_mfma_f32_16x16x32_bf16 v[68:71], v[148:151], v[104:107], v[68:71]
    v_add_u32 v22, 0x10000, v14
    v_add_u32 v23, 0x10000, v15
    v_mfma_f32_16x16x32_bf16 v[184:187], v[172:175], v[100:103], v[184:187]
    v_add_u32 v24, 0x10000, v16
    v_add_u32 v25, 0x10000, v17
    v_add_u32 v26, 0x10000, v18
    v_mfma_f32_16x16x32_bf16 v[40:43], v[152:155], v[100:103], v[40:43]
    ds_read_b128 v[92:95], v9 offset:0
    ds_read_b128 v[96:99], v9 offset:2048
    v_mfma_f32_16x16x32_bf16 v[72:75], v[152:155], v[104:107], v[72:75]
    ds_read_b64_tr_b16 v[108:109], v19 offset:0
    ds_read_b64_tr_b16 v[110:111], v19 offset:2048
    v_mfma_f32_16x16x32_bf16 v[188:191], v[172:175], v[104:107], v[188:191]
    ds_read_b64_tr_b16 v[112:113], v20 offset:0
    ds_read_b64_tr_b16 v[114:115], v20 offset:2048
    ds_read_b64_tr_b16 v[116:117], v21 offset:0
    v_mfma_f32_16x16x32_bf16 v[44:47], v[156:159], v[100:103], v[44:47]
    ds_read_b64_tr_b16 v[118:119], v21 offset:2048
    ds_read_b64_tr_b16 v[120:121], v22 offset:0
    v_mfma_f32_16x16x32_bf16 v[76:79], v[156:159], v[104:107], v[76:79]
    ds_read_b64_tr_b16 v[122:123], v22 offset:2048
    ds_read_b64_tr_b16 v[124:125], v23 offset:0
    v_mfma_f32_16x16x32_bf16 v[192:195], v[100:103], v[100:103], v[192:195]
    ds_read_b64_tr_b16 v[126:127], v23 offset:2048
    ds_read_b64_tr_b16 v[128:129], v24 offset:0
    ds_read_b64_tr_b16 v[130:131], v24 offset:2048
    v_mfma_f32_16x16x32_bf16 v[48:51], v[160:163], v[100:103], v[48:51]
    ds_read_b64_tr_b16 v[132:133], v25 offset:0
    ds_read_b64_tr_b16 v[134:135], v25 offset:2048
    v_mfma_f32_16x16x32_bf16 v[80:83], v[160:163], v[104:107], v[80:83]
    ds_read_b64_tr_b16 v[136:137], v26 offset:0
    ds_read_b64_tr_b16 v[138:139], v26 offset:2048
    v_mfma_f32_16x16x32_bf16 v[196:199], v[104:107], v[104:107], v[196:199]
    v_mfma_f32_16x16x32_bf16 v[52:55], v[164:167], v[100:103], v[52:55]
    v_mfma_f32_16x16x32_bf16 v[84:87], v[164:167], v[104:107], v[84:87]
    v_mfma_f32_16x16x32_bf16 v[56:59], v[168:171], v[100:103], v[56:59]
    v_mfma_f32_16x16x32_bf16 v[88:91], v[168:171], v[104:107], v[88:91]
    s_waitcnt lgkmcnt(0)
    v_mfma_f32_16x16x32_bf16 v[28:31], v[108:111], v[92:95], v[28:31]
    ds_read_b128 v[100:103], v10 offset:0
    ds_read_b128 v[104:107], v10 offset:2048
    v_mfma_f32_16x16x32_bf16 v[60:63], v[108:111], v[96:99], v[60:63]
    ds_read_b64_tr_b16 v[140:141], v19 offset:8192
    v_mfma_f32_16x16x32_bf16 v[176:179], v[108:111], v[172:175], v[176:179]
    ds_read_b64_tr_b16 v[142:143], v19 offset:10240
    v_mfma_f32_16x16x32_bf16 v[32:35], v[112:115], v[92:95], v[32:35]
    ds_read_b64_tr_b16 v[144:145], v20 offset:8192
    v_mfma_f32_16x16x32_bf16 v[64:67], v[112:115], v[96:99], v[64:67]
    ds_read_b64_tr_b16 v[146:147], v20 offset:10240
    v_mfma_f32_16x16x32_bf16 v[180:183], v[112:115], v[172:175], v[180:183]
    ds_read_b64_tr_b16 v[148:149], v21 offset:8192
    v_mfma_f32_16x16x32_bf16 v[36:39], v[116:119], v[92:95], v[36:39]
    ds_read_b64_tr_b16 v[150:151], v21 offset:10240
    v_mfma_f32_16x16x32_bf16 v[68:71], v[116:119], v[96:99], v[68:71]
    ds_read_b64_tr_b16 v[152:153], v22 offset:8192
    v_mfma_f32_16x16x32_bf16 v[184:187], v[172:175], v[92:95], v[184:187]
    ds_read_b64_tr_b16 v[154:155], v22 offset:10240
    ds_read_b64_tr_b16 v[156:157], v23 offset:8192
    v_mfma_f32_16x16x32_bf16 v[40:43], v[120:123], v[92:95], v[40:43]
    ds_read_b64_tr_b16 v[158:159], v23 offset:10240
    v_mfma_f32_16x16x32_bf16 v[72:75], v[120:123], v[96:99], v[72:75]
    ds_read_b64_tr_b16 v[160:161], v24 offset:8192
    v_mfma_f32_16x16x32_bf16 v[188:191], v[172:175], v[96:99], v[188:191]
    ds_read_b64_tr_b16 v[162:163], v24 offset:10240
    v_mfma_f32_16x16x32_bf16 v[44:47], v[124:127], v[92:95], v[44:47]
    ds_read_b64_tr_b16 v[164:165], v25 offset:8192
    v_mfma_f32_16x16x32_bf16 v[76:79], v[124:127], v[96:99], v[76:79]
    ds_read_b64_tr_b16 v[166:167], v25 offset:10240
    v_mfma_f32_16x16x32_bf16 v[192:195], v[92:95], v[92:95], v[192:195]
    ds_read_b64_tr_b16 v[168:169], v26 offset:8192
    v_mfma_f32_16x16x32_bf16 v[48:51], v[128:131], v[92:95], v[48:51]
    ds_read_b64_tr_b16 v[170:171], v26 offset:10240
    v_mfma_f32_16x16x32_bf16 v[80:83], v[128:131], v[96:99], v[80:83]
    v_mfma_f32_16x16x32_bf16 v[196:199], v[96:99], v[96:99], v[196:199]
    v_mfma_f32_16x16x32_bf16 v[52:55], v[132:135], v[92:95], v[52:55]
    v_mfma_f32_16x16x32_bf16 v[84:87], v[132:135], v[96:99], v[84:87]
    v_mfma_f32_16x16x32_bf16 v[56:59], v[136:139], v[92:95], v[56:59]
    v_mfma_f32_16x16x32_bf16 v[88:91], v[136:139], v[96:99], v[88:91]
    s_waitcnt lgkmcnt(0)
    v_mfma_f32_16x16x32_bf16 v[28:31], v[140:143], v[100:103], v[28:31]
    v_mfma_f32_16x16x32_bf16 v[60:63], v[140:143], v[104:107], v[60:63]
    v_mfma_f32_16x16x32_bf16 v[176:179], v[140:143], v[172:175], v[176:179]
    v_mfma_f32_16x16x32_bf16 v[32:35], v[144:147], v[100:103], v[32:35]
    v_mfma_f32_16x16x32_bf16 v[64:67], v[144:147], v[104:107], v[64:67]
    s_waitcnt lgkmcnt(0)
    s_barrier
    v_mfma_f32_16x16x32_bf16 v[180:183], v[144:147], v[172:175], v[180:183]
    v_add_u32 v9, 0x18000, v7
    v_add_u32 v10, 0x18000, v8
    v_add_u32 v19, 0x18000, v11
    v_mfma_f32_16x16x32_bf16 v[36:39], v[148:151], v[100:103], v[36:39]
    v_add_u32 v20, 0x18000, v12
    v_add_u32 v21, 0x18000, v13
    v_mfma_f32_16x16x32_bf16 v[68:71], v[148:151], v[104:107], v[68:71]
    v_add_u32 v22, 0x18000, v14
    v_add_u32 v23, 0x18000, v15
    v_mfma_f32_16x16x32_bf16 v[184:187], v[172:175], v[100:103], v[184:187]
    v_add_u32 v24, 0x18000, v16
    v_add_u32 v25, 0x18000, v17
    v_add_u32 v26, 0x18000, v18
    v_mfma_f32_16x16x32_bf16 v[40:43], v[152:155], v[100:103], v[40:43]
    ds_read_b128 v[92:95], v9 offset:0
    ds_read_b128 v[96:99], v9 offset:2048
    v_mfma_f32_16x16x32_bf16 v[72:75], v[152:155], v[104:107], v[72:75]
    ds_read_b64_tr_b16 v[108:109], v19 offset:0
    ds_read_b64_tr_b16 v[110:111], v19 offset:2048
    v_mfma_f32_16x16x32_bf16 v[188:191], v[172:175], v[104:107], v[188:191]
    ds_read_b64_tr_b16 v[112:113], v20 offset:0
    ds_read_b64_tr_b16 v[114:115], v20 offset:2048
    ds_read_b64_tr_b16 v[116:117], v21 offset:0
    v_mfma_f32_16x16x32_bf16 v[44:47], v[156:159], v[100:103], v[44:47]
    ds_read_b64_tr_b16 v[118:119], v21 offset:2048
    ds_read_b64_tr_b16 v[120:121], v22 offset:0
    v_mfma_f32_16x16x32_bf16 v[76:79], v[156:159], v[104:107], v[76:79]
    ds_read_b64_tr_b16 v[122:123], v22 offset:2048
    ds_read_b64_tr_b16 v[124:125], v23 offset:0
    v_mfma_f32_16x16x32_bf16 v[192:195], v[100:103], v[100:103], v[192:195]
    ds_read_b64_tr_b16 v[126:127], v23 offset:2048
    ds_read_b64_tr_b16 v[128:129], v24 offset:0
    ds_read_b64_tr_b16 v[130:131], v24 offset:2048
    v_mfma_f32_16x16x32_bf16 v[48:51], v[160:163], v[100:103], v[48:51]
    ds_read_b64_tr_b16 v[132:133], v25 offset:0
    ds_read_b64_tr_b16 v[134:135], v25 offset:2048
    v_mfma_f32_16x16x32_bf16 v[80:83], v[160:163], v[104:107], v[80:83]
    ds_read_b64_tr_b16 v[136:137], v26 offset:0
    ds_read_b64_tr_b16 v[138:139], v26 offset:2048
    v_mfma_f32_16x16x32_bf16 v[196:199], v[104:107], v[104:107], v[196:199]
    v_mfma_f32_16x16x32_bf16 v[52:55], v[164:167], v[100:103], v[52:55]
    v_mfma_f32_16x16x32_bf16 v[84:87], v[164:167], v[104:107], v[84:87]
    v_mfma_f32_16x16x32_bf16 v[56:59], v[168:171], v[100:103], v[56:59]
    v_mfma_f32_16x16x32_bf16 v[88:91], v[168:171], v[104:107], v[88:91]
    s_waitcnt lgkmcnt(0)
    v_mfma_f32_16x16x32_bf16 v[28:31], v[108:111], v[92:95], v[28:31]
    ds_read_b128 v[100:103], v10 offset:0
    ds_read_b128 v[104:107], v10 offset:2048
    v_mfma_f32_16x16x32_bf16 v[60:63], v[108:111], v[96:99], v[60:63]
    ds_read_b64_tr_b16 v[140:141], v19 offset:8192
    v_mfma_f32_16x16x32_bf16 v[176:179], v[108:111], v[172:175], v[176:179]
    ds_read_b64_tr_b16 v[142:143], v19 offset:10240
    v_mfma_f32_16x16x32_bf16 v[32:35], v[112:115], v[92:95], v[32:35]
    ds_read_b64_tr_b16 v[144:145], v20 offset:8192
    v_mfma_f32_16x16x32_bf16 v[64:67], v[112:115], v[96:99], v[64:67]
    ds_read_b64_tr_b16 v[146:147], v20 offset:10240
    v_mfma_f32_16x16x32_bf16 v[180:183], v[112:115], v[172:175], v[180:183]
    ds_read_b64_tr_b16 v[148:149], v21 offset:8192
    v_mfma_f32_16x16x32_bf16 v[36:39], v[116:119], v[92:95], v[36:39]
    ds_read_b64_tr_b16 v[150:151], v21 offset:10240
    v_mfma_f32_16x16x32_bf16 v[68:71], v[116:119], v[96:99], v[68:71]
    ds_read_b64_tr_b16 v[152:153], v22 offset:8192
    v_mfma_f32_16x16x32_bf16 v[184:187], v[172:175], v[92:95], v[184:187]
    ds_read_b64_tr_b16 v[154:155], v22 offset:10240
    ds_read_b64_tr_b16 v[156:157], v23 offset:8192
    v_mfma_f32_16x16x32_bf16 v[40:43], v[120:123], v[92:95], v[40:43]
    ds_read_b64_tr_b16 v[158:159], v23 offset:10240
    v_mfma_f32_16x16x32_bf16 v[72:75], v[120:123], v[96:99], v[72:75]
    ds_read_b64_tr_b16 v[160:161], v24 offset:8192
    v_mfma_f32_16x16x32_bf16 v[188:191], v[172:175], v[96:99], v[188:191]
    ds_read_b64_tr_b16 v[162:163], v24 offset:10240
    v_mfma_f32_16x16x32_bf16 v[44:47], v[124:127], v[92:95], v[44:47]
    ds_read_b64_tr_b16 v[164:165], v25 offset:8192
    v_mfma_f32_16x16x32_bf16 v[76:79], v[124:127], v[96:99], v[76:79]
    ds_read_b64_tr_b16 v[166:167], v25 offset:10240
    v_mfma_f32_16x16x32_bf16 v[192:195], v[92:95], v[92:95], v[192:195]
    ds_read_b64_tr_b16 v[168:169], v26 offset:8192
    v_mfma_f32_16x16x32_bf16 v[48:51], v[128:131], v[92:95], v[48:51]
    ds_read_b64_tr_b16 v[170:171], v26 offset:10240
    v_mfma_f32_16x16x32_bf16 v[80:83], v[128:131], v[96:99], v[80:83]
    v_mfma_f32_16x16x32_bf16 v[196:199], v[96:99], v[96:99], v[196:199]
    v_mfma_f32_16x16x32_bf16 v[52:55], v[132:135], v[92:95], v[52:55]
    v_mfma_f32_16x16x32_bf16 v[84:87], v[132:135], v[96:99], v[84:87]
    v_mfma_f32_16x16x32_bf16 v[56:59], v[136:139], v[92:95], v[56:59]
    v_mfma_f32_16x16x32_bf16 v[88:91], v[136:139], v[96:99], v[88:91]
    s_waitcnt lgkmcnt(0)
    v_mfma_f32_16x16x32_bf16 v[28:31], v[140:143], v[100:103], v[28:31]
    v_mfma_f32_16x16x32_bf16 v[60:63], v[140:143], v[104:107], v[60:63]
    v_mfma_f32_16x16x32_bf16 v[176:179], v[140:143], v[172:175], v[176:179]
    v_mfma_f32_16x16x32_bf16 v[32:35], v[144:147], v[100:103], v[32:35]
    v_mfma_f32_16x16x32_bf16 v[64:67], v[144:147], v[104:107], v[64:67]
    s_waitcnt lgkmcnt(0)
    s_barrier
    v_mfma_f32_16x16x32_bf16 v[180:183], v[144:147], v[172:175], v[180:183]
    v_add_u32 v9, 0x0, v7
    v_add_u32 v10, 0x0, v8
    v_add_u32 v19, 0x0, v11
    v_mfma_f32_16x16x32_bf16 v[36:39], v[148:151], v[100:103], v[36:39]
    v_add_u32 v20, 0x0, v12
    v_add_u32 v21, 0x0, v13
    v_mfma_f32_16x16x32_bf16 v[68:71], v[148:151], v[104:107], v[68:71]
    v_add_u32 v22, 0x0, v14
    v_add_u32 v23, 0x0, v15
    v_mfma_f32_16x16x32_bf16 v[184:187], v[172:175], v[100:103], v[184:187]
    v_add_u32 v24, 0x0, v16
    v_add_u32 v25, 0x0, v17
    v_add_u32 v26, 0x0, v18
    v_mfma_f32_16x16x32_bf16 v[40:43], v[152:155], v[100:103], v[40:43]
    ds_read_b128 v[92:95], v9 offset:0
    ds_read_b128 v[96:99], v9 offset:2048
    v_mfma_f32_16x16x32_bf16 v[72:75], v[152:155], v[104:107], v[72:75]
    ds_read_b64_tr_b16 v[108:109], v19 offset:0
    ds_read_b64_tr_b16 v[110:111], v19 offset:2048
    v_mfma_f32_16x16x32_bf16 v[188:191], v[172:175], v[104:107], v[188:191]
    ds_read_b64_tr_b16 v[112:113], v20 offset:0
    ds_read_b64_tr_b16 v[114:115], v20 offset:2048
    ds_read_b64_tr_b16 v[116:117], v21 offset:0
    v_mfma_f32_16x16x32_bf16 v[44:47], v[156:159], v[100:103], v[44:47]
    ds_read_b64_tr_b16 v[118:119], v21 offset:2048
    ds_read_b64_tr_b16 v[120:121], v22 offset:0
    v_mfma_f32_16x16x32_bf16 v[76:79], v[156:159], v[104:107], v[76:79]
    ds_read_b64_tr_b16 v[122:123], v22 offset:2048
    ds_read_b64_tr_b16 v[124:125], v23 offset:0
    v_mfma_f32_16x16x32_bf16 v[192:195], v[100:103], v[100:103], v[192:195]
    ds_read_b64_tr_b16 v[126:127], v23 offset:2048
    ds_read_b64_tr_b16 v[128:129], v24 offset:0
    ds_read_b64_tr_b16 v[130:131], v24 offset:2048
    v_mfma_f32_16x16x32_bf16 v[48:51], v[160:163], v[100:103], v[48:51]
    ds_read_b64_tr_b16 v[132:133], v25 offset:0
    ds_read_b64_tr_b16 v[134:135], v25 offset:2048
    v_mfma_f32_16x16x32_bf16 v[80:83], v[160:163], v[104:107], v[80:83]
    ds_read_b64_tr_b16 v[136:137], v26 offset:0
    ds_read_b64_tr_b16 v[138:139], v26 offset:2048
    v_mfma_f32_16x16x32_bf16 v[196:199], v[104:107], v[104:107], v[196:199]
    v_mfma_f32_16x16x32_bf16 v[52:55], v[164:167], v[100:103], v[52:55]
    v_mfma_f32_16x16x32_bf16 v[84:87], v[164:167], v[104:107], v[84:87]
    v_mfma_f32_16x16x32_bf16 v[56:59], v[168:171], v[100:103], v[56:59]
    v_mfma_f32_16x16x32_bf16 v[88:91], v[168:171], v[104:107], v[88:91]
    s_waitcnt lgkmcnt(0)
    v_mfma_f32_16x16x32_bf16 v[28:31], v[108:111], v[92:95], v[28:31]
    ds_read_b128 v[100:103], v10 offset:0
    ds_read_b128 v[104:107], v10 offset:2048
    v_mfma_f32_16x16x32_bf16 v[60:63], v[108:111], v[96:99], v[60:63]
    ds_read_b64_tr_b16 v[140:141], v19 offset:8192
    v_mfma_f32_16x16x32_bf16 v[176:179], v[108:111], v[172:175], v[176:179]
    ds_read_b64_tr_b16 v[142:143], v19 offset:10240
    v_mfma_f32_16x16x32_bf16 v[32:35], v[112:115], v[92:95], v[32:35]
    ds_read_b64_tr_b16 v[144:145], v20 offset:8192
    v_mfma_f32_16x16x32_bf16 v[64:67], v[112:115], v[96:99], v[64:67]
    ds_read_b64_tr_b16 v[146:147], v20 offset:10240
    v_mfma_f32_16x16x32_bf16 v[180:183], v[112:115], v[172:175], v[180:183]
    ds_read_b64_tr_b16 v[148:149], v21 offset:8192
    v_mfma_f32_16x16x32_bf16 v[36:39], v[116:119], v[92:95], v[36:39]
    ds_read_b64_tr_b16 v[150:151], v21 offset:10240
    v_mfma_f32_16x16x32_bf16 v[68:71], v[116:119], v[96:99], v[68:71]
    ds_read_b64_tr_b16 v[152:153], v22 offset:8192
    v_mfma_f32_16x16x32_bf16 v[184:187], v[172:175], v[92:95], v[184:187]
    ds_read_b64_tr_b16 v[154:155], v22 offset:10240
    ds_read_b64_tr_b16 v[156:157], v23 offset:8192
    v_mfma_f32_16x16x32_bf16 v[40:43], v[120:123], v[92:95], v[40:43]
    ds_read_b64_tr_b16 v[158:159], v23 offset:10240
    v_mfma_f32_16x16x32_bf16 v[72:75], v[120:123], v[96:99], v[72:75]
    ds_read_b64_tr_b16 v[160:161], v24 offset:8192
    v_mfma_f32_16x16x32_bf16 v[188:191], v[172:175], v[96:99], v[188:191]
    ds_read_b64_tr_b16 v[162:163], v24 offset:10240
    v_mfma_f32_16x16x32_bf16 v[44:47], v[124:127], v[92:95], v[44:47]
    ds_read_b64_tr_b16 v[164:165], v25 offset:8192
    v_mfma_f32_16x16x32_bf16 v[76:79], v[124:127], v[96:99], v[76:79]
    ds_read_b64_tr_b16 v[166:167], v25 offset:10240
    v_mfma_f32_16x16x32_bf16 v[192:195], v[92:95], v[92:95], v[192:195]
    ds_read_b64_tr_b16 v[168:169], v26 offset:8192
    v_mfma_f32_16x16x32_bf16 v[48:51], v[128:131], v[92:95], v[48:51]
    ds_read_b64_tr_b16 v[170:171], v26 offset:10240
    v_mfma_f32_16x16x32_bf16 v[80:83], v[128:131], v[96:99], v[80:83]
    v_mfma_f32_16x16x32_bf16 v[196:199], v[96:99], v[96:99], v[196:199]
    v_mfma_f32_16x16x32_bf16 v[52:55], v[132:135], v[92:95], v[52:55]
    v_mfma_f32_16x16x32_bf16 v[84:87], v[132:135], v[96:99], v[84:87]
    v_mfma_f32_16x16x32_bf16 v[56:59], v[136:139], v[92:95], v[56:59]
    v_mfma_f32_16x16x32_bf16 v[88:91], v[136:139], v[96:99], v[88:91]
    s_waitcnt lgkmcnt(0)
    v_mfma_f32_16x16x32_bf16 v[28:31], v[140:143], v[100:103], v[28:31]
    v_mfma_f32_16x16x32_bf16 v[60:63], v[140:143], v[104:107], v[60:63]
    v_mfma_f32_16x16x32_bf16 v[176:179], v[140:143], v[172:175], v[176:179]
    v_mfma_f32_16x16x32_bf16 v[32:35], v[144:147], v[100:103], v[32:35]
    v_mfma_f32_16x16x32_bf16 v[64:67], v[144:147], v[104:107], v[64:67]
    s_waitcnt lgkmcnt(0)
    s_barrier
    v_mfma_f32_16x16x32_bf16 v[180:183], v[144:147], v[172:175], v[180:183]
    v_add_u32 v9, 0x8000, v7
    v_add_u32 v10, 0x8000, v8
    v_add_u32 v19, 0x8000, v11
    v_mfma_f32_16x16x32_bf16 v[36:39], v[148:151], v[100:103], v[36:39]
    v_add_u32 v20, 0x8000, v12
    v_add_u32 v21, 0x8000, v13
    v_mfma_f32_16x16x32_bf16 v[68:71], v[148:151], v[104:107], v[68:71]
    v_add_u32 v22, 0x8000, v14
    v_add_u32 v23, 0x8000, v15
    v_mfma_f32_16x16x32_bf16 v[184:187], v[172:175], v[100:103], v[184:187]
    v_add_u32 v24, 0x8000, v16
    v_add_u32 v25, 0x8000, v17
    v_add_u32 v26, 0x8000, v18
    v_mfma_f32_16x16x32_bf16 v[40:43], v[152:155], v[100:103], v[40:43]
    ds_read_b128 v[92:95], v9 offset:0
    ds_read_b128 v[96:99], v9 offset:2048
    v_mfma_f32_16x16x32_bf16 v[72:75], v[152:155], v[104:107], v[72:75]
    ds_read_b64_tr_b16 v[108:109], v19 offset:0
    ds_read_b64_tr_b16 v[110:111], v19 offset:2048
    v_mfma_f32_16x16x32_bf16 v[188:191], v[172:175], v[104:107], v[188:191]
    ds_read_b64_tr_b16 v[112:113], v20 offset:0
    ds_read_b64_tr_b16 v[114:115], v20 offset:2048
    ds_read_b64_tr_b16 v[116:117], v21 offset:0
    v_mfma_f32_16x16x32_bf16 v[44:47], v[156:159], v[100:103], v[44:47]
    ds_read_b64_tr_b16 v[118:119], v21 offset:2048
    ds_read_b64_tr_b16 v[120:121], v22 offset:0
    v_mfma_f32_16x16x32_bf16 v[76:79], v[156:159], v[104:107], v[76:79]
    ds_read_b64_tr_b16 v[122:123], v22 offset:2048
    ds_read_b64_tr_b16 v[124:125], v23 offset:0
    v_mfma_f32_16x16x32_bf16 v[192:195], v[100:103], v[100:103], v[192:195]
    ds_read_b64_tr_b16 v[126:127], v23 offset:2048
    ds_read_b64_tr_b16 v[128:129], v24 offset:0
    ds_read_b64_tr_b16 v[130:131], v24 offset:2048
    v_mfma_f32_16x16x32_bf16 v[48:51], v[160:163], v[100:103], v[48:51]
    ds_read_b64_tr_b16 v[132:133], v25 offset:0
    ds_read_b64_tr_b16 v[134:135], v25 offset:2048
    v_mfma_f32_16x16x32_bf16 v[80:83], v[160:163], v[104:107], v[80:83]
    ds_read_b64_tr_b16 v[136:137], v26 offset:0
    ds_read_b64_tr_b16 v[138:139], v26 offset:2048
    v_mfma_f32_16x16x32_bf16 v[196:199], v[104:107], v[104:107], v[196:199]
    v_mfma_f32_16x16x32_bf16 v[52:55], v[164:167], v[100:103], v[52:55]
    v_mfma_f32_16x16x32_bf16 v[84:87], v[164:167], v[104:107], v[84:87]
    v_mfma_f32_16x16x32_bf16 v[56:59], v[168:171], v[100:103], v[56:59]
    v_mfma_f32_16x16x32_bf16 v[88:91], v[168:171], v[104:107], v[88:91]
    s_waitcnt lgkmcnt(0)
    v_mfma_f32_16x16x32_bf16 v[28:31], v[108:111], v[92:95], v[28:31]
    ds_read_b128 v[100:103], v10 offset:0
    ds_read_b128 v[104:107], v10 offset:2048
    v_mfma_f32_16x16x32_bf16 v[60:63], v[108:111], v[96:99], v[60:63]
    ds_read_b64_tr_b16 v[140:141], v19 offset:8192
    v_mfma_f32_16x16x32_bf16 v[176:179], v[108:111], v[172:175], v[176:179]
    ds_read_b64_tr_b16 v[142:143], v19 offset:10240
    v_mfma_f32_16x16x32_bf16 v[32:35], v[112:115], v[92:95], v[32:35]
    ds_read_b64_tr_b16 v[144:145], v20 offset:8192
    v_mfma_f32_16x16x32_bf16 v[64:67], v[112:115], v[96:99], v[64:67]
    ds_read_b64_tr_b16 v[146:147], v20 offset:10240
    v_mfma_f32_16x16x32_bf16 v[180:183], v[112:115], v[172:175], v[180:183]
    ds_read_b64_tr_b16 v[148:149], v21 offset:8192
    v_mfma_f32_16x16x32_bf16 v[36:39], v[116:119], v[92:95], v[36:39]
    ds_read_b64_tr_b16 v[150:151], v21 offset:10240
    v_mfma_f32_16x16x32_bf16 v[68:71], v[116:119], v[96:99], v[68:71]
    ds_read_b64_tr_b16 v[152:153], v22 offset:8192
    v_mfma_f32_16x16x32_bf16 v[184:187], v[172:175], v[92:95], v[184:187]
    ds_read_b64_tr_b16 v[154:155], v22 offset:10240
    ds_read_b64_tr_b16 v[156:157], v23 offset:8192
    v_mfma_f32_16x16x32_bf16 v[40:43], v[120:123], v[92:95], v[40:43]
    ds_read_b64_tr_b16 v[158:159], v23 offset:10240
    v_mfma_f32_16x16x32_bf16 v[72:75], v[120:123], v[96:99], v[72:75]
    ds_read_b64_tr_b16 v[160:161], v24 offset:8192
    v_mfma_f32_16x16x32_bf16 v[188:191], v[172:175], v[96:99], v[188:191]
    ds_read_b64_tr_b16 v[162:163], v24 offset:10240
    v_mfma_f32_16x16x32_bf16 v[44:47], v[124:127], v[92:95], v[44:47]
    ds_read_b64_tr_b16 v[164:165], v25 offset:8192
    v_mfma_f32_16x16x32_bf16 v[76:79], v[124:127], v[96:99], v[76:79]
    ds_read_b64_tr_b16 v[166:167], v25 offset:10240
    v_mfma_f32_16x16x32_bf16 v[192:195], v[92:95], v[92:95], v[192:195]
    ds_read_b64_tr_b16 v[168:169], v26 offset:8192
    v_mfma_f32_16x16x32_bf16 v[48:51], v[128:131], v[92:95], v[48:51]
    ds_read_b64_tr_b16 v[170:171], v26 offset:10240
    v_mfma_f32_16x16x32_bf16 v[80:83], v[128:131], v[96:99], v[80:83]
    v_mfma_f32_16x16x32_bf16 v[196:199], v[96:99], v[96:99], v[196:199]
    v_mfma_f32_16x16x32_bf16 v[52:55], v[132:135], v[92:95], v[52:55]
    v_mfma_f32_16x16x32_bf16 v[84:87], v[132:135], v[96:99], v[84:87]
    v_mfma_f32_16x16x32_bf16 v[56:59], v[136:139], v[92:95], v[56:59]
    v_mfma_f32_16x16x32_bf16 v[88:91], v[136:139], v[96:99], v[88:91]
    s_waitcnt lgkmcnt(0)
    v_mfma_f32_16x16x32_bf16 v[28:31], v[140:143], v[100:103], v[28:31]
    v_mfma_f32_16x16x32_bf16 v[60:63], v[140:143], v[104:107], v[60:63]
    v_mfma_f32_16x16x32_bf16 v[176:179], v[140:143], v[172:175], v[176:179]
    v_mfma_f32_16x16x32_bf16 v[32:35], v[144:147], v[100:103], v[32:35]
    v_mfma_f32_16x16x32_bf16 v[64:67], v[144:147], v[104:107], v[64:67]
    v_mfma_f32_16x16x32_bf16 v[180:183], v[144:147], v[172:175], v[180:183]
    v_mfma_f32_16x16x32_bf16 v[36:39], v[148:151], v[100:103], v[36:39]
    v_mfma_f32_16x16x32_bf16 v[68:71], v[148:151], v[104:107], v[68:71]
    v_mfma_f32_16x16x32_bf16 v[184:187], v[172:175], v[100:103], v[184:187]
    v_mfma_f32_16x16x32_bf16 v[40:43], v[152:155], v[100:103], v[40:43]
    v_mfma_f32_16x16x32_bf16 v[72:75], v[152:155], v[104:107], v[72:75]
    v_mfma_f32_16x16x32_bf16 v[188:191], v[172:175], v[104:107], v[188:191]
    v_mfma_f32_16x16x32_bf16 v[44:47], v[156:159], v[100:103], v[44:47]
    v_mfma_f32_16x16x32_bf16 v[76:79], v[156:159], v[104:107], v[76:79]
    v_mfma_f32_16x16x32_bf16 v[192:195], v[100:103], v[100:103], v[192:195]
    v_mfma_f32_16x16x32_bf16 v[48:51], v[160:163], v[100:103], v[48:51]
    v_mfma_f32_16x16x32_bf16 v[80:83], v[160:163], v[104:107], v[80:83]
    v_mfma_f32_16x16x32_bf16 v[196:199], v[104:107], v[104:107], v[196:199]
    v_mfma_f32_16x16x32_bf16 v[52:55], v[164:167], v[100:103], v[52:55]
    v_mfma_f32_16x16x32_bf16 v[84:87], v[164:167], v[104:107], v[84:87]
    v_mfma_f32_16x16x32_bf16 v[56:59], v[168:171], v[100:103], v[56:59]
    v_mfma_f32_16x16x32_bf16 v[88:91], v[168:171], v[104:107], v[88:91]
    s_lshl_b32 s31, s46, 6
    v_lshl_add_u32 v3, v1, 4, s31
    v_add_u32 v3, 0x20000, v3
    ds_write_b128 v3, v[176:179]
    s_lshl_b32 s31, s47, 6
    v_lshl_add_u32 v3, v1, 4, s31
    v_add_u32 v3, 0x20000, v3
    ds_write_b128 v3, v[180:183]
    v_and_b32 v3, 3, v2
    v_lshrrev_b32 v4, 2, v2
    v_cmp_eq_u32 s[42:43], 1, v3
    v_cmp_eq_u32 s[44:45], 2, v3
    v_cmp_eq_u32 vcc, 3, v3
    v_cmp_eq_u32 s[58:59], v4, v1
    s_mov_b32 s32, 0x3acccccd
    v_mov_b32 v5, 0
    s_waitcnt lgkmcnt(0)
    s_barrier
    s_lshl_b32 s31, s46, 6
    v_lshl_add_u32 v3, v1, 4, s31
    v_add_u32 v3, 0x20000, v3
    ds_read_b128 v[208:211], v3
    s_lshl_b32 s31, s47, 6
    v_lshl_add_u32 v3, v1, 4, s31
    v_add_u32 v3, 0x20000, v3
    ds_read_b128 v[212:215], v3
    s_lshl_b32 s31, s48, 6
    v_lshl_add_u32 v3, v1, 4, s31
    v_add_u32 v3, 0x20000, v3
    ds_read_b128 v[216:219], v3
    s_lshl_b32 s31, s49, 6
    v_lshl_add_u32 v3, v1, 4, s31
    v_add_u32 v3, 0x20000, v3
    ds_read_b128 v[220:223], v3
    s_lshl_b32 s31, s50, 6
    v_lshl_add_u32 v3, v1, 4, s31
    v_add_u32 v3, 0x20000, v3
    ds_read_b128 v[224:227], v3
    s_lshl_b32 s31, s51, 6
    v_lshl_add_u32 v3, v1, 4, s31
    v_add_u32 v3, 0x20000, v3
    ds_read_b128 v[228:231], v3
    s_lshl_b32 s31, s52, 6
    v_lshl_add_u32 v3, v1, 4, s31
    v_add_u32 v3, 0x20000, v3
    ds_read_b128 v[232:235], v3
    s_lshl_b32 s31, s53, 6
    v_lshl_add_u32 v3, v1, 4, s31
    v_add_u32 v3, 0x20000, v3
    ds_read_b128 v[236:239], v3
    v_cndmask_b32 v112, v192, v193, s[42:43]
    v_cndmask_b32 v112, v112, v194, s[44:45]
    v_cndmask_b32 v112, v112, v195, vcc
    v_cndmask_b32 v112, v5, v112, s[58:59]
    v_mov_b32 v108, v112
    s_nop 1
    v_permlane32_swap_b32 v112, v108
    v_add_f32 v112, v112, v108
    v_mov_b32 v108, v112
    s_nop 1
    v_permlane16_swap_b32 v112, v108
    v_add_f32 v112, v112, v108
    v_mul_f32 v108, s32, v184
    v_mul_f32 v112, s32, v112
    v_fma_f32 v112, -v108, v108, v112
    v_max_f32 v112, 0, v112
    v_cvt_pk_bf16_f32 v200, v108, v108
    v_lshlrev_b32 v200, 16, v200
    v_xor_b32 v200, 0x80000000, v200
    v_cvt_pk_bf16_f32 v112, v112, v112
    v_lshlrev_b32 v112, 16, v112
    v_add_f32 v112, 0x3727c5ac, v112
    v_cvt_pk_bf16_f32 v112, v112, v112
    v_lshlrev_b32 v112, 16, v112
    v_sqrt_f32 v112, v112
    s_nop 0
    v_cvt_pk_bf16_f32 v112, v112, v112
    v_lshlrev_b32 v112, 16, v112
    v_rcp_f32 v204, v112
    v_cndmask_b32 v112, v196, v197, s[42:43]
    v_cndmask_b32 v112, v112, v198, s[44:45]
    v_cndmask_b32 v112, v112, v199, vcc
    v_cndmask_b32 v112, v5, v112, s[58:59]
    v_mov_b32 v108, v112
    s_nop 1
    v_permlane32_swap_b32 v112, v108
    v_add_f32 v112, v112, v108
    v_mov_b32 v108, v112
    s_nop 1
    v_permlane16_swap_b32 v112, v108
    v_add_f32 v112, v112, v108
    v_mul_f32 v108, s32, v188
    v_mul_f32 v112, s32, v112
    v_fma_f32 v112, -v108, v108, v112
    v_max_f32 v112, 0, v112
    v_cvt_pk_bf16_f32 v202, v108, v108
    v_lshlrev_b32 v202, 16, v202
    v_xor_b32 v202, 0x80000000, v202
    v_cvt_pk_bf16_f32 v112, v112, v112
    v_lshlrev_b32 v112, 16, v112
    v_add_f32 v112, 0x3727c5ac, v112
    v_cvt_pk_bf16_f32 v112, v112, v112
    v_lshlrev_b32 v112, 16, v112
    v_sqrt_f32 v112, v112
    s_nop 0
    v_cvt_pk_bf16_f32 v112, v112, v112
    v_lshlrev_b32 v112, 16, v112
    v_rcp_f32 v206, v112
    s_waitcnt lgkmcnt(0)
    s_mul_i32 s33, s30, 9216
    s_add_u32 s33, s33, 0x10000
    v_mul_u32_u24 v240, 288, v1
    v_lshl_add_u32 v240, v2, 3, v240
    v_add_u32 v240, s33, v240
    s_mul_i32 s31, s46, 1152
    v_add_u32 v11, s31, v240
    s_mul_i32 s31, s47, 1152
    v_add_u32 v12, s31, v240
    s_mul_i32 s31, s48, 1152
    v_add_u32 v13, s31, v240
    s_mul_i32 s31, s49, 1152
    v_add_u32 v14, s31, v240
    s_mul_i32 s31, s50, 1152
    v_add_u32 v15, s31, v240
    s_mul_i32 s31, s51, 1152
    v_add_u32 v16, s31, v240
    s_mul_i32 s31, s52, 1152
    v_add_u32 v17, s31, v240
    s_mul_i32 s31, s53, 1152
    v_add_u32 v18, s31, v240
    v_pk_fma_f32 v[28:29], v[208:209], v[200:201], v[28:29] op_sel_hi:[1,0,1]
    v_pk_fma_f32 v[30:31], v[210:211], v[200:201], v[30:31] op_sel_hi:[1,0,1]
    v_pk_mul_f32 v[28:29], v[28:29], v[204:205] op_sel_hi:[1,0]
    v_pk_mul_f32 v[30:31], v[30:31], v[204:205] op_sel_hi:[1,0]
    v_cvt_pk_bf16_f32 v28, v28, v29
    v_cvt_pk_bf16_f32 v29, v30, v31
    ds_write_b64 v11, v[28:29] offset:0
    v_pk_fma_f32 v[60:61], v[208:209], v[202:203], v[60:61] op_sel_hi:[1,0,1]
    v_pk_fma_f32 v[62:63], v[210:211], v[202:203], v[62:63] op_sel_hi:[1,0,1]
    v_pk_mul_f32 v[60:61], v[60:61], v[206:207] op_sel_hi:[1,0]
    v_pk_mul_f32 v[62:63], v[62:63], v[206:207] op_sel_hi:[1,0]
    v_cvt_pk_bf16_f32 v60, v60, v61
    v_cvt_pk_bf16_f32 v61, v62, v63
    ds_write_b64 v11, v[60:61] offset:128
    v_pk_fma_f32 v[32:33], v[212:213], v[200:201], v[32:33] op_sel_hi:[1,0,1]
    v_pk_fma_f32 v[34:35], v[214:215], v[200:201], v[34:35] op_sel_hi:[1,0,1]
    v_pk_mul_f32 v[32:33], v[32:33], v[204:205] op_sel_hi:[1,0]
    v_pk_mul_f32 v[34:35], v[34:35], v[204:205] op_sel_hi:[1,0]
    v_cvt_pk_bf16_f32 v32, v32, v33
    v_cvt_pk_bf16_f32 v33, v34, v35
    ds_write_b64 v12, v[32:33] offset:0
    v_pk_fma_f32 v[64:65], v[212:213], v[202:203], v[64:65] op_sel_hi:[1,0,1]
    v_pk_fma_f32 v[66:67], v[214:215], v[202:203], v[66:67] op_sel_hi:[1,0,1]
    v_pk_mul_f32 v[64:65], v[64:65], v[206:207] op_sel_hi:[1,0]
    v_pk_mul_f32 v[66:67], v[66:67], v[206:207] op_sel_hi:[1,0]
    v_cvt_pk_bf16_f32 v64, v64, v65
    v_cvt_pk_bf16_f32 v65, v66, v67
    ds_write_b64 v12, v[64:65] offset:128
    v_pk_fma_f32 v[36:37], v[216:217], v[200:201], v[36:37] op_sel_hi:[1,0,1]
    v_pk_fma_f32 v[38:39], v[218:219], v[200:201], v[38:39] op_sel_hi:[1,0,1]
    v_pk_mul_f32 v[36:37], v[36:37], v[204:205] op_sel_hi:[1,0]
    v_pk_mul_f32 v[38:39], v[38:39], v[204:205] op_sel_hi:[1,0]
    v_cvt_pk_bf16_f32 v36, v36, v37
    v_cvt_pk_bf16_f32 v37, v38, v39
    ds_write_b64 v13, v[36:37] offset:0
    v_pk_fma_f32 v[68:69], v[216:217], v[202:203], v[68:69] op_sel_hi:[1,0,1]
    v_pk_fma_f32 v[70:71], v[218:219], v[202:203], v[70:71] op_sel_hi:[1,0,1]
    v_pk_mul_f32 v[68:69], v[68:69], v[206:207] op_sel_hi:[1,0]
    v_pk_mul_f32 v[70:71], v[70:71], v[206:207] op_sel_hi:[1,0]
    v_cvt_pk_bf16_f32 v68, v68, v69
    v_cvt_pk_bf16_f32 v69, v70, v71
    ds_write_b64 v13, v[68:69] offset:128
    v_pk_fma_f32 v[40:41], v[220:221], v[200:201], v[40:41] op_sel_hi:[1,0,1]
    v_pk_fma_f32 v[42:43], v[222:223], v[200:201], v[42:43] op_sel_hi:[1,0,1]
    v_pk_mul_f32 v[40:41], v[40:41], v[204:205] op_sel_hi:[1,0]
    v_pk_mul_f32 v[42:43], v[42:43], v[204:205] op_sel_hi:[1,0]
    v_cvt_pk_bf16_f32 v40, v40, v41
    v_cvt_pk_bf16_f32 v41, v42, v43
    ds_write_b64 v14, v[40:41] offset:0
    v_pk_fma_f32 v[72:73], v[220:221], v[202:203], v[72:73] op_sel_hi:[1,0,1]
    v_pk_fma_f32 v[74:75], v[222:223], v[202:203], v[74:75] op_sel_hi:[1,0,1]
    v_pk_mul_f32 v[72:73], v[72:73], v[206:207] op_sel_hi:[1,0]
    v_pk_mul_f32 v[74:75], v[74:75], v[206:207] op_sel_hi:[1,0]
    v_cvt_pk_bf16_f32 v72, v72, v73
    v_cvt_pk_bf16_f32 v73, v74, v75
    ds_write_b64 v14, v[72:73] offset:128
    v_pk_fma_f32 v[44:45], v[224:225], v[200:201], v[44:45] op_sel_hi:[1,0,1]
    v_pk_fma_f32 v[46:47], v[226:227], v[200:201], v[46:47] op_sel_hi:[1,0,1]
    v_pk_mul_f32 v[44:45], v[44:45], v[204:205] op_sel_hi:[1,0]
    v_pk_mul_f32 v[46:47], v[46:47], v[204:205] op_sel_hi:[1,0]
    v_cvt_pk_bf16_f32 v44, v44, v45
    v_cvt_pk_bf16_f32 v45, v46, v47
    ds_write_b64 v15, v[44:45] offset:0
    v_pk_fma_f32 v[76:77], v[224:225], v[202:203], v[76:77] op_sel_hi:[1,0,1]
    v_pk_fma_f32 v[78:79], v[226:227], v[202:203], v[78:79] op_sel_hi:[1,0,1]
    v_pk_mul_f32 v[76:77], v[76:77], v[206:207] op_sel_hi:[1,0]
    v_pk_mul_f32 v[78:79], v[78:79], v[206:207] op_sel_hi:[1,0]
    v_cvt_pk_bf16_f32 v76, v76, v77
    v_cvt_pk_bf16_f32 v77, v78, v79
    ds_write_b64 v15, v[76:77] offset:128
    v_pk_fma_f32 v[48:49], v[228:229], v[200:201], v[48:49] op_sel_hi:[1,0,1]
    v_pk_fma_f32 v[50:51], v[230:231], v[200:201], v[50:51] op_sel_hi:[1,0,1]
    v_pk_mul_f32 v[48:49], v[48:49], v[204:205] op_sel_hi:[1,0]
    v_pk_mul_f32 v[50:51], v[50:51], v[204:205] op_sel_hi:[1,0]
    v_cvt_pk_bf16_f32 v48, v48, v49
    v_cvt_pk_bf16_f32 v49, v50, v51
    ds_write_b64 v16, v[48:49] offset:0
    v_pk_fma_f32 v[80:81], v[228:229], v[202:203], v[80:81] op_sel_hi:[1,0,1]
    v_pk_fma_f32 v[82:83], v[230:231], v[202:203], v[82:83] op_sel_hi:[1,0,1]
    v_pk_mul_f32 v[80:81], v[80:81], v[206:207] op_sel_hi:[1,0]
    v_pk_mul_f32 v[82:83], v[82:83], v[206:207] op_sel_hi:[1,0]
    v_cvt_pk_bf16_f32 v80, v80, v81
    v_cvt_pk_bf16_f32 v81, v82, v83
    ds_write_b64 v16, v[80:81] offset:128
    v_pk_fma_f32 v[52:53], v[232:233], v[200:201], v[52:53] op_sel_hi:[1,0,1]
    v_pk_fma_f32 v[54:55], v[234:235], v[200:201], v[54:55] op_sel_hi:[1,0,1]
    v_pk_mul_f32 v[52:53], v[52:53], v[204:205] op_sel_hi:[1,0]
    v_pk_mul_f32 v[54:55], v[54:55], v[204:205] op_sel_hi:[1,0]
    v_cvt_pk_bf16_f32 v52, v52, v53
    v_cvt_pk_bf16_f32 v53, v54, v55
    ds_write_b64 v17, v[52:53] offset:0
    v_pk_fma_f32 v[84:85], v[232:233], v[202:203], v[84:85] op_sel_hi:[1,0,1]
    v_pk_fma_f32 v[86:87], v[234:235], v[202:203], v[86:87] op_sel_hi:[1,0,1]
    v_pk_mul_f32 v[84:85], v[84:85], v[206:207] op_sel_hi:[1,0]
    v_pk_mul_f32 v[86:87], v[86:87], v[206:207] op_sel_hi:[1,0]
    v_cvt_pk_bf16_f32 v84, v84, v85
    v_cvt_pk_bf16_f32 v85, v86, v87
    ds_write_b64 v17, v[84:85] offset:128
    v_pk_fma_f32 v[56:57], v[236:237], v[200:201], v[56:57] op_sel_hi:[1,0,1]
    v_pk_fma_f32 v[58:59], v[238:239], v[200:201], v[58:59] op_sel_hi:[1,0,1]
    v_pk_mul_f32 v[56:57], v[56:57], v[204:205] op_sel_hi:[1,0]
    v_pk_mul_f32 v[58:59], v[58:59], v[204:205] op_sel_hi:[1,0]
    v_cvt_pk_bf16_f32 v56, v56, v57
    v_cvt_pk_bf16_f32 v57, v58, v59
    ds_write_b64 v18, v[56:57] offset:0
    v_pk_fma_f32 v[88:89], v[236:237], v[202:203], v[88:89] op_sel_hi:[1,0,1]
    v_pk_fma_f32 v[90:91], v[238:239], v[202:203], v[90:91] op_sel_hi:[1,0,1]
    v_pk_mul_f32 v[88:89], v[88:89], v[206:207] op_sel_hi:[1,0]
    v_pk_mul_f32 v[90:91], v[90:91], v[206:207] op_sel_hi:[1,0]
    v_cvt_pk_bf16_f32 v88, v88, v89
    v_cvt_pk_bf16_f32 v89, v90, v91
    ds_write_b64 v18, v[88:89] offset:128
    v_mul_u32_u24 v241, 288, v1
    v_lshl_add_u32 v241, v2, 4, v241
    v_add_u32 v241, s33, v241
    s_lshl_b32 s31, s30, 5
    s_add_u32 s31, s31, s40
    s_lshl_b32 s31, s31, 3
    s_lshl_b32 s32, s29, 19
    s_add_u32 s31, s31, s32
    v_lshlrev_b32 v242, 14, v1
    v_lshl_add_u32 v242, v2, 4, v242
    v_add_u32 v242, s31, v242
    s_waitcnt lgkmcnt(0)
    ds_read_b128 v[92:95], v241 offset:0
    ds_read_b128 v[96:99], v241 offset:1152
    ds_read_b128 v[100:103], v241 offset:2304
    ds_read_b128 v[104:107], v241 offset:3456
    ds_read_b128 v[140:143], v241 offset:4608
    ds_read_b128 v[144:147], v241 offset:5760
    ds_read_b128 v[148:151], v241 offset:6912
    ds_read_b128 v[152:155], v241 offset:8064
    s_mov_b32 s31, 0
    s_waitcnt lgkmcnt(7)
    buffer_store_dwordx4 v[92:95], v242, s[12:15], s31 offen sc1
    s_mov_b32 s31, 65536
    s_waitcnt lgkmcnt(6)
    buffer_store_dwordx4 v[96:99], v242, s[12:15], s31 offen sc1
    s_mov_b32 s31, 131072
    s_waitcnt lgkmcnt(5)
    buffer_store_dwordx4 v[100:103], v242, s[12:15], s31 offen sc1
    s_mov_b32 s31, 196608
    s_waitcnt lgkmcnt(4)
    buffer_store_dwordx4 v[104:107], v242, s[12:15], s31 offen sc1
    s_mov_b32 s31, 262144
    s_waitcnt lgkmcnt(3)
    buffer_store_dwordx4 v[140:143], v242, s[12:15], s31 offen sc1
    s_mov_b32 s31, 327680
    s_waitcnt lgkmcnt(2)
    buffer_store_dwordx4 v[144:147], v242, s[12:15], s31 offen sc1
    s_mov_b32 s31, 393216
    s_waitcnt lgkmcnt(1)
    buffer_store_dwordx4 v[148:151], v242, s[12:15], s31 offen sc1
    s_mov_b32 s31, 458752
    s_waitcnt lgkmcnt(0)
    buffer_store_dwordx4 v[152:155], v242, s[12:15], s31 offen sc1
    s_waitcnt vmcnt(0)
    s_barrier
    s_cmp_lg_u32 s80, 0
    s_cbranch_scc1 qkv_kernel_sig
    s_waitcnt vmcnt(0)
    v_readfirstlane_b32 s81, v248
    s_nop 0
    s_cmp_eq_u32 s81, 0
    s_cselect_b32 s81, s82, s81
    s_lshl_b32 s31, s28, 4
    s_add_u32 s31, s31, s29
    s_lshl_b32 s31, s31, 3
    s_add_u32 s31, s31, 0
    v_mov_b32 v3, s31
    v_mov_b32 v244, s81
    v_not_b32 v245, v244
    s_mov_b64 exec, 1
    buffer_store_dwordx2 v[244:245], v3, s[84:87], 0 offen sc1
    s_mov_b64 exec, -1
qkv_kernel_sig:
    s_branch qkv_kernel_end
qkv_kernel_loader:
    s_setprio 1
    s_sub_u32 s30, s30, 4
    v_lshrrev_b32 v5, 3, v0
    v_and_b32 v6, 7, v0
    s_mul_i32 s31, s30, 32
    s_add_u32 s32, s31, 0
    v_add_u32 v1, s32, v5
    v_bfe_u32 v2, v1, 1, 3
    v_xor_b32 v2, v2, v6
    v_add_u32 v1, s40, v1
    v_mul_u32_u24 v1, 1280, v1
    v_lshl_add_u32 v7, v2, 4, v1
    s_add_u32 s32, s31, 8
    v_add_u32 v1, s32, v5
    v_bfe_u32 v2, v1, 1, 3
    v_xor_b32 v2, v2, v6
    v_add_u32 v1, s40, v1
    v_mul_u32_u24 v1, 1280, v1
    v_lshl_add_u32 v8, v2, 4, v1
    s_add_u32 s32, s31, 16
    v_add_u32 v1, s32, v5
    v_bfe_u32 v2, v1, 1, 3
    v_xor_b32 v2, v2, v6
    v_add_u32 v1, s40, v1
    v_mul_u32_u24 v1, 1280, v1
    v_lshl_add_u32 v9, v2, 4, v1
    s_add_u32 s32, s31, 24
    v_add_u32 v1, s32, v5
    v_bfe_u32 v2, v1, 1, 3
    v_xor_b32 v2, v2, v6
    v_add_u32 v1, s40, v1
    v_mul_u32_u24 v1, 1280, v1
    v_lshl_add_u32 v10, v2, 4, v1
    s_lshl_b32 s31, s30, 4
    s_lshl_b32 s32, s41, 1
    v_add_u32 v1, 0, v0
    v_lshrrev_b32 v2, 4, v1
    v_and_b32 v1, 15, v1
    v_and_b32 v3, 7, v2
    v_lshlrev_b32 v3, 1, v3
    v_xor_b32 v1, v1, v3
    v_and_b32 v3, 3, v2
    v_bfe_u32 v4, v2, 3, 1
    v_lshl_add_u32 v3, v4, 2, v3
    v_bfe_u32 v4, v2, 2, 1
    v_lshl_add_u32 v3, v4, 3, v3
    v_add_u32 v3, s31, v3
    v_mul_u32_u24 v3, 3840, v3
    v_lshl_add_u32 v3, v1, 4, v3
    v_add_u32 v19, s32, v3
    v_add_u32 v1, 64, v0
    v_lshrrev_b32 v2, 4, v1
    v_and_b32 v1, 15, v1
    v_and_b32 v3, 7, v2
    v_lshlrev_b32 v3, 1, v3
    v_xor_b32 v1, v1, v3
    v_and_b32 v3, 3, v2
    v_bfe_u32 v4, v2, 3, 1
    v_lshl_add_u32 v3, v4, 2, v3
    v_bfe_u32 v4, v2, 2, 1
    v_lshl_add_u32 v3, v4, 3, v3
    v_add_u32 v3, s31, v3
    v_mul_u32_u24 v3, 3840, v3
    v_lshl_add_u32 v3, v1, 4, v3
    v_add_u32 v20, s32, v3
    v_add_u32 v1, 128, v0
    v_lshrrev_b32 v2, 4, v1
    v_and_b32 v1, 15, v1
    v_and_b32 v3, 7, v2
    v_lshlrev_b32 v3, 1, v3
    v_xor_b32 v1, v1, v3
    v_and_b32 v3, 3, v2
    v_bfe_u32 v4, v2, 3, 1
    v_lshl_add_u32 v3, v4, 2, v3
    v_bfe_u32 v4, v2, 2, 1
    v_lshl_add_u32 v3, v4, 3, v3
    v_add_u32 v3, s31, v3
    v_mul_u32_u24 v3, 3840, v3
    v_lshl_add_u32 v3, v1, 4, v3
    v_add_u32 v21, s32, v3
    v_add_u32 v1, 192, v0
    v_lshrrev_b32 v2, 4, v1
    v_and_b32 v1, 15, v1
    v_and_b32 v3, 7, v2
    v_lshlrev_b32 v3, 1, v3
    v_xor_b32 v1, v1, v3
    v_and_b32 v3, 3, v2
    v_bfe_u32 v4, v2, 3, 1
    v_lshl_add_u32 v3, v4, 2, v3
    v_bfe_u32 v4, v2, 2, 1
    v_lshl_add_u32 v3, v4, 3, v3
    v_add_u32 v3, s31, v3
    v_mul_u32_u24 v3, 3840, v3
    v_lshl_add_u32 v3, v1, 4, v3
    v_add_u32 v22, s32, v3
    s_mul_i32 s35, s30, 4096
    s_mul_i32 s36, s30, 4096
    s_mul_i32 s54, s54, 0
    s_mul_i32 s55, s55, 0
    s_add_u32 s37, s54, s55
    s_lshl_b32 s33, s37, 7
    s_mul_i32 s34, s37, 245760
    s_waitcnt lgkmcnt(0)
    s_mov_b32 s4, s64
    s_and_b32 s5, s65, 0xffff
    s_mov_b32 s6, 0x280000
    s_mov_b32 s7, 0x20000
    s_mov_b32 s8, s66
    s_and_b32 s9, s67, 0xffff
    s_mov_b32 s10, 0x258000
    s_mov_b32 s11, 0x20000
    s_add_u32 m0, s36, 0x4000
    s_nop 0
    buffer_load_dwordx4 v19, s[8:11], s34 offen lds
    s_add_u32 m0, s36, 0x4400
    s_nop 0
    buffer_load_dwordx4 v20, s[8:11], s34 offen lds
    s_add_u32 m0, s36, 0x4800
    s_nop 0
    buffer_load_dwordx4 v21, s[8:11], s34 offen lds
    s_add_u32 m0, s36, 0x4c00
    s_nop 0
    buffer_load_dwordx4 v22, s[8:11], s34 offen lds
    s_add_u32 s34, s34, 245760
    s_cmp_eq_u32 s34, 2457600
    s_cselect_b32 s34, 0, s34
    s_add_u32 m0, s35, 0x0
    s_nop 0
    buffer_load_dwordx4 v7, s[4:7], s33 offen lds
    s_add_u32 m0, s35, 0x400
    s_nop 0
    buffer_load_dwordx4 v8, s[4:7], s33 offen lds
    s_add_u32 m0, s35, 0x800
    s_nop 0
    buffer_load_dwordx4 v9, s[4:7], s33 offen lds
    s_add_u32 m0, s35, 0xc00
    s_nop 0
    buffer_load_dwordx4 v10, s[4:7], s33 offen lds
    s_add_u32 s33, s33, 128
    s_cmp_eq_u32 s33, 1280
    s_cselect_b32 s33, 0, s33
    s_add_u32 m0, s36, 0xc000
    s_nop 0
    buffer_load_dwordx4 v19, s[8:11], s34 offen lds
    s_add_u32 m0, s36, 0xc400
    s_nop 0
    buffer_load_dwordx4 v20, s[8:11], s34 offen lds
    s_add_u32 m0, s36, 0xc800
    s_nop 0
    buffer_load_dwordx4 v21, s[8:11], s34 offen lds
    s_add_u32 m0, s36, 0xcc00
    s_nop 0
    buffer_load_dwordx4 v22, s[8:11], s34 offen lds
    s_add_u32 s34, s34, 245760
    s_cmp_eq_u32 s34, 2457600
    s_cselect_b32 s34, 0, s34
    s_add_u32 m0, s35, 0x8000
    s_nop 0
    buffer_load_dwordx4 v7, s[4:7], s33 offen lds
    s_add_u32 m0, s35, 0x8400
    s_nop 0
    buffer_load_dwordx4 v8, s[4:7], s33 offen lds
    s_add_u32 m0, s35, 0x8800
    s_nop 0
    buffer_load_dwordx4 v9, s[4:7], s33 offen lds
    s_add_u32 m0, s35, 0x8c00
    s_nop 0
    buffer_load_dwordx4 v10, s[4:7], s33 offen lds
    s_add_u32 s33, s33, 128
    s_cmp_eq_u32 s33, 1280
    s_cselect_b32 s33, 0, s33
    s_add_u32 m0, s36, 0x14000
    s_nop 0
    buffer_load_dwordx4 v19, s[8:11], s34 offen lds
    s_add_u32 m0, s36, 0x14400
    s_nop 0
    buffer_load_dwordx4 v20, s[8:11], s34 offen lds
    s_add_u32 m0, s36, 0x14800
    s_nop 0
    buffer_load_dwordx4 v21, s[8:11], s34 offen lds
    s_add_u32 m0, s36, 0x14c00
    s_nop 0
    buffer_load_dwordx4 v22, s[8:11], s34 offen lds
    s_add_u32 s34, s34, 245760
    s_cmp_eq_u32 s34, 2457600
    s_cselect_b32 s34, 0, s34
    s_add_u32 m0, s35, 0x10000
    s_nop 0
    buffer_load_dwordx4 v7, s[4:7], s33 offen lds
    s_add_u32 m0, s35, 0x10400
    s_nop 0
    buffer_load_dwordx4 v8, s[4:7], s33 offen lds
    s_add_u32 m0, s35, 0x10800
    s_nop 0
    buffer_load_dwordx4 v9, s[4:7], s33 offen lds
    s_add_u32 m0, s35, 0x10c00
    s_nop 0
    buffer_load_dwordx4 v10, s[4:7], s33 offen lds
    s_add_u32 s33, s33, 128
    s_cmp_eq_u32 s33, 1280
    s_cselect_b32 s33, 0, s33
    s_waitcnt vmcnt(16)
    s_barrier
    s_add_u32 m0, s36, 0x1c000
    s_nop 0
    buffer_load_dwordx4 v19, s[8:11], s34 offen lds
    s_add_u32 m0, s36, 0x1c400
    s_nop 0
    buffer_load_dwordx4 v20, s[8:11], s34 offen lds
    s_add_u32 m0, s36, 0x1c800
    s_nop 0
    buffer_load_dwordx4 v21, s[8:11], s34 offen lds
    s_add_u32 m0, s36, 0x1cc00
    s_nop 0
    buffer_load_dwordx4 v22, s[8:11], s34 offen lds
    s_add_u32 s34, s34, 245760
    s_cmp_eq_u32 s34, 2457600
    s_cselect_b32 s34, 0, s34
    s_add_u32 m0, s35, 0x18000
    s_nop 0
    buffer_load_dwordx4 v7, s[4:7], s33 offen lds
    s_add_u32 m0, s35, 0x18400
    s_nop 0
    buffer_load_dwordx4 v8, s[4:7], s33 offen lds
    s_add_u32 m0, s35, 0x18800
    s_nop 0
    buffer_load_dwordx4 v9, s[4:7], s33 offen lds
    s_add_u32 m0, s35, 0x18c00
    s_nop 0
    buffer_load_dwordx4 v10, s[4:7], s33 offen lds
    s_add_u32 s33, s33, 128
    s_cmp_eq_u32 s33, 1280
    s_cselect_b32 s33, 0, s33
    s_waitcnt vmcnt(16)
    s_barrier
    s_add_u32 m0, s36, 0x4000
    s_nop 0
    buffer_load_dwordx4 v19, s[8:11], s34 offen lds
    s_add_u32 m0, s36, 0x4400
    s_nop 0
    buffer_load_dwordx4 v20, s[8:11], s34 offen lds
    s_add_u32 m0, s36, 0x4800
    s_nop 0
    buffer_load_dwordx4 v21, s[8:11], s34 offen lds
    s_add_u32 m0, s36, 0x4c00
    s_nop 0
    buffer_load_dwordx4 v22, s[8:11], s34 offen lds
    s_add_u32 s34, s34, 245760
    s_cmp_eq_u32 s34, 2457600
    s_cselect_b32 s34, 0, s34
    s_add_u32 m0, s35, 0x0
    s_nop 0
    buffer_load_dwordx4 v7, s[4:7], s33 offen lds
    s_add_u32 m0, s35, 0x400
    s_nop 0
    buffer_load_dwordx4 v8, s[4:7], s33 offen lds
    s_add_u32 m0, s35, 0x800
    s_nop 0
    buffer_load_dwordx4 v9, s[4:7], s33 offen lds
    s_add_u32 m0, s35, 0xc00
    s_nop 0
    buffer_load_dwordx4 v10, s[4:7], s33 offen lds
    s_add_u32 s33, s33, 128
    s_cmp_eq_u32 s33, 1280
    s_cselect_b32 s33, 0, s33
    s_waitcnt vmcnt(16)
    s_barrier
    s_add_u32 m0, s36, 0xc000
    s_nop 0
    buffer_load_dwordx4 v19, s[8:11], s34 offen lds
    s_add_u32 m0, s36, 0xc400
    s_nop 0
    buffer_load_dwordx4 v20, s[8:11], s34 offen lds
    s_add_u32 m0, s36, 0xc800
    s_nop 0
    buffer_load_dwordx4 v21, s[8:11], s34 offen lds
    s_add_u32 m0, s36, 0xcc00
    s_nop 0
    buffer_load_dwordx4 v22, s[8:11], s34 offen lds
    s_add_u32 s34, s34, 245760
    s_cmp_eq_u32 s34, 2457600
    s_cselect_b32 s34, 0, s34
    s_add_u32 m0, s35, 0x8000
    s_nop 0
    buffer_load_dwordx4 v7, s[4:7], s33 offen lds
    s_add_u32 m0, s35, 0x8400
    s_nop 0
    buffer_load_dwordx4 v8, s[4:7], s33 offen lds
    s_add_u32 m0, s35, 0x8800
    s_nop 0
    buffer_load_dwordx4 v9, s[4:7], s33 offen lds
    s_add_u32 m0, s35, 0x8c00
    s_nop 0
    buffer_load_dwordx4 v10, s[4:7], s33 offen lds
    s_add_u32 s33, s33, 128
    s_cmp_eq_u32 s33, 1280
    s_cselect_b32 s33, 0, s33
    s_waitcnt vmcnt(16)
    s_barrier
    s_add_u32 m0, s36, 0x14000
    s_nop 0
    buffer_load_dwordx4 v19, s[8:11], s34 offen lds
    s_add_u32 m0, s36, 0x14400
    s_nop 0
    buffer_load_dwordx4 v20, s[8:11], s34 offen lds
    s_add_u32 m0, s36, 0x14800
    s_nop 0
    buffer_load_dwordx4 v21, s[8:11], s34 offen lds
    s_add_u32 m0, s36, 0x14c00
    s_nop 0
    buffer_load_dwordx4 v22, s[8:11], s34 offen lds
    s_add_u32 s34, s34, 245760
    s_cmp_eq_u32 s34, 2457600
    s_cselect_b32 s34, 0, s34
    s_add_u32 m0, s35, 0x10000
    s_nop 0
    buffer_load_dwordx4 v7, s[4:7], s33 offen lds
    s_add_u32 m0, s35, 0x10400
    s_nop 0
    buffer_load_dwordx4 v8, s[4:7], s33 offen lds
    s_add_u32 m0, s35, 0x10800
    s_nop 0
    buffer_load_dwordx4 v9, s[4:7], s33 offen lds
    s_add_u32 m0, s35, 0x10c00
    s_nop 0
    buffer_load_dwordx4 v10, s[4:7], s33 offen lds
    s_add_u32 s33, s33, 128
    s_cmp_eq_u32 s33, 1280
    s_cselect_b32 s33, 0, s33
    s_waitcnt vmcnt(16)
    s_barrier
    s_add_u32 m0, s36, 0x1c000
    s_nop 0
    buffer_load_dwordx4 v19, s[8:11], s34 offen lds
    s_add_u32 m0, s36, 0x1c400
    s_nop 0
    buffer_load_dwordx4 v20, s[8:11], s34 offen lds
    s_add_u32 m0, s36, 0x1c800
    s_nop 0
    buffer_load_dwordx4 v21, s[8:11], s34 offen lds
    s_add_u32 m0, s36, 0x1cc00
    s_nop 0
    buffer_load_dwordx4 v22, s[8:11], s34 offen lds
    s_add_u32 s34, s34, 245760
    s_cmp_eq_u32 s34, 2457600
    s_cselect_b32 s34, 0, s34
    s_add_u32 m0, s35, 0x18000
    s_nop 0
    buffer_load_dwordx4 v7, s[4:7], s33 offen lds
    s_add_u32 m0, s35, 0x18400
    s_nop 0
    buffer_load_dwordx4 v8, s[4:7], s33 offen lds
    s_add_u32 m0, s35, 0x18800
    s_nop 0
    buffer_load_dwordx4 v9, s[4:7], s33 offen lds
    s_add_u32 m0, s35, 0x18c00
    s_nop 0
    buffer_load_dwordx4 v10, s[4:7], s33 offen lds
    s_add_u32 s33, s33, 128
    s_cmp_eq_u32 s33, 1280
    s_cselect_b32 s33, 0, s33
    s_waitcnt vmcnt(16)
    s_barrier
    s_add_u32 m0, s36, 0x4000
    s_nop 0
    buffer_load_dwordx4 v19, s[8:11], s34 offen lds
    s_add_u32 m0, s36, 0x4400
    s_nop 0
    buffer_load_dwordx4 v20, s[8:11], s34 offen lds
    s_add_u32 m0, s36, 0x4800
    s_nop 0
    buffer_load_dwordx4 v21, s[8:11], s34 offen lds
    s_add_u32 m0, s36, 0x4c00
    s_nop 0
    buffer_load_dwordx4 v22, s[8:11], s34 offen lds
    s_add_u32 s34, s34, 245760
    s_cmp_eq_u32 s34, 2457600
    s_cselect_b32 s34, 0, s34
    s_add_u32 m0, s35, 0x0
    s_nop 0
    buffer_load_dwordx4 v7, s[4:7], s33 offen lds
    s_add_u32 m0, s35, 0x400
    s_nop 0
    buffer_load_dwordx4 v8, s[4:7], s33 offen lds
    s_add_u32 m0, s35, 0x800
    s_nop 0
    buffer_load_dwordx4 v9, s[4:7], s33 offen lds
    s_add_u32 m0, s35, 0xc00
    s_nop 0
    buffer_load_dwordx4 v10, s[4:7], s33 offen lds
    s_add_u32 s33, s33, 128
    s_cmp_eq_u32 s33, 1280
    s_cselect_b32 s33, 0, s33
    s_waitcnt vmcnt(16)
    s_barrier
    s_add_u32 m0, s36, 0xc000
    s_nop 0
    buffer_load_dwordx4 v19, s[8:11], s34 offen lds
    s_add_u32 m0, s36, 0xc400
    s_nop 0
    buffer_load_dwordx4 v20, s[8:11], s34 offen lds
    s_add_u32 m0, s36, 0xc800
    s_nop 0
    buffer_load_dwordx4 v21, s[8:11], s34 offen lds
    s_add_u32 m0, s36, 0xcc00
    s_nop 0
    buffer_load_dwordx4 v22, s[8:11], s34 offen lds
    s_add_u32 s34, s34, 245760
    s_cmp_eq_u32 s34, 2457600
    s_cselect_b32 s34, 0, s34
    s_add_u32 m0, s35, 0x8000
    s_nop 0
    buffer_load_dwordx4 v7, s[4:7], s33 offen lds
    s_add_u32 m0, s35, 0x8400
    s_nop 0
    buffer_load_dwordx4 v8, s[4:7], s33 offen lds
    s_add_u32 m0, s35, 0x8800
    s_nop 0
    buffer_load_dwordx4 v9, s[4:7], s33 offen lds
    s_add_u32 m0, s35, 0x8c00
    s_nop 0
    buffer_load_dwordx4 v10, s[4:7], s33 offen lds
    s_add_u32 s33, s33, 128
    s_cmp_eq_u32 s33, 1280
    s_cselect_b32 s33, 0, s33
    v_lshl_add_u32 v23, s30, 6, v0
    s_lshr_b32 s31, s2, 3
    s_mul_i32 s31, s31, 100
    s_add_u32 s32, s31, 100
    s_min_u32 s32, s32, 3200
    s_and_b32 s54, s2, 1
    s_mul_i32 s54, s54, 640
    s_mov_b32 s12, s68
    s_and_b32 s13, s69, 0xffff
    s_mov_b32 s14, 0xc8000
    s_mov_b32 s15, 0x20000
    v_add_u32 v1, s31, v23
    v_mul_u32_u24 v2, 13108, v1
    v_lshrrev_b32 v2, 16, v2
    v_mul_u32_u24 v3, 5, v2
    v_sub_u32 v3, v1, v3
    v_mul_u32_u24 v2, 1280, v2
    v_lshl_add_u32 v2, v3, 7, v2
    v_cmp_gt_u32 vcc, s32, v1
    v_mov_b32 v3, -1
    s_nop 0
    v_cndmask_b32 v2, v3, v2, vcc
    buffer_load_dword v4, v2, s[12:15], s54 offen
    s_waitcnt vmcnt(17)
    s_barrier
    s_waitcnt vmcnt(9)
    s_barrier
    s_waitcnt vmcnt(1)
    s_barrier
    s_barrier
    s_barrier
qkv_kernel_end:
    s_setprio 0
attn_kernel:
    s_and_b32 s17, s2, 7
    s_lshr_b32 s18, s2, 3
    s_lshl_b32 s34, s17, 1
    s_and_b32 s17, s18, 1
    s_add_u32 s34, s34, s17
    s_lshr_b32 s15, s18, 1
    s_mov_b32 s16, s80
    v_lshrrev_b32 v1, 4, v0
    v_and_b32 v2, 15, v0
    v_min_u32 v7, 2, v1
    s_and_b32 s35, s16, 3
    s_lshr_b32 s36, s16, 2
    s_lshl_b32 s14, s34, 1
    s_add_u32 s14, s14, s36
    s_mul_i32 s37, s36, 34496
    s_mul_i32 s19, s14, 81920
    s_lshl_b32 s17, s15, 10
    s_add_u32 s19, s19, s17
    s_sub_u32 s19, s19, 2048
    v_lshlrev_b32 v3, 4, v0
    s_mul_i32 s18, s35, 768
    s_lshl_b32 s21, s15, 10
    s_add_u32 s21, s21, s18
    s_sub_u32 s21, s21, 2048
    v_add_u32 v8, s21, v3
    v_max_i32 v8, 0, v8
    s_mul_i32 s21, s14, 81920
    s_add_u32 s18, s18, s37
    s_mov_b32 s38, -1
    s_mov_b32 s39, 0xffff
    v_lshlrev_b32 v4, 1, v1
    v_min_u32 v5, 4, v4
    v_add_u32 v4, 1, v4
    v_min_u32 v4, 4, v4
    v_mov_b32 v11, v5
    v_mov_b32 v12, v4
    v_lshlrev_b32 v9, 14, v5
    v_lshl_add_u32 v9, v2, 3, v9
    v_lshlrev_b32 v10, 14, v4
    v_lshl_add_u32 v10, v2, 3, v10
    s_waitcnt lgkmcnt(0)
    s_mov_b32 s4, s78
    s_and_b32 s5, s79, 0xffff
    s_mov_b32 s6, 0x780000
    s_mov_b32 s7, 0x20000
    s_sub_u32 s40, s15, 2
    s_cmp_lg_u32 s80, 0
    s_cbranch_scc1 attn_kernel_dep_done
    s_waitcnt vmcnt(0)
    v_readfirstlane_b32 s81, v248
    s_nop 0
    s_cmp_eq_u32 s81, 0
    s_cselect_b32 s81, s82, s81
    v_lshrrev_b32 v13, 4, v0
    v_add_u32 v13, s40, v13
    v_and_b32 v14, 15, v0
    v_cmp_gt_u32 s[42:43], 15, v14
    v_cmp_le_i32 vcc, 0, v13
    s_and_b64 s[42:43], s[42:43], vcc
    v_cmp_ge_i32 vcc, s15, v13
    s_and_b64 s[42:43], s[42:43], vcc
    v_lshl_add_u32 v13, v13, 4, v14
    v_lshlrev_b32 v13, 3, v13
    v_add_u32 v13, 0, v13
    s_mov_b32 s41, 0
    s_mov_b64 exec, s[42:43]
attn_kernel_dep_loop:
    buffer_load_dwordx2 v[244:245], v13, s[84:87], 0 offen sc1
    s_waitcnt vmcnt(0)
    v_not_b32 v245, v245
    v_xor_b32 v244, s81, v244
    v_xor_b32 v245, s81, v245
    v_or_b32 v244, v244, v245
    v_cmp_ne_u32 vcc, 0, v244
    s_nop 1
    s_cbranch_vccz attn_kernel_dep_ok
    s_sleep 1
    s_add_u32 s41, s41, 1
    s_cmp_lt_u32 s41, 200000
    s_cbranch_scc1 attn_kernel_dep_loop
attn_kernel_dep_ok:
    s_mov_b64 exec, -1
attn_kernel_dep_done:
    s_barrier
    s_mov_b64 exec, s[38:39]
    s_add_u32 s17, s21, 2621440
    s_add_u32 m0, s18, 0
    s_nop 0
    buffer_load_dwordx4 v8, s[4:7], s17 offen sc1 lds
    s_add_u32 s17, s21, 2637824
    s_add_u32 m0, s18, 3136
    s_nop 0
    buffer_load_dwordx4 v8, s[4:7], s17 offen sc1 lds
    s_add_u32 s17, s21, 2654208
    s_add_u32 m0, s18, 6272
    s_nop 0
    buffer_load_dwordx4 v8, s[4:7], s17 offen sc1 lds
    s_add_u32 s17, s21, 2670592
    s_add_u32 m0, s18, 9408
    s_nop 0
    buffer_load_dwordx4 v8, s[4:7], s17 offen sc1 lds
    s_add_u32 s17, s21, 2686976
    s_add_u32 m0, s18, 12544
    s_nop 0
    buffer_load_dwordx4 v8, s[4:7], s17 offen sc1 lds
    s_mov_b64 exec, -1
    s_lshl_b32 s17, s35, 8
    s_add_u32 s17, s17, s19
    s_add_u32 s17, s17, 2048
    buffer_load_dwordx2 v[16:17], v9, s[4:7], s17 offen offset:0 sc1
    buffer_load_dwordx2 v[18:19], v10, s[4:7], s17 offen offset:0 sc1
    buffer_load_dwordx2 v[20:21], v9, s[4:7], s17 offen offset:128 sc1
    buffer_load_dwordx2 v[22:23], v10, s[4:7], s17 offen offset:128 sc1
    s_mov_b64 exec, s[38:39]
    s_add_u32 s17, s21, 5242880
    s_add_u32 m0, s18, 15680
    s_nop 0
    buffer_load_dwordx4 v8, s[4:7], s17 offen sc1 lds
    s_add_u32 s17, s21, 5259264
    s_add_u32 m0, s18, 18816
    s_nop 0
    buffer_load_dwordx4 v8, s[4:7], s17 offen sc1 lds
    s_add_u32 s17, s21, 5275648
    s_add_u32 m0, s18, 21952
    s_nop 0
    buffer_load_dwordx4 v8, s[4:7], s17 offen sc1 lds
    s_add_u32 s17, s21, 5292032
    s_add_u32 m0, s18, 25088
    s_nop 0
    buffer_load_dwordx4 v8, s[4:7], s17 offen sc1 lds
    s_add_u32 s17, s21, 5308416
    s_add_u32 m0, s18, 28224
    s_nop 0
    buffer_load_dwordx4 v8, s[4:7], s17 offen sc1 lds
    v_mov_b32 v24, 0x3f80
    v_mov_b32 v25, 0
    v_mov_b32 v26, 0x3f80
    v_mov_b32 v27, 0
    v_add_u32 v4, s18, v3
    ds_write_b128 v4, v[24:27] offset:31360
    s_mov_b64 exec, -1
    s_add_u32 s8, s78, 0x800000
    s_addc_u32 s9, s79, 0
    s_and_b32 s9, s9, 0xffff
    s_mov_b32 s10, 0x280000
    s_mov_b32 s11, 0x20000
    v_lshl_add_u32 v6, v1, 2, 0
    v_cmp_le_u32 s[22:23], v6, v2
    v_lshl_add_u32 v6, v1, 2, 1
    v_cmp_le_u32 s[24:25], v6, v2
    v_lshl_add_u32 v6, v1, 2, 2
    v_cmp_le_u32 s[26:27], v6, v2
    v_lshl_add_u32 v6, v1, 2, 3
    v_cmp_le_u32 s[28:29], v6, v2
    v_cmp_eq_u32 s[30:31], 3, v1
    v_cmp_le_u32 s[32:33], 2, v1
    v_mov_b32 v32, 0
    v_mov_b32 v6, 0xffff
    v_mov_b32 v33, 0xffff0000
    v_cndmask_b32 v28, v32, v6, s[22:23]
    v_cndmask_b32 v30, v32, v33, s[24:25]
    v_or_b32 v28, v28, v30
    v_not_b32 v30, v28
    v_cndmask_b32 v29, v32, v6, s[26:27]
    v_cndmask_b32 v31, v32, v33, s[28:29]
    v_or_b32 v29, v29, v31
    v_not_b32 v31, v29
    s_mov_b32 s20, 0x3ea52b5c
    s_lshl_b32 s17, s35, 8
    s_add_u32 s17, s17, s37
    v_lshl_add_u32 v6, v2, 3, s17
    v_mul_u32_u24 v34, 3136, v11
    v_add_u32 v34, v34, v6
    v_mul_u32_u24 v35, 3136, v12
    v_add_u32 v35, v35, v6
    s_add_u32 s17, s17, 15680
    v_lshrrev_b32 v6, 2, v0
    v_lshl_add_u32 v6, v6, 3, s17
    v_and_b32 v36, 3, v0
    v_mul_u32_u24 v36, 3136, v36
    v_add_u32 v36, v36, v6
    v_and_b32 v37, 1, v0
    v_mul_u32_u24 v37, 3136, v37
    v_add_u32 v37, v37, v6
    v_add_u32 v37, 12544, v37
    s_waitcnt vmcnt(5)
    v_cndmask_b32 v16, v16, v32, s[30:31]
    v_cndmask_b32 v17, v17, v32, s[30:31]
    v_cndmask_b32 v18, v18, v32, s[32:33]
    v_cndmask_b32 v19, v19, v32, s[32:33]
    v_cndmask_b32 v20, v20, v32, s[30:31]
    v_cndmask_b32 v21, v21, v32, s[30:31]
    v_cndmask_b32 v22, v22, v32, s[32:33]
    v_cndmask_b32 v23, v23, v32, s[32:33]
    s_waitcnt lgkmcnt(0)
    s_barrier
    ds_read_b64 v[176:177], v34 offset:0
    ds_read_b64 v[178:179], v35 offset:0
    ds_read_b64 v[180:181], v34 offset:128
    ds_read_b64 v[182:183], v35 offset:128
    ds_read_b64 v[184:185], v34 offset:256
    ds_read_b64 v[186:187], v35 offset:256
    ds_read_b64 v[188:189], v34 offset:384
    ds_read_b64 v[190:191], v35 offset:384
    ds_read_b64 v[192:193], v34 offset:512
    ds_read_b64 v[194:195], v35 offset:512
    ds_read_b64 v[196:197], v34 offset:640
    ds_read_b64 v[198:199], v35 offset:640
    s_waitcnt lgkmcnt(10)
    v_mfma_f32_16x16x32_bf16 v[40:43], v[176:179], v[16:19], 0
    ds_read_b64 v[176:177], v34 offset:768
    ds_read_b64 v[178:179], v35 offset:768
    s_waitcnt lgkmcnt(10)
    v_mfma_f32_16x16x32_bf16 v[44:47], v[180:183], v[16:19], 0
    v_mfma_f32_16x16x32_bf16 v[108:111], v[180:183], v[20:23], 0
    ds_read_b64 v[180:181], v34 offset:896
    ds_read_b64 v[182:183], v35 offset:896
    s_waitcnt lgkmcnt(10)
    v_mfma_f32_16x16x32_bf16 v[48:51], v[184:187], v[16:19], 0
    v_mfma_f32_16x16x32_bf16 v[112:115], v[184:187], v[20:23], 0
    ds_read_b64 v[184:185], v34 offset:1024
    ds_read_b64 v[186:187], v35 offset:1024
    s_waitcnt lgkmcnt(10)
    v_mfma_f32_16x16x32_bf16 v[52:55], v[188:191], v[16:19], 0
    v_mfma_f32_16x16x32_bf16 v[116:119], v[188:191], v[20:23], 0
    ds_read_b64 v[188:189], v34 offset:1152
    ds_read_b64 v[190:191], v35 offset:1152
    s_waitcnt lgkmcnt(10)
    v_mfma_f32_16x16x32_bf16 v[56:59], v[192:195], v[16:19], 0
    v_mfma_f32_16x16x32_bf16 v[120:123], v[192:195], v[20:23], 0
    ds_read_b64 v[192:193], v34 offset:1280
    ds_read_b64 v[194:195], v35 offset:1280
    s_waitcnt lgkmcnt(10)
    v_mfma_f32_16x16x32_bf16 v[60:63], v[196:199], v[16:19], 0
    v_mfma_f32_16x16x32_bf16 v[124:127], v[196:199], v[20:23], 0
    ds_read_b64 v[196:197], v34 offset:1408
    ds_read_b64 v[198:199], v35 offset:1408
    s_waitcnt lgkmcnt(10)
    v_mfma_f32_16x16x32_bf16 v[64:67], v[176:179], v[16:19], 0
    v_mfma_f32_16x16x32_bf16 v[128:131], v[176:179], v[20:23], 0
    ds_read_b64 v[176:177], v34 offset:1536
    ds_read_b64 v[178:179], v35 offset:1536
    s_waitcnt lgkmcnt(10)
    v_mfma_f32_16x16x32_bf16 v[68:71], v[180:183], v[16:19], 0
    v_mfma_f32_16x16x32_bf16 v[132:135], v[180:183], v[20:23], 0
    ds_read_b64 v[180:181], v34 offset:1664
    ds_read_b64 v[182:183], v35 offset:1664
    s_waitcnt lgkmcnt(10)
    v_mfma_f32_16x16x32_bf16 v[72:75], v[184:187], v[16:19], 0
    v_mfma_f32_16x16x32_bf16 v[136:139], v[184:187], v[20:23], 0
    ds_read_b64 v[184:185], v34 offset:1792
    ds_read_b64 v[186:187], v35 offset:1792
    s_waitcnt lgkmcnt(10)
    v_mfma_f32_16x16x32_bf16 v[76:79], v[188:191], v[16:19], 0
    v_mfma_f32_16x16x32_bf16 v[140:143], v[188:191], v[20:23], 0
    ds_read_b64 v[188:189], v34 offset:1920
    ds_read_b64 v[190:191], v35 offset:1920
    s_waitcnt lgkmcnt(10)
    v_mfma_f32_16x16x32_bf16 v[80:83], v[192:195], v[16:19], 0
    v_mfma_f32_16x16x32_bf16 v[144:147], v[192:195], v[20:23], 0
    ds_read_b64 v[192:193], v34 offset:2048
    ds_read_b64 v[194:195], v35 offset:2048
    s_waitcnt lgkmcnt(10)
    v_mfma_f32_16x16x32_bf16 v[84:87], v[196:199], v[16:19], 0
    v_mfma_f32_16x16x32_bf16 v[148:151], v[196:199], v[20:23], 0
    ds_read_b64 v[196:197], v34 offset:2176
    ds_read_b64 v[198:199], v35 offset:2176
    s_waitcnt lgkmcnt(10)
    v_mfma_f32_16x16x32_bf16 v[88:91], v[176:179], v[16:19], 0
    v_mfma_f32_16x16x32_bf16 v[152:155], v[176:179], v[20:23], 0
    s_waitcnt lgkmcnt(8)
    v_mfma_f32_16x16x32_bf16 v[92:95], v[180:183], v[16:19], 0
    v_mfma_f32_16x16x32_bf16 v[156:159], v[180:183], v[20:23], 0
    s_waitcnt lgkmcnt(6)
    v_mfma_f32_16x16x32_bf16 v[96:99], v[184:187], v[16:19], 0
    v_mfma_f32_16x16x32_bf16 v[160:163], v[184:187], v[20:23], 0
    s_waitcnt lgkmcnt(4)
    v_mfma_f32_16x16x32_bf16 v[100:103], v[188:191], v[16:19], 0
    v_mfma_f32_16x16x32_bf16 v[164:167], v[188:191], v[20:23], 0
    s_waitcnt lgkmcnt(2)
    v_mfma_f32_16x16x32_bf16 v[104:107], v[192:195], v[16:19], 0
    v_mfma_f32_16x16x32_bf16 v[168:171], v[192:195], v[20:23], 0
    s_waitcnt lgkmcnt(0)
    v_mfma_f32_16x16x32_bf16 v[172:175], v[196:199], v[20:23], 0
    s_nop 7
    s_cmp_ge_u32 s15, 2
    s_cbranch_scc1 attn_kernel_nomask
    s_lshl_b32 s21, s35, 1
    s_lshl_b32 s17, s15, 3
    s_add_u32 s21, s21, s17
    s_sub_u32 s21, 16, s21
    s_cmp_gt_u32 s21, 0
    s_cbranch_scc0 attn_kernel_mdone0
    v_mov_b32 v40, 0xf149f2ca
    v_mov_b32 v41, 0xf149f2ca
    v_mov_b32 v42, 0xf149f2ca
    v_mov_b32 v43, 0xf149f2ca
    s_cmp_gt_u32 s21, 1
    s_cbranch_scc0 attn_kernel_mdone0
    v_mov_b32 v44, 0xf149f2ca
    v_mov_b32 v45, 0xf149f2ca
    v_mov_b32 v46, 0xf149f2ca
    v_mov_b32 v47, 0xf149f2ca
    s_cmp_gt_u32 s21, 2
    s_cbranch_scc0 attn_kernel_mdone0
    v_mov_b32 v48, 0xf149f2ca
    v_mov_b32 v49, 0xf149f2ca
    v_mov_b32 v50, 0xf149f2ca
    v_mov_b32 v51, 0xf149f2ca
    s_cmp_gt_u32 s21, 3
    s_cbranch_scc0 attn_kernel_mdone0
    v_mov_b32 v52, 0xf149f2ca
    v_mov_b32 v53, 0xf149f2ca
    v_mov_b32 v54, 0xf149f2ca
    v_mov_b32 v55, 0xf149f2ca
    s_cmp_gt_u32 s21, 4
    s_cbranch_scc0 attn_kernel_mdone0
    v_mov_b32 v56, 0xf149f2ca
    v_mov_b32 v57, 0xf149f2ca
    v_mov_b32 v58, 0xf149f2ca
    v_mov_b32 v59, 0xf149f2ca
    s_cmp_gt_u32 s21, 5
    s_cbranch_scc0 attn_kernel_mdone0
    v_mov_b32 v60, 0xf149f2ca
    v_mov_b32 v61, 0xf149f2ca
    v_mov_b32 v62, 0xf149f2ca
    v_mov_b32 v63, 0xf149f2ca
    s_cmp_gt_u32 s21, 6
    s_cbranch_scc0 attn_kernel_mdone0
    v_mov_b32 v64, 0xf149f2ca
    v_mov_b32 v65, 0xf149f2ca
    v_mov_b32 v66, 0xf149f2ca
    v_mov_b32 v67, 0xf149f2ca
    s_cmp_gt_u32 s21, 7
    s_cbranch_scc0 attn_kernel_mdone0
    v_mov_b32 v68, 0xf149f2ca
    v_mov_b32 v69, 0xf149f2ca
    v_mov_b32 v70, 0xf149f2ca
    v_mov_b32 v71, 0xf149f2ca
    s_cmp_gt_u32 s21, 8
    s_cbranch_scc0 attn_kernel_mdone0
    v_mov_b32 v72, 0xf149f2ca
    v_mov_b32 v73, 0xf149f2ca
    v_mov_b32 v74, 0xf149f2ca
    v_mov_b32 v75, 0xf149f2ca
    s_cmp_gt_u32 s21, 9
    s_cbranch_scc0 attn_kernel_mdone0
    v_mov_b32 v76, 0xf149f2ca
    v_mov_b32 v77, 0xf149f2ca
    v_mov_b32 v78, 0xf149f2ca
    v_mov_b32 v79, 0xf149f2ca
    s_cmp_gt_u32 s21, 10
    s_cbranch_scc0 attn_kernel_mdone0
    v_mov_b32 v80, 0xf149f2ca
    v_mov_b32 v81, 0xf149f2ca
    v_mov_b32 v82, 0xf149f2ca
    v_mov_b32 v83, 0xf149f2ca
    s_cmp_gt_u32 s21, 11
    s_cbranch_scc0 attn_kernel_mdone0
    v_mov_b32 v84, 0xf149f2ca
    v_mov_b32 v85, 0xf149f2ca
    v_mov_b32 v86, 0xf149f2ca
    v_mov_b32 v87, 0xf149f2ca
    s_cmp_gt_u32 s21, 12
    s_cbranch_scc0 attn_kernel_mdone0
    v_mov_b32 v88, 0xf149f2ca
    v_mov_b32 v89, 0xf149f2ca
    v_mov_b32 v90, 0xf149f2ca
    v_mov_b32 v91, 0xf149f2ca
    s_cmp_gt_u32 s21, 13
    s_cbranch_scc0 attn_kernel_mdone0
    v_mov_b32 v92, 0xf149f2ca
    v_mov_b32 v93, 0xf149f2ca
    v_mov_b32 v94, 0xf149f2ca
    v_mov_b32 v95, 0xf149f2ca
    s_cmp_gt_u32 s21, 14
    s_cbranch_scc0 attn_kernel_mdone0
    v_mov_b32 v96, 0xf149f2ca
    v_mov_b32 v97, 0xf149f2ca
    v_mov_b32 v98, 0xf149f2ca
    v_mov_b32 v99, 0xf149f2ca
    s_cmp_gt_u32 s21, 15
    s_cbranch_scc0 attn_kernel_mdone0
    v_mov_b32 v100, 0xf149f2ca
    v_mov_b32 v101, 0xf149f2ca
    v_mov_b32 v102, 0xf149f2ca
    v_mov_b32 v103, 0xf149f2ca
attn_kernel_mdone0:
    s_lshl_b32 s21, s35, 1
    s_lshl_b32 s17, s15, 3
    s_add_u32 s21, s21, s17
    s_sub_u32 s21, 15, s21
    s_cmp_gt_u32 s21, 0
    s_cbranch_scc0 attn_kernel_mdone1
    v_mov_b32 v108, 0xf149f2ca
    v_mov_b32 v109, 0xf149f2ca
    v_mov_b32 v110, 0xf149f2ca
    v_mov_b32 v111, 0xf149f2ca
    s_cmp_gt_u32 s21, 1
    s_cbranch_scc0 attn_kernel_mdone1
    v_mov_b32 v112, 0xf149f2ca
    v_mov_b32 v113, 0xf149f2ca
    v_mov_b32 v114, 0xf149f2ca
    v_mov_b32 v115, 0xf149f2ca
    s_cmp_gt_u32 s21, 2
    s_cbranch_scc0 attn_kernel_mdone1
    v_mov_b32 v116, 0xf149f2ca
    v_mov_b32 v117, 0xf149f2ca
    v_mov_b32 v118, 0xf149f2ca
    v_mov_b32 v119, 0xf149f2ca
    s_cmp_gt_u32 s21, 3
    s_cbranch_scc0 attn_kernel_mdone1
    v_mov_b32 v120, 0xf149f2ca
    v_mov_b32 v121, 0xf149f2ca
    v_mov_b32 v122, 0xf149f2ca
    v_mov_b32 v123, 0xf149f2ca
    s_cmp_gt_u32 s21, 4
    s_cbranch_scc0 attn_kernel_mdone1
    v_mov_b32 v124, 0xf149f2ca
    v_mov_b32 v125, 0xf149f2ca
    v_mov_b32 v126, 0xf149f2ca
    v_mov_b32 v127, 0xf149f2ca
    s_cmp_gt_u32 s21, 5
    s_cbranch_scc0 attn_kernel_mdone1
    v_mov_b32 v128, 0xf149f2ca
    v_mov_b32 v129, 0xf149f2ca
    v_mov_b32 v130, 0xf149f2ca
    v_mov_b32 v131, 0xf149f2ca
    s_cmp_gt_u32 s21, 6
    s_cbranch_scc0 attn_kernel_mdone1
    v_mov_b32 v132, 0xf149f2ca
    v_mov_b32 v133, 0xf149f2ca
    v_mov_b32 v134, 0xf149f2ca
    v_mov_b32 v135, 0xf149f2ca
    s_cmp_gt_u32 s21, 7
    s_cbranch_scc0 attn_kernel_mdone1
    v_mov_b32 v136, 0xf149f2ca
    v_mov_b32 v137, 0xf149f2ca
    v_mov_b32 v138, 0xf149f2ca
    v_mov_b32 v139, 0xf149f2ca
    s_cmp_gt_u32 s21, 8
    s_cbranch_scc0 attn_kernel_mdone1
    v_mov_b32 v140, 0xf149f2ca
    v_mov_b32 v141, 0xf149f2ca
    v_mov_b32 v142, 0xf149f2ca
    v_mov_b32 v143, 0xf149f2ca
    s_cmp_gt_u32 s21, 9
    s_cbranch_scc0 attn_kernel_mdone1
    v_mov_b32 v144, 0xf149f2ca
    v_mov_b32 v145, 0xf149f2ca
    v_mov_b32 v146, 0xf149f2ca
    v_mov_b32 v147, 0xf149f2ca
    s_cmp_gt_u32 s21, 10
    s_cbranch_scc0 attn_kernel_mdone1
    v_mov_b32 v148, 0xf149f2ca
    v_mov_b32 v149, 0xf149f2ca
    v_mov_b32 v150, 0xf149f2ca
    v_mov_b32 v151, 0xf149f2ca
    s_cmp_gt_u32 s21, 11
    s_cbranch_scc0 attn_kernel_mdone1
    v_mov_b32 v152, 0xf149f2ca
    v_mov_b32 v153, 0xf149f2ca
    v_mov_b32 v154, 0xf149f2ca
    v_mov_b32 v155, 0xf149f2ca
    s_cmp_gt_u32 s21, 12
    s_cbranch_scc0 attn_kernel_mdone1
    v_mov_b32 v156, 0xf149f2ca
    v_mov_b32 v157, 0xf149f2ca
    v_mov_b32 v158, 0xf149f2ca
    v_mov_b32 v159, 0xf149f2ca
    s_cmp_gt_u32 s21, 13
    s_cbranch_scc0 attn_kernel_mdone1
    v_mov_b32 v160, 0xf149f2ca
    v_mov_b32 v161, 0xf149f2ca
    v_mov_b32 v162, 0xf149f2ca
    v_mov_b32 v163, 0xf149f2ca
    s_cmp_gt_u32 s21, 14
    s_cbranch_scc0 attn_kernel_mdone1
    v_mov_b32 v164, 0xf149f2ca
    v_mov_b32 v165, 0xf149f2ca
    v_mov_b32 v166, 0xf149f2ca
    v_mov_b32 v167, 0xf149f2ca
    s_cmp_gt_u32 s21, 15
    s_cbranch_scc0 attn_kernel_mdone1
    v_mov_b32 v168, 0xf149f2ca
    v_mov_b32 v169, 0xf149f2ca
    v_mov_b32 v170, 0xf149f2ca
    v_mov_b32 v171, 0xf149f2ca
attn_kernel_mdone1:
attn_kernel_nomask:
    v_mov_b32 v202, s20
    v_cndmask_b32 v104, v40, v104, s[22:23]
    v_cndmask_b32 v105, v41, v105, s[24:25]
    v_cndmask_b32 v106, v42, v106, s[26:27]
    v_cndmask_b32 v107, v43, v107, s[28:29]
    v_max3_f32 v200, v44, v45, v46
    v_max3_f32 v201, v47, v48, v49
    v_max3_f32 v200, v200, v50, v51
    v_max3_f32 v201, v201, v52, v53
    v_max3_f32 v200, v200, v54, v55
    v_max3_f32 v201, v201, v56, v57
    v_max3_f32 v200, v200, v58, v59
    v_max3_f32 v201, v201, v60, v61
    v_max3_f32 v200, v200, v62, v63
    v_max3_f32 v201, v201, v64, v65
    v_max3_f32 v200, v200, v66, v67
    v_max3_f32 v201, v201, v68, v69
    v_max3_f32 v200, v200, v70, v71
    v_max3_f32 v201, v201, v72, v73
    v_max3_f32 v200, v200, v74, v75
    v_max3_f32 v201, v201, v76, v77
    v_max3_f32 v200, v200, v78, v79
    v_max3_f32 v201, v201, v80, v81
    v_max3_f32 v200, v200, v82, v83
    v_max3_f32 v201, v201, v84, v85
    v_max3_f32 v200, v200, v86, v87
    v_max3_f32 v201, v201, v88, v89
    v_max3_f32 v200, v200, v90, v91
    v_max3_f32 v201, v201, v92, v93
    v_max3_f32 v200, v200, v94, v95
    v_max3_f32 v201, v201, v96, v97
    v_max3_f32 v200, v200, v98, v99
    v_max3_f32 v201, v201, v100, v101
    v_max3_f32 v200, v200, v102, v103
    v_max3_f32 v201, v201, v104, v105
    v_max3_f32 v200, v200, v106, v107
    v_max_f32 v200, v200, v201
    v_mov_b32 v201, v200
    s_nop 1
    v_permlane32_swap_b32 v200, v201
    v_max_f32 v200, v200, v201
    v_mov_b32 v201, v200
    s_nop 1
    v_permlane16_swap_b32 v200, v201
    v_max_f32 v200, v200, v201
    v_mul_f32 v200, s20, v200
    v_fma_f32 v44, v44, s20, -v200
    v_fma_f32 v45, v45, s20, -v200
    v_fma_f32 v46, v46, s20, -v200
    v_fma_f32 v47, v47, s20, -v200
    v_exp_f32 v44, v44
    v_exp_f32 v45, v45
    v_exp_f32 v46, v46
    v_exp_f32 v47, v47
    v_cvt_pk_bf16_f32 v42, v44, v45
    v_cvt_pk_bf16_f32 v43, v46, v47
    v_fma_f32 v48, v48, s20, -v200
    v_fma_f32 v49, v49, s20, -v200
    v_fma_f32 v50, v50, s20, -v200
    v_fma_f32 v51, v51, s20, -v200
    v_exp_f32 v48, v48
    v_exp_f32 v49, v49
    v_exp_f32 v50, v50
    v_exp_f32 v51, v51
    v_cvt_pk_bf16_f32 v48, v48, v49
    v_cvt_pk_bf16_f32 v49, v50, v51
    v_fma_f32 v52, v52, s20, -v200
    v_fma_f32 v53, v53, s20, -v200
    v_fma_f32 v54, v54, s20, -v200
    v_fma_f32 v55, v55, s20, -v200
    v_exp_f32 v52, v52
    v_exp_f32 v53, v53
    v_exp_f32 v54, v54
    v_exp_f32 v55, v55
    v_cvt_pk_bf16_f32 v50, v52, v53
    v_cvt_pk_bf16_f32 v51, v54, v55
    v_fma_f32 v56, v56, s20, -v200
    v_fma_f32 v57, v57, s20, -v200
    v_fma_f32 v58, v58, s20, -v200
    v_fma_f32 v59, v59, s20, -v200
    v_exp_f32 v56, v56
    v_exp_f32 v57, v57
    v_exp_f32 v58, v58
    v_exp_f32 v59, v59
    v_cvt_pk_bf16_f32 v56, v56, v57
    v_cvt_pk_bf16_f32 v57, v58, v59
    v_fma_f32 v60, v60, s20, -v200
    v_fma_f32 v61, v61, s20, -v200
    v_fma_f32 v62, v62, s20, -v200
    v_fma_f32 v63, v63, s20, -v200
    v_exp_f32 v60, v60
    v_exp_f32 v61, v61
    v_exp_f32 v62, v62
    v_exp_f32 v63, v63
    v_cvt_pk_bf16_f32 v58, v60, v61
    v_cvt_pk_bf16_f32 v59, v62, v63
    v_fma_f32 v64, v64, s20, -v200
    v_fma_f32 v65, v65, s20, -v200
    v_fma_f32 v66, v66, s20, -v200
    v_fma_f32 v67, v67, s20, -v200
    v_exp_f32 v64, v64
    v_exp_f32 v65, v65
    v_exp_f32 v66, v66
    v_exp_f32 v67, v67
    v_cvt_pk_bf16_f32 v64, v64, v65
    v_cvt_pk_bf16_f32 v65, v66, v67
    v_fma_f32 v68, v68, s20, -v200
    v_fma_f32 v69, v69, s20, -v200
    v_fma_f32 v70, v70, s20, -v200
    v_fma_f32 v71, v71, s20, -v200
    v_exp_f32 v68, v68
    v_exp_f32 v69, v69
    v_exp_f32 v70, v70
    v_exp_f32 v71, v71
    v_cvt_pk_bf16_f32 v66, v68, v69
    v_cvt_pk_bf16_f32 v67, v70, v71
    v_fma_f32 v72, v72, s20, -v200
    v_fma_f32 v73, v73, s20, -v200
    v_fma_f32 v74, v74, s20, -v200
    v_fma_f32 v75, v75, s20, -v200
    v_exp_f32 v72, v72
    v_exp_f32 v73, v73
    v_exp_f32 v74, v74
    v_exp_f32 v75, v75
    v_cvt_pk_bf16_f32 v72, v72, v73
    v_cvt_pk_bf16_f32 v73, v74, v75
    v_fma_f32 v76, v76, s20, -v200
    v_fma_f32 v77, v77, s20, -v200
    v_fma_f32 v78, v78, s20, -v200
    v_fma_f32 v79, v79, s20, -v200
    v_exp_f32 v76, v76
    v_exp_f32 v77, v77
    v_exp_f32 v78, v78
    v_exp_f32 v79, v79
    v_cvt_pk_bf16_f32 v74, v76, v77
    v_cvt_pk_bf16_f32 v75, v78, v79
    v_fma_f32 v80, v80, s20, -v200
    v_fma_f32 v81, v81, s20, -v200
    v_fma_f32 v82, v82, s20, -v200
    v_fma_f32 v83, v83, s20, -v200
    v_exp_f32 v80, v80
    v_exp_f32 v81, v81
    v_exp_f32 v82, v82
    v_exp_f32 v83, v83
    v_cvt_pk_bf16_f32 v80, v80, v81
    v_cvt_pk_bf16_f32 v81, v82, v83
    v_fma_f32 v84, v84, s20, -v200
    v_fma_f32 v85, v85, s20, -v200
    v_fma_f32 v86, v86, s20, -v200
    v_fma_f32 v87, v87, s20, -v200
    v_exp_f32 v84, v84
    v_exp_f32 v85, v85
    v_exp_f32 v86, v86
    v_exp_f32 v87, v87
    v_cvt_pk_bf16_f32 v82, v84, v85
    v_cvt_pk_bf16_f32 v83, v86, v87
    v_fma_f32 v88, v88, s20, -v200
    v_fma_f32 v89, v89, s20, -v200
    v_fma_f32 v90, v90, s20, -v200
    v_fma_f32 v91, v91, s20, -v200
    v_exp_f32 v88, v88
    v_exp_f32 v89, v89
    v_exp_f32 v90, v90
    v_exp_f32 v91, v91
    v_cvt_pk_bf16_f32 v88, v88, v89
    v_cvt_pk_bf16_f32 v89, v90, v91
    v_fma_f32 v92, v92, s20, -v200
    v_fma_f32 v93, v93, s20, -v200
    v_fma_f32 v94, v94, s20, -v200
    v_fma_f32 v95, v95, s20, -v200
    v_exp_f32 v92, v92
    v_exp_f32 v93, v93
    v_exp_f32 v94, v94
    v_exp_f32 v95, v95
    v_cvt_pk_bf16_f32 v90, v92, v93
    v_cvt_pk_bf16_f32 v91, v94, v95
    v_fma_f32 v96, v96, s20, -v200
    v_fma_f32 v97, v97, s20, -v200
    v_fma_f32 v98, v98, s20, -v200
    v_fma_f32 v99, v99, s20, -v200
    v_exp_f32 v96, v96
    v_exp_f32 v97, v97
    v_exp_f32 v98, v98
    v_exp_f32 v99, v99
    v_cvt_pk_bf16_f32 v96, v96, v97
    v_cvt_pk_bf16_f32 v97, v98, v99
    v_fma_f32 v100, v100, s20, -v200
    v_fma_f32 v101, v101, s20, -v200
    v_fma_f32 v102, v102, s20, -v200
    v_fma_f32 v103, v103, s20, -v200
    v_exp_f32 v100, v100
    v_exp_f32 v101, v101
    v_exp_f32 v102, v102
    v_exp_f32 v103, v103
    v_cvt_pk_bf16_f32 v98, v100, v101
    v_cvt_pk_bf16_f32 v99, v102, v103
    v_fma_f32 v104, v104, s20, -v200
    v_fma_f32 v105, v105, s20, -v200
    v_fma_f32 v106, v106, s20, -v200
    v_fma_f32 v107, v107, s20, -v200
    v_exp_f32 v104, v104
    v_exp_f32 v105, v105
    v_exp_f32 v106, v106
    v_exp_f32 v107, v107
    v_cvt_pk_bf16_f32 v3, v104, v105
    v_cvt_pk_bf16_f32 v4, v106, v107
    v_and_b32 v104, v3, v28
    v_and_b32 v105, v4, v29
    v_and_b32 v40, v3, v30
    v_and_b32 v41, v4, v31
    v_lshl_add_u32 v224, s16, 6, v0
    s_lshr_b32 s17, s2, 3
    s_mul_i32 s17, s17, 280
    s_add_u32 s18, s17, 280
    s_min_u32 s18, s18, 8960
    s_and_b32 s21, s2, 1
    s_mul_i32 s21, s21, 1792
    s_mov_b32 s40, s70
    s_and_b32 s41, s71, 0xffff
    s_mov_b32 s42, 0x21c000
    s_mov_b32 s43, 0x20000
    v_add_u32 v3, s17, v224
    v_mul_u32_u24 v4, 9363, v3
    v_lshrrev_b32 v4, 17, v4
    v_mul_u32_u24 v5, 14, v4
    v_sub_u32 v5, v3, v5
    v_mul_u32_u24 v4, 3456, v4
    v_lshl_add_u32 v4, v5, 7, v4
    v_cmp_gt_u32 vcc, s18, v3
    v_mov_b32 v5, -1
    s_nop 0
    v_cndmask_b32 v4, v5, v4, vcc
    buffer_load_dword v6, v4, s[40:43], s21 offen
    v_cndmask_b32 v172, v108, v172, s[22:23]
    v_cndmask_b32 v173, v109, v173, s[24:25]
    v_cndmask_b32 v174, v110, v174, s[26:27]
    v_cndmask_b32 v175, v111, v175, s[28:29]
    v_max3_f32 v200, v112, v113, v114
    v_max3_f32 v201, v115, v116, v117
    v_max3_f32 v200, v200, v118, v119
    v_max3_f32 v201, v201, v120, v121
    v_max3_f32 v200, v200, v122, v123
    v_max3_f32 v201, v201, v124, v125
    v_max3_f32 v200, v200, v126, v127
    v_max3_f32 v201, v201, v128, v129
    v_max3_f32 v200, v200, v130, v131
    v_max3_f32 v201, v201, v132, v133
    v_max3_f32 v200, v200, v134, v135
    v_max3_f32 v201, v201, v136, v137
    v_max3_f32 v200, v200, v138, v139
    v_max3_f32 v201, v201, v140, v141
    v_max3_f32 v200, v200, v142, v143
    v_max3_f32 v201, v201, v144, v145
    v_max3_f32 v200, v200, v146, v147
    v_max3_f32 v201, v201, v148, v149
    v_max3_f32 v200, v200, v150, v151
    v_max3_f32 v201, v201, v152, v153
    v_max3_f32 v200, v200, v154, v155
    v_max3_f32 v201, v201, v156, v157
    v_max3_f32 v200, v200, v158, v159
    v_max3_f32 v201, v201, v160, v161
    v_max3_f32 v200, v200, v162, v163
    v_max3_f32 v201, v201, v164, v165
    v_max3_f32 v200, v200, v166, v167
    v_max3_f32 v201, v201, v168, v169
    v_max3_f32 v200, v200, v170, v171
    v_max3_f32 v201, v201, v172, v173
    v_max3_f32 v200, v200, v174, v175
    v_max_f32 v200, v200, v201
    v_mov_b32 v201, v200
    s_nop 1
    v_permlane32_swap_b32 v200, v201
    v_max_f32 v200, v200, v201
    v_mov_b32 v201, v200
    s_nop 1
    v_permlane16_swap_b32 v200, v201
    v_max_f32 v200, v200, v201
    v_mul_f32 v200, s20, v200
    v_fma_f32 v112, v112, s20, -v200
    v_fma_f32 v113, v113, s20, -v200
    v_fma_f32 v114, v114, s20, -v200
    v_fma_f32 v115, v115, s20, -v200
    v_exp_f32 v112, v112
    v_exp_f32 v113, v113
    v_exp_f32 v114, v114
    v_exp_f32 v115, v115
    v_cvt_pk_bf16_f32 v112, v112, v113
    v_cvt_pk_bf16_f32 v113, v114, v115
    v_fma_f32 v116, v116, s20, -v200
    v_fma_f32 v117, v117, s20, -v200
    v_fma_f32 v118, v118, s20, -v200
    v_fma_f32 v119, v119, s20, -v200
    v_exp_f32 v116, v116
    v_exp_f32 v117, v117
    v_exp_f32 v118, v118
    v_exp_f32 v119, v119
    v_cvt_pk_bf16_f32 v114, v116, v117
    v_cvt_pk_bf16_f32 v115, v118, v119
    v_fma_f32 v120, v120, s20, -v200
    v_fma_f32 v121, v121, s20, -v200
    v_fma_f32 v122, v122, s20, -v200
    v_fma_f32 v123, v123, s20, -v200
    v_exp_f32 v120, v120
    v_exp_f32 v121, v121
    v_exp_f32 v122, v122
    v_exp_f32 v123, v123
    v_cvt_pk_bf16_f32 v120, v120, v121
    v_cvt_pk_bf16_f32 v121, v122, v123
    v_fma_f32 v124, v124, s20, -v200
    v_fma_f32 v125, v125, s20, -v200
    v_fma_f32 v126, v126, s20, -v200
    v_fma_f32 v127, v127, s20, -v200
    v_exp_f32 v124, v124
    v_exp_f32 v125, v125
    v_exp_f32 v126, v126
    v_exp_f32 v127, v127
    v_cvt_pk_bf16_f32 v122, v124, v125
    v_cvt_pk_bf16_f32 v123, v126, v127
    v_fma_f32 v128, v128, s20, -v200
    v_fma_f32 v129, v129, s20, -v200
    v_fma_f32 v130, v130, s20, -v200
    v_fma_f32 v131, v131, s20, -v200
    v_exp_f32 v128, v128
    v_exp_f32 v129, v129
    v_exp_f32 v130, v130
    v_exp_f32 v131, v131
    v_cvt_pk_bf16_f32 v128, v128, v129
    v_cvt_pk_bf16_f32 v129, v130, v131
    v_fma_f32 v132, v132, s20, -v200
    v_fma_f32 v133, v133, s20, -v200
    v_fma_f32 v134, v134, s20, -v200
    v_fma_f32 v135, v135, s20, -v200
    v_exp_f32 v132, v132
    v_exp_f32 v133, v133
    v_exp_f32 v134, v134
    v_exp_f32 v135, v135
    v_cvt_pk_bf16_f32 v130, v132, v133
    v_cvt_pk_bf16_f32 v131, v134, v135
    v_fma_f32 v136, v136, s20, -v200
    v_fma_f32 v137, v137, s20, -v200
    v_fma_f32 v138, v138, s20, -v200
    v_fma_f32 v139, v139, s20, -v200
    v_exp_f32 v136, v136
    v_exp_f32 v137, v137
    v_exp_f32 v138, v138
    v_exp_f32 v139, v139
    v_cvt_pk_bf16_f32 v136, v136, v137
    v_cvt_pk_bf16_f32 v137, v138, v139
    v_fma_f32 v140, v140, s20, -v200
    v_fma_f32 v141, v141, s20, -v200
    v_fma_f32 v142, v142, s20, -v200
    v_fma_f32 v143, v143, s20, -v200
    v_exp_f32 v140, v140
    v_exp_f32 v141, v141
    v_exp_f32 v142, v142
    v_exp_f32 v143, v143
    v_cvt_pk_bf16_f32 v138, v140, v141
    v_cvt_pk_bf16_f32 v139, v142, v143
    v_fma_f32 v144, v144, s20, -v200
    v_fma_f32 v145, v145, s20, -v200
    v_fma_f32 v146, v146, s20, -v200
    v_fma_f32 v147, v147, s20, -v200
    v_exp_f32 v144, v144
    v_exp_f32 v145, v145
    v_exp_f32 v146, v146
    v_exp_f32 v147, v147
    v_cvt_pk_bf16_f32 v144, v144, v145
    v_cvt_pk_bf16_f32 v145, v146, v147
    v_fma_f32 v148, v148, s20, -v200
    v_fma_f32 v149, v149, s20, -v200
    v_fma_f32 v150, v150, s20, -v200
    v_fma_f32 v151, v151, s20, -v200
    v_exp_f32 v148, v148
    v_exp_f32 v149, v149
    v_exp_f32 v150, v150
    v_exp_f32 v151, v151
    v_cvt_pk_bf16_f32 v146, v148, v149
    v_cvt_pk_bf16_f32 v147, v150, v151
    v_fma_f32 v152, v152, s20, -v200
    v_fma_f32 v153, v153, s20, -v200
    v_fma_f32 v154, v154, s20, -v200
    v_fma_f32 v155, v155, s20, -v200
    v_exp_f32 v152, v152
    v_exp_f32 v153, v153
    v_exp_f32 v154, v154
    v_exp_f32 v155, v155
    v_cvt_pk_bf16_f32 v152, v152, v153
    v_cvt_pk_bf16_f32 v153, v154, v155
    v_fma_f32 v156, v156, s20, -v200
    v_fma_f32 v157, v157, s20, -v200
    v_fma_f32 v158, v158, s20, -v200
    v_fma_f32 v159, v159, s20, -v200
    v_exp_f32 v156, v156
    v_exp_f32 v157, v157
    v_exp_f32 v158, v158
    v_exp_f32 v159, v159
    v_cvt_pk_bf16_f32 v154, v156, v157
    v_cvt_pk_bf16_f32 v155, v158, v159
    v_fma_f32 v160, v160, s20, -v200
    v_fma_f32 v161, v161, s20, -v200
    v_fma_f32 v162, v162, s20, -v200
    v_fma_f32 v163, v163, s20, -v200
    v_exp_f32 v160, v160
    v_exp_f32 v161, v161
    v_exp_f32 v162, v162
    v_exp_f32 v163, v163
    v_cvt_pk_bf16_f32 v160, v160, v161
    v_cvt_pk_bf16_f32 v161, v162, v163
    v_fma_f32 v164, v164, s20, -v200
    v_fma_f32 v165, v165, s20, -v200
    v_fma_f32 v166, v166, s20, -v200
    v_fma_f32 v167, v167, s20, -v200
    v_exp_f32 v164, v164
    v_exp_f32 v165, v165
    v_exp_f32 v166, v166
    v_exp_f32 v167, v167
    v_cvt_pk_bf16_f32 v162, v164, v165
    v_cvt_pk_bf16_f32 v163, v166, v167
    v_fma_f32 v168, v168, s20, -v200
    v_fma_f32 v169, v169, s20, -v200
    v_fma_f32 v170, v170, s20, -v200
    v_fma_f32 v171, v171, s20, -v200
    v_exp_f32 v168, v168
    v_exp_f32 v169, v169
    v_exp_f32 v170, v170
    v_exp_f32 v171, v171
    v_cvt_pk_bf16_f32 v168, v168, v169
    v_cvt_pk_bf16_f32 v169, v170, v171
    v_fma_f32 v172, v172, s20, -v200
    v_fma_f32 v173, v173, s20, -v200
    v_fma_f32 v174, v174, s20, -v200
    v_fma_f32 v175, v175, s20, -v200
    v_exp_f32 v172, v172
    v_exp_f32 v173, v173
    v_exp_f32 v174, v174
    v_exp_f32 v175, v175
    v_cvt_pk_bf16_f32 v3, v172, v173
    v_cvt_pk_bf16_f32 v4, v174, v175
    v_and_b32 v170, v3, v28
    v_and_b32 v171, v4, v29
    v_and_b32 v108, v3, v30
    v_and_b32 v109, v4, v31
    s_waitcnt vmcnt(1)
    s_barrier
    ds_read_b64_tr_b16 v[176:177], v36 offset:0
    ds_read_b64_tr_b16 v[178:179], v36 offset:128
    ds_read_b64_tr_b16 v[180:181], v37 offset:0
    ds_read_b64_tr_b16 v[182:183], v37 offset:128
    ds_read_b64_tr_b16 v[184:185], v36 offset:256
    ds_read_b64_tr_b16 v[186:187], v36 offset:384
    ds_read_b64_tr_b16 v[188:189], v37 offset:256
    ds_read_b64_tr_b16 v[190:191], v37 offset:384
    ds_read_b64_tr_b16 v[192:193], v36 offset:512
    ds_read_b64_tr_b16 v[194:195], v36 offset:640
    ds_read_b64_tr_b16 v[196:197], v37 offset:512
    ds_read_b64_tr_b16 v[198:199], v37 offset:640
    s_waitcnt lgkmcnt(8)
    v_mfma_f32_16x16x32_bf16 v[208:211], v[176:179], v[40:43], 0
    v_mfma_f32_16x16x16_bf16 v[216:219], v[178:179], v[108:109], 0
    v_mfma_f32_16x16x32_bf16 v[212:215], v[180:183], v[40:43], 0
    v_mfma_f32_16x16x16_bf16 v[220:223], v[182:183], v[108:109], 0
    ds_read_b64_tr_b16 v[176:177], v36 offset:768
    ds_read_b64_tr_b16 v[178:179], v36 offset:896
    ds_read_b64_tr_b16 v[180:181], v37 offset:768
    ds_read_b64_tr_b16 v[182:183], v37 offset:896
    s_waitcnt lgkmcnt(8)
    v_mfma_f32_16x16x32_bf16 v[208:211], v[184:187], v[48:51], v[208:211]
    v_mfma_f32_16x16x32_bf16 v[216:219], v[184:187], v[112:115], v[216:219]
    v_mfma_f32_16x16x32_bf16 v[212:215], v[188:191], v[48:51], v[212:215]
    v_mfma_f32_16x16x32_bf16 v[220:223], v[188:191], v[112:115], v[220:223]
    ds_read_b64_tr_b16 v[184:185], v36 offset:1024
    ds_read_b64_tr_b16 v[186:187], v36 offset:1152
    ds_read_b64_tr_b16 v[188:189], v37 offset:1024
    ds_read_b64_tr_b16 v[190:191], v37 offset:1152
    s_waitcnt lgkmcnt(8)
    v_mfma_f32_16x16x32_bf16 v[208:211], v[192:195], v[56:59], v[208:211]
    v_mfma_f32_16x16x32_bf16 v[216:219], v[192:195], v[120:123], v[216:219]
    v_mfma_f32_16x16x32_bf16 v[212:215], v[196:199], v[56:59], v[212:215]
    v_mfma_f32_16x16x32_bf16 v[220:223], v[196:199], v[120:123], v[220:223]
    ds_read_b64_tr_b16 v[192:193], v36 offset:1280
    ds_read_b64_tr_b16 v[194:195], v36 offset:1408
    ds_read_b64_tr_b16 v[196:197], v37 offset:1280
    ds_read_b64_tr_b16 v[198:199], v37 offset:1408
    s_waitcnt lgkmcnt(8)
    v_mfma_f32_16x16x32_bf16 v[208:211], v[176:179], v[64:67], v[208:211]
    v_mfma_f32_16x16x32_bf16 v[216:219], v[176:179], v[128:131], v[216:219]
    v_mfma_f32_16x16x32_bf16 v[212:215], v[180:183], v[64:67], v[212:215]
    v_mfma_f32_16x16x32_bf16 v[220:223], v[180:183], v[128:131], v[220:223]
    ds_read_b64_tr_b16 v[176:177], v36 offset:1536
    ds_read_b64_tr_b16 v[178:179], v36 offset:1664
    ds_read_b64_tr_b16 v[180:181], v37 offset:1536
    ds_read_b64_tr_b16 v[182:183], v37 offset:1664
    s_waitcnt lgkmcnt(8)
    v_mfma_f32_16x16x32_bf16 v[208:211], v[184:187], v[72:75], v[208:211]
    v_mfma_f32_16x16x32_bf16 v[216:219], v[184:187], v[136:139], v[216:219]
    v_mfma_f32_16x16x32_bf16 v[212:215], v[188:191], v[72:75], v[212:215]
    v_mfma_f32_16x16x32_bf16 v[220:223], v[188:191], v[136:139], v[220:223]
    ds_read_b64_tr_b16 v[184:185], v36 offset:1792
    ds_read_b64_tr_b16 v[186:187], v36 offset:1920
    ds_read_b64_tr_b16 v[188:189], v37 offset:1792
    ds_read_b64_tr_b16 v[190:191], v37 offset:1920
    s_waitcnt lgkmcnt(8)
    v_mfma_f32_16x16x32_bf16 v[208:211], v[192:195], v[80:83], v[208:211]
    v_mfma_f32_16x16x32_bf16 v[216:219], v[192:195], v[144:147], v[216:219]
    v_mfma_f32_16x16x32_bf16 v[212:215], v[196:199], v[80:83], v[212:215]
    v_mfma_f32_16x16x32_bf16 v[220:223], v[196:199], v[144:147], v[220:223]
    ds_read_b64_tr_b16 v[192:193], v36 offset:2048
    ds_read_b64_tr_b16 v[194:195], v36 offset:2176
    ds_read_b64_tr_b16 v[196:197], v37 offset:2048
    ds_read_b64_tr_b16 v[198:199], v37 offset:2176
    s_waitcnt lgkmcnt(8)
    v_mfma_f32_16x16x32_bf16 v[208:211], v[176:179], v[88:91], v[208:211]
    v_mfma_f32_16x16x32_bf16 v[216:219], v[176:179], v[152:155], v[216:219]
    v_mfma_f32_16x16x32_bf16 v[212:215], v[180:183], v[88:91], v[212:215]
    v_mfma_f32_16x16x32_bf16 v[220:223], v[180:183], v[152:155], v[220:223]
    s_waitcnt lgkmcnt(4)
    v_mfma_f32_16x16x32_bf16 v[208:211], v[184:187], v[96:99], v[208:211]
    v_mfma_f32_16x16x32_bf16 v[216:219], v[184:187], v[160:163], v[216:219]
    v_mfma_f32_16x16x32_bf16 v[212:215], v[188:191], v[96:99], v[212:215]
    v_mfma_f32_16x16x32_bf16 v[220:223], v[188:191], v[160:163], v[220:223]
    s_waitcnt lgkmcnt(0)
    v_mfma_f32_16x16x16_bf16 v[208:211], v[192:193], v[104:105], v[208:211]
    v_mfma_f32_16x16x32_bf16 v[216:219], v[192:195], v[168:171], v[216:219]
    v_mfma_f32_16x16x16_bf16 v[212:215], v[196:197], v[104:105], v[212:215]
    v_mfma_f32_16x16x32_bf16 v[220:223], v[196:199], v[168:171], v[220:223]
    s_mul_i32 s17, s35, 2560
    s_mul_i32 s18, s36, 40
    s_add_u32 s17, s17, s18
    s_add_u32 s17, s17, 68992
    v_mul_u32_u24 v225, 80, v2
    v_lshl_add_u32 v225, v1, 3, v225
    v_add_u32 v225, s17, v225
    v_mov_b32 v3, v212
    v_mov_b32 v4, v212
    s_nop 1
    v_permlane16_swap_b32 v3, v4
    v_mov_b32 v3, v4
    s_nop 1
    v_permlane32_swap_b32 v3, v4
    v_rcp_f32 v3, v3
    s_nop 0
    v_mul_f32 v208, v3, v208
    v_mul_f32 v212, v3, v212
    v_mul_f32 v209, v3, v209
    v_mul_f32 v213, v3, v213
    v_mul_f32 v210, v3, v210
    v_mul_f32 v214, v3, v214
    v_mul_f32 v211, v3, v211
    v_mul_f32 v215, v3, v215
    v_cvt_pk_bf16_f32 v208, v208, v209
    v_cvt_pk_bf16_f32 v209, v210, v211
    v_cvt_pk_bf16_f32 v212, v212, v213
    v_cvt_pk_bf16_f32 v213, v214, v215
    ds_write_b64 v225, v[208:209] offset:0
    s_mov_b64 exec, 0xffff
    ds_write_b64 v225, v[212:213] offset:32
    s_mov_b64 exec, -1
    v_mov_b32 v3, v220
    v_mov_b32 v4, v220
    s_nop 1
    v_permlane16_swap_b32 v3, v4
    v_mov_b32 v3, v4
    s_nop 1
    v_permlane32_swap_b32 v3, v4
    v_rcp_f32 v3, v3
    s_nop 0
    v_mul_f32 v216, v3, v216
    v_mul_f32 v220, v3, v220
    v_mul_f32 v217, v3, v217
    v_mul_f32 v221, v3, v221
    v_mul_f32 v218, v3, v218
    v_mul_f32 v222, v3, v222
    v_mul_f32 v219, v3, v219
    v_mul_f32 v223, v3, v223
    v_cvt_pk_bf16_f32 v216, v216, v217
    v_cvt_pk_bf16_f32 v217, v218, v219
    v_cvt_pk_bf16_f32 v220, v220, v221
    v_cvt_pk_bf16_f32 v221, v222, v223
    ds_write_b64 v225, v[216:217] offset:1280
    s_mov_b64 exec, 0xffff
    ds_write_b64 v225, v[220:221] offset:1312
    s_mov_b64 exec, -1
    s_mul_i32 s17, s16, 1280
    v_lshl_add_u32 v3, v0, 4, s17
    v_add_u32 v4, 68992, v3
    s_mul_i32 s17, s34, 163840
    s_mul_i32 s18, s15, 10240
    s_add_u32 s17, s17, s18
    s_waitcnt lgkmcnt(0)
    s_barrier
    ds_read_b128 v[176:179], v4
    ds_read_b128 v[180:183], v4 offset:1024
    s_waitcnt lgkmcnt(1)
    buffer_store_dwordx4 v[176:179], v3, s[8:11], s17 offen sc1
    s_waitcnt lgkmcnt(0)
    s_mov_b64 exec, 0xffff
    buffer_store_dwordx4 v[180:183], v3, s[8:11], s17 offen offset:1024 sc1
    s_mov_b64 exec, -1
    s_waitcnt vmcnt(0)
    s_barrier
    s_cmp_lg_u32 s80, 0
    s_cbranch_scc1 attn_kernel_sig
    s_waitcnt vmcnt(0)
    v_readfirstlane_b32 s81, v248
    s_nop 0
    s_cmp_eq_u32 s81, 0
    s_cselect_b32 s81, s82, s81
    s_lshl_b32 s17, s15, 4
    s_add_u32 s17, s17, s34
    s_lshl_b32 s17, s17, 3
    s_add_u32 s17, s17, 2048
    v_mov_b32 v3, s17
    v_mov_b32 v244, s81
    v_not_b32 v245, v244
    s_mov_b64 exec, 1
    buffer_store_dwordx2 v[244:245], v3, s[84:87], 0 offen sc1
    s_mov_b64 exec, -1
attn_kernel_sig:
attn_kernel_end:
wo_kernel:
    s_and_b32 s31, s2, 7
    s_lshr_b32 s32, s2, 3
    s_mul_i32 s54, s32, 205
    s_lshr_b32 s54, s54, 10
    s_mul_i32 s55, s54, 5
    s_sub_u32 s55, s32, s55
    s_lshr_b32 s32, s31, 1
    s_mul_i32 s28, s32, 11
    s_add_u32 s56, s28, 12
    s_lshr_b32 s56, s56, 1
    s_add_u32 s28, s28, 1
    s_lshr_b32 s28, s28, 1
    s_add_u32 s28, s28, s54
    s_cmp_ge_u32 s28, s56
    s_cbranch_scc1 wo_kernel_end
    s_and_b32 s29, s31, 1
    s_mul_i32 s29, s29, 5
    s_add_u32 s29, s29, s55
    s_mov_b32 s30, s80
    s_mul_i32 s40, s28, 96
    s_mul_i32 s41, s29, 64
    s_cmp_ge_u32 s30, 4
    s_cbranch_scc1 wo_kernel_loader
    v_lshrrev_b32 v1, 4, v0
    v_and_b32 v2, 15, v0
    s_lshr_b32 s38, s30, 1
    s_and_b32 s39, s30, 1
    s_mul_i32 s31, s38, 6144
    v_lshrrev_b32 v3, 1, v2
    v_lshlrev_b32 v4, 7, v2
    v_add_u32 v4, s31, v4
    v_add_u32 v5, 0, v1
    v_xor_b32 v5, v5, v3
    v_lshl_add_u32 v7, v5, 4, v4
    v_add_u32 v5, 4, v1
    v_xor_b32 v5, v5, v3
    v_lshl_add_u32 v8, v5, 4, v4
    v_lshrrev_b32 v3, 2, v2
    v_and_b32 v4, 1, v1
    v_lshl_add_u32 v3, v4, 2, v3
    v_lshrrev_b32 v4, 1, v1
    v_lshl_add_u32 v4, v4, 4, v3
    v_mul_u32_u24 v4, 128, v4
    v_and_b32 v5, 1, v2
    v_lshl_add_u32 v4, v5, 3, v4
    v_bfe_u32 v5, v2, 1, 1
    v_lshl_add_u32 v4, v5, 4, v4
    v_add_u32 v4, 12288, v4
    v_and_b32 v3, 6, v3
    s_mul_i32 s31, s39, 2
    s_add_u32 s46, s31, 0
    s_lshl_b32 s31, s46, 1
    v_xor_b32 v5, s31, v3
    v_lshl_add_u32 v11, v5, 4, v4
    s_mul_i32 s31, s39, 2
    s_add_u32 s47, s31, 1
    s_lshl_b32 s31, s47, 1
    v_xor_b32 v5, s31, v3
    v_lshl_add_u32 v12, v5, 4, v4
    s_waitcnt lgkmcnt(0)
    s_add_u32 s12, s78, 0xb00000
    s_addc_u32 s13, s79, 0
    s_and_b32 s13, s13, 0xffff
    s_mov_b32 s14, 0x280000
    s_mov_b32 s15, 0x20000
    s_mov_b32 s16, s64
    s_and_b32 s17, s65, 0xffff
    s_mov_b32 s18, 0x280000
    s_mov_b32 s19, 0x20000
    s_mul_i32 s31, s30, 24
    s_add_u32 s31, s31, s40
    v_lshrrev_b32 v3, 3, v0
    v_add_u32 v3, s31, v3
    v_mul_u32_u24 v3, 1280, v3
    v_and_b32 v4, 7, v0
    v_lshl_add_u32 v3, v4, 4, v3
    s_lshl_b32 s31, s41, 1
    v_add_u32 v15, s31, v3
    v_add_u32 v16, 10240, v15
    v_add_u32 v17, 20480, v15
    buffer_load_dwordx4 v[20:23], v15, s[16:19], 0 offen
    buffer_load_dwordx4 v[24:27], v16, s[16:19], 0 offen
    buffer_load_dwordx4 v[28:31], v17, s[16:19], 0 offen
    s_mul_i32 s31, s40, 8193
    s_lshr_b32 s31, s31, 20
    s_add_u32 s32, s40, 95
    s_mul_i32 s32, s32, 8193
    s_lshr_b32 s32, s32, 20
    s_min_u32 s32, s32, 15
    s_cmp_lg_u32 s80, 0
    s_cbranch_scc1 wo_kernel_dep_done
    s_waitcnt vmcnt(0)
    v_readfirstlane_b32 s81, v248
    s_nop 0
    s_cmp_eq_u32 s81, 0
    s_cselect_b32 s81, s82, s81
    v_lshrrev_b32 v3, 4, v0
    v_add_u32 v3, s31, v3
    v_and_b32 v4, 15, v0
    v_cmp_gt_u32 s[42:43], 16, v4
    v_cmp_le_i32 vcc, 0, v3
    s_and_b64 s[42:43], s[42:43], vcc
    v_cmp_ge_i32 vcc, s32, v3
    s_and_b64 s[42:43], s[42:43], vcc
    v_lshl_add_u32 v3, v3, 4, v4
    v_lshlrev_b32 v3, 3, v3
    v_add_u32 v3, 2048, v3
    s_mov_b32 s56, 0
    s_mov_b64 exec, s[42:43]
wo_kernel_dep_loop:
    buffer_load_dwordx2 v[244:245], v3, s[84:87], 0 offen sc1
    s_waitcnt vmcnt(0)
    v_not_b32 v245, v245
    v_xor_b32 v244, s81, v244
    v_xor_b32 v245, s81, v245
    v_or_b32 v244, v244, v245
    v_cmp_ne_u32 vcc, 0, v244
    s_nop 1
    s_cbranch_vccz wo_kernel_dep_ok
    s_sleep 1
    s_add_u32 s56, s56, 1
    s_cmp_lt_u32 s56, 200000
    s_cbranch_scc1 wo_kernel_dep_loop
wo_kernel_dep_ok:
    s_mov_b64 exec, -1
wo_kernel_dep_done:
    s_barrier
    s_barrier
    v_add_u32 v9, 0x0, v7
    v_add_u32 v10, 0x0, v8
    v_add_u32 v13, 0x0, v11
    v_add_u32 v14, 0x0, v12
    ds_read_b128 v[56:59], v9 offset:0
    ds_read_b128 v[60:63], v9 offset:2048
    ds_read_b128 v[64:67], v9 offset:4096
    ds_read_b64_tr_b16 v[104:105], v13 offset:0
    ds_read_b64_tr_b16 v[106:107], v13 offset:1024
    ds_read_b64_tr_b16 v[108:109], v14 offset:0
    ds_read_b64_tr_b16 v[110:111], v14 offset:1024
    ds_read_b128 v[68:71], v10 offset:0
    ds_read_b128 v[72:75], v10 offset:2048
    ds_read_b128 v[76:79], v10 offset:4096
    ds_read_b64_tr_b16 v[112:113], v13 offset:4096
    ds_read_b64_tr_b16 v[114:115], v13 offset:5120
    ds_read_b64_tr_b16 v[116:117], v14 offset:4096
    ds_read_b64_tr_b16 v[118:119], v14 offset:5120
    v_add_u32 v9, 0x5000, v7
    v_add_u32 v10, 0x5000, v8
    v_add_u32 v13, 0x5000, v11
    v_add_u32 v14, 0x5000, v12
    ds_read_b128 v[80:83], v9 offset:0
    ds_read_b128 v[84:87], v9 offset:2048
    ds_read_b128 v[88:91], v9 offset:4096
    ds_read_b64_tr_b16 v[120:121], v13 offset:0
    ds_read_b64_tr_b16 v[122:123], v13 offset:1024
    ds_read_b64_tr_b16 v[124:125], v14 offset:0
    ds_read_b64_tr_b16 v[126:127], v14 offset:1024
    s_waitcnt lgkmcnt(14)
    v_mfma_f32_16x16x32_bf16 v[32:35], v[104:107], v[56:59], 0
    ds_read_b128 v[92:95], v10 offset:0
    ds_read_b128 v[96:99], v10 offset:2048
    v_mfma_f32_16x16x32_bf16 v[40:43], v[104:107], v[60:63], 0
    ds_read_b128 v[100:103], v10 offset:4096
    ds_read_b64_tr_b16 v[128:129], v13 offset:4096
    v_mfma_f32_16x16x32_bf16 v[48:51], v[104:107], v[64:67], 0
    ds_read_b64_tr_b16 v[130:131], v13 offset:5120
    ds_read_b64_tr_b16 v[132:133], v14 offset:4096
    v_mfma_f32_16x16x32_bf16 v[36:39], v[108:111], v[56:59], 0
    ds_read_b64_tr_b16 v[134:135], v14 offset:5120
    v_mfma_f32_16x16x32_bf16 v[44:47], v[108:111], v[60:63], 0
    v_mfma_f32_16x16x32_bf16 v[52:55], v[108:111], v[64:67], 0
    s_waitcnt lgkmcnt(14)
    v_mfma_f32_16x16x32_bf16 v[32:35], v[112:115], v[68:71], v[32:35]
    s_waitcnt lgkmcnt(0)
    s_barrier
    v_mfma_f32_16x16x32_bf16 v[40:43], v[112:115], v[72:75], v[40:43]
    v_add_u32 v9, 0xa000, v7
    v_add_u32 v10, 0xa000, v8
    v_add_u32 v13, 0xa000, v11
    v_add_u32 v14, 0xa000, v12
    v_mfma_f32_16x16x32_bf16 v[48:51], v[112:115], v[76:79], v[48:51]
    ds_read_b128 v[56:59], v9 offset:0
    ds_read_b128 v[60:63], v9 offset:2048
    ds_read_b128 v[64:67], v9 offset:4096
    ds_read_b64_tr_b16 v[104:105], v13 offset:0
    v_mfma_f32_16x16x32_bf16 v[36:39], v[116:119], v[68:71], v[36:39]
    ds_read_b64_tr_b16 v[106:107], v13 offset:1024
    ds_read_b64_tr_b16 v[108:109], v14 offset:0
    ds_read_b64_tr_b16 v[110:111], v14 offset:1024
    v_mfma_f32_16x16x32_bf16 v[44:47], v[116:119], v[72:75], v[44:47]
    v_mfma_f32_16x16x32_bf16 v[52:55], v[116:119], v[76:79], v[52:55]
    s_waitcnt lgkmcnt(14)
    v_mfma_f32_16x16x32_bf16 v[32:35], v[120:123], v[80:83], v[32:35]
    ds_read_b128 v[68:71], v10 offset:0
    ds_read_b128 v[72:75], v10 offset:2048
    v_mfma_f32_16x16x32_bf16 v[40:43], v[120:123], v[84:87], v[40:43]
    ds_read_b128 v[76:79], v10 offset:4096
    ds_read_b64_tr_b16 v[112:113], v13 offset:4096
    v_mfma_f32_16x16x32_bf16 v[48:51], v[120:123], v[88:91], v[48:51]
    ds_read_b64_tr_b16 v[114:115], v13 offset:5120
    ds_read_b64_tr_b16 v[116:117], v14 offset:4096
    v_mfma_f32_16x16x32_bf16 v[36:39], v[124:127], v[80:83], v[36:39]
    ds_read_b64_tr_b16 v[118:119], v14 offset:5120
    v_mfma_f32_16x16x32_bf16 v[44:47], v[124:127], v[84:87], v[44:47]
    v_mfma_f32_16x16x32_bf16 v[52:55], v[124:127], v[88:91], v[52:55]
    s_waitcnt lgkmcnt(14)
    v_mfma_f32_16x16x32_bf16 v[32:35], v[128:131], v[92:95], v[32:35]
    v_add_u32 v9, 0xf000, v7
    v_add_u32 v10, 0xf000, v8
    v_add_u32 v13, 0xf000, v11
    v_mfma_f32_16x16x32_bf16 v[40:43], v[128:131], v[96:99], v[40:43]
    v_add_u32 v14, 0xf000, v12
    ds_read_b128 v[80:83], v9 offset:0
    ds_read_b128 v[84:87], v9 offset:2048
    v_mfma_f32_16x16x32_bf16 v[48:51], v[128:131], v[100:103], v[48:51]
    ds_read_b128 v[88:91], v9 offset:4096
    ds_read_b64_tr_b16 v[120:121], v13 offset:0
    ds_read_b64_tr_b16 v[122:123], v13 offset:1024
    v_mfma_f32_16x16x32_bf16 v[36:39], v[132:135], v[92:95], v[36:39]
    ds_read_b64_tr_b16 v[124:125], v14 offset:0
    ds_read_b64_tr_b16 v[126:127], v14 offset:1024
    v_mfma_f32_16x16x32_bf16 v[44:47], v[132:135], v[96:99], v[44:47]
    v_mfma_f32_16x16x32_bf16 v[52:55], v[132:135], v[100:103], v[52:55]
    s_waitcnt lgkmcnt(14)
    v_mfma_f32_16x16x32_bf16 v[32:35], v[104:107], v[56:59], v[32:35]
    ds_read_b128 v[92:95], v10 offset:0
    ds_read_b128 v[96:99], v10 offset:2048
    v_mfma_f32_16x16x32_bf16 v[40:43], v[104:107], v[60:63], v[40:43]
    ds_read_b128 v[100:103], v10 offset:4096
    ds_read_b64_tr_b16 v[128:129], v13 offset:4096
    v_mfma_f32_16x16x32_bf16 v[48:51], v[104:107], v[64:67], v[48:51]
    ds_read_b64_tr_b16 v[130:131], v13 offset:5120
    ds_read_b64_tr_b16 v[132:133], v14 offset:4096
    v_mfma_f32_16x16x32_bf16 v[36:39], v[108:111], v[56:59], v[36:39]
    ds_read_b64_tr_b16 v[134:135], v14 offset:5120
    v_mfma_f32_16x16x32_bf16 v[44:47], v[108:111], v[60:63], v[44:47]
    v_mfma_f32_16x16x32_bf16 v[52:55], v[108:111], v[64:67], v[52:55]
    s_waitcnt lgkmcnt(14)
    v_mfma_f32_16x16x32_bf16 v[32:35], v[112:115], v[68:71], v[32:35]
    s_waitcnt lgkmcnt(0)
    s_barrier
    v_mfma_f32_16x16x32_bf16 v[40:43], v[112:115], v[72:75], v[40:43]
    v_add_u32 v9, 0x14000, v7
    v_add_u32 v10, 0x14000, v8
    v_add_u32 v13, 0x14000, v11
    v_add_u32 v14, 0x14000, v12
    v_mfma_f32_16x16x32_bf16 v[48:51], v[112:115], v[76:79], v[48:51]
    ds_read_b128 v[56:59], v9 offset:0
    ds_read_b128 v[60:63], v9 offset:2048
    ds_read_b128 v[64:67], v9 offset:4096
    ds_read_b64_tr_b16 v[104:105], v13 offset:0
    v_mfma_f32_16x16x32_bf16 v[36:39], v[116:119], v[68:71], v[36:39]
    ds_read_b64_tr_b16 v[106:107], v13 offset:1024
    ds_read_b64_tr_b16 v[108:109], v14 offset:0
    ds_read_b64_tr_b16 v[110:111], v14 offset:1024
    v_mfma_f32_16x16x32_bf16 v[44:47], v[116:119], v[72:75], v[44:47]
    v_mfma_f32_16x16x32_bf16 v[52:55], v[116:119], v[76:79], v[52:55]
    s_waitcnt lgkmcnt(14)
    v_mfma_f32_16x16x32_bf16 v[32:35], v[120:123], v[80:83], v[32:35]
    ds_read_b128 v[68:71], v10 offset:0
    ds_read_b128 v[72:75], v10 offset:2048
    v_mfma_f32_16x16x32_bf16 v[40:43], v[120:123], v[84:87], v[40:43]
    ds_read_b128 v[76:79], v10 offset:4096
    ds_read_b64_tr_b16 v[112:113], v13 offset:4096
    v_mfma_f32_16x16x32_bf16 v[48:51], v[120:123], v[88:91], v[48:51]
    ds_read_b64_tr_b16 v[114:115], v13 offset:5120
    ds_read_b64_tr_b16 v[116:117], v14 offset:4096
    v_mfma_f32_16x16x32_bf16 v[36:39], v[124:127], v[80:83], v[36:39]
    ds_read_b64_tr_b16 v[118:119], v14 offset:5120
    v_mfma_f32_16x16x32_bf16 v[44:47], v[124:127], v[84:87], v[44:47]
    v_mfma_f32_16x16x32_bf16 v[52:55], v[124:127], v[88:91], v[52:55]
    s_waitcnt lgkmcnt(14)
    v_mfma_f32_16x16x32_bf16 v[32:35], v[128:131], v[92:95], v[32:35]
    v_add_u32 v9, 0x19000, v7
    v_add_u32 v10, 0x19000, v8
    v_add_u32 v13, 0x19000, v11
    v_mfma_f32_16x16x32_bf16 v[40:43], v[128:131], v[96:99], v[40:43]
    v_add_u32 v14, 0x19000, v12
    ds_read_b128 v[80:83], v9 offset:0
    ds_read_b128 v[84:87], v9 offset:2048
    v_mfma_f32_16x16x32_bf16 v[48:51], v[128:131], v[100:103], v[48:51]
    ds_read_b128 v[88:91], v9 offset:4096
    ds_read_b64_tr_b16 v[120:121], v13 offset:0
    ds_read_b64_tr_b16 v[122:123], v13 offset:1024
    v_mfma_f32_16x16x32_bf16 v[36:39], v[132:135], v[92:95], v[36:39]
    ds_read_b64_tr_b16 v[124:125], v14 offset:0
    ds_read_b64_tr_b16 v[126:127], v14 offset:1024
    v_mfma_f32_16x16x32_bf16 v[44:47], v[132:135], v[96:99], v[44:47]
    v_mfma_f32_16x16x32_bf16 v[52:55], v[132:135], v[100:103], v[52:55]
    s_waitcnt lgkmcnt(14)
    v_mfma_f32_16x16x32_bf16 v[32:35], v[104:107], v[56:59], v[32:35]
    ds_read_b128 v[92:95], v10 offset:0
    ds_read_b128 v[96:99], v10 offset:2048
    v_mfma_f32_16x16x32_bf16 v[40:43], v[104:107], v[60:63], v[40:43]
    ds_read_b128 v[100:103], v10 offset:4096
    ds_read_b64_tr_b16 v[128:129], v13 offset:4096
    v_mfma_f32_16x16x32_bf16 v[48:51], v[104:107], v[64:67], v[48:51]
    ds_read_b64_tr_b16 v[130:131], v13 offset:5120
    ds_read_b64_tr_b16 v[132:133], v14 offset:4096
    v_mfma_f32_16x16x32_bf16 v[36:39], v[108:111], v[56:59], v[36:39]
    ds_read_b64_tr_b16 v[134:135], v14 offset:5120
    v_mfma_f32_16x16x32_bf16 v[44:47], v[108:111], v[60:63], v[44:47]
    v_mfma_f32_16x16x32_bf16 v[52:55], v[108:111], v[64:67], v[52:55]
    s_waitcnt lgkmcnt(14)
    v_mfma_f32_16x16x32_bf16 v[32:35], v[112:115], v[68:71], v[32:35]
    s_waitcnt lgkmcnt(0)
    s_barrier
    v_mfma_f32_16x16x32_bf16 v[40:43], v[112:115], v[72:75], v[40:43]
    v_add_u32 v9, 0x1e000, v7
    v_add_u32 v10, 0x1e000, v8
    v_add_u32 v13, 0x1e000, v11
    v_add_u32 v14, 0x1e000, v12
    v_mfma_f32_16x16x32_bf16 v[48:51], v[112:115], v[76:79], v[48:51]
    ds_read_b128 v[56:59], v9 offset:0
    ds_read_b128 v[60:63], v9 offset:2048
    ds_read_b128 v[64:67], v9 offset:4096
    ds_read_b64_tr_b16 v[104:105], v13 offset:0
    v_mfma_f32_16x16x32_bf16 v[36:39], v[116:119], v[68:71], v[36:39]
    ds_read_b64_tr_b16 v[106:107], v13 offset:1024
    ds_read_b64_tr_b16 v[108:109], v14 offset:0
    ds_read_b64_tr_b16 v[110:111], v14 offset:1024
    v_mfma_f32_16x16x32_bf16 v[44:47], v[116:119], v[72:75], v[44:47]
    v_mfma_f32_16x16x32_bf16 v[52:55], v[116:119], v[76:79], v[52:55]
    s_waitcnt lgkmcnt(14)
    v_mfma_f32_16x16x32_bf16 v[32:35], v[120:123], v[80:83], v[32:35]
    ds_read_b128 v[68:71], v10 offset:0
    ds_read_b128 v[72:75], v10 offset:2048
    v_mfma_f32_16x16x32_bf16 v[40:43], v[120:123], v[84:87], v[40:43]
    ds_read_b128 v[76:79], v10 offset:4096
    ds_read_b64_tr_b16 v[112:113], v13 offset:4096
    v_mfma_f32_16x16x32_bf16 v[48:51], v[120:123], v[88:91], v[48:51]
    ds_read_b64_tr_b16 v[114:115], v13 offset:5120
    ds_read_b64_tr_b16 v[116:117], v14 offset:4096
    v_mfma_f32_16x16x32_bf16 v[36:39], v[124:127], v[80:83], v[36:39]
    ds_read_b64_tr_b16 v[118:119], v14 offset:5120
    v_mfma_f32_16x16x32_bf16 v[44:47], v[124:127], v[84:87], v[44:47]
    v_mfma_f32_16x16x32_bf16 v[52:55], v[124:127], v[88:91], v[52:55]
    s_waitcnt lgkmcnt(14)
    v_mfma_f32_16x16x32_bf16 v[32:35], v[128:131], v[92:95], v[32:35]
    v_add_u32 v9, 0x23000, v7
    v_add_u32 v10, 0x23000, v8
    v_add_u32 v13, 0x23000, v11
    v_mfma_f32_16x16x32_bf16 v[40:43], v[128:131], v[96:99], v[40:43]
    v_add_u32 v14, 0x23000, v12
    ds_read_b128 v[80:83], v9 offset:0
    ds_read_b128 v[84:87], v9 offset:2048
    v_mfma_f32_16x16x32_bf16 v[48:51], v[128:131], v[100:103], v[48:51]
    ds_read_b128 v[88:91], v9 offset:4096
    ds_read_b64_tr_b16 v[120:121], v13 offset:0
    ds_read_b64_tr_b16 v[122:123], v13 offset:1024
    v_mfma_f32_16x16x32_bf16 v[36:39], v[132:135], v[92:95], v[36:39]
    ds_read_b64_tr_b16 v[124:125], v14 offset:0
    ds_read_b64_tr_b16 v[126:127], v14 offset:1024
    v_mfma_f32_16x16x32_bf16 v[44:47], v[132:135], v[96:99], v[44:47]
    v_mfma_f32_16x16x32_bf16 v[52:55], v[132:135], v[100:103], v[52:55]
    s_waitcnt lgkmcnt(14)
    v_mfma_f32_16x16x32_bf16 v[32:35], v[104:107], v[56:59], v[32:35]
    ds_read_b128 v[92:95], v10 offset:0
    ds_read_b128 v[96:99], v10 offset:2048
    v_mfma_f32_16x16x32_bf16 v[40:43], v[104:107], v[60:63], v[40:43]
    ds_read_b128 v[100:103], v10 offset:4096
    ds_read_b64_tr_b16 v[128:129], v13 offset:4096
    v_mfma_f32_16x16x32_bf16 v[48:51], v[104:107], v[64:67], v[48:51]
    ds_read_b64_tr_b16 v[130:131], v13 offset:5120
    ds_read_b64_tr_b16 v[132:133], v14 offset:4096
    v_mfma_f32_16x16x32_bf16 v[36:39], v[108:111], v[56:59], v[36:39]
    ds_read_b64_tr_b16 v[134:135], v14 offset:5120
    v_mfma_f32_16x16x32_bf16 v[44:47], v[108:111], v[60:63], v[44:47]
    v_mfma_f32_16x16x32_bf16 v[52:55], v[108:111], v[64:67], v[52:55]
    s_waitcnt lgkmcnt(14)
    v_mfma_f32_16x16x32_bf16 v[32:35], v[112:115], v[68:71], v[32:35]
    s_waitcnt lgkmcnt(0)
    s_barrier
    v_mfma_f32_16x16x32_bf16 v[40:43], v[112:115], v[72:75], v[40:43]
    v_add_u32 v9, 0x0, v7
    v_add_u32 v10, 0x0, v8
    v_add_u32 v13, 0x0, v11
    v_add_u32 v14, 0x0, v12
    v_mfma_f32_16x16x32_bf16 v[48:51], v[112:115], v[76:79], v[48:51]
    ds_read_b128 v[56:59], v9 offset:0
    ds_read_b128 v[60:63], v9 offset:2048
    ds_read_b128 v[64:67], v9 offset:4096
    ds_read_b64_tr_b16 v[104:105], v13 offset:0
    v_mfma_f32_16x16x32_bf16 v[36:39], v[116:119], v[68:71], v[36:39]
    ds_read_b64_tr_b16 v[106:107], v13 offset:1024
    ds_read_b64_tr_b16 v[108:109], v14 offset:0
    ds_read_b64_tr_b16 v[110:111], v14 offset:1024
    v_mfma_f32_16x16x32_bf16 v[44:47], v[116:119], v[72:75], v[44:47]
    v_mfma_f32_16x16x32_bf16 v[52:55], v[116:119], v[76:79], v[52:55]
    s_waitcnt lgkmcnt(14)
    v_mfma_f32_16x16x32_bf16 v[32:35], v[120:123], v[80:83], v[32:35]
    ds_read_b128 v[68:71], v10 offset:0
    ds_read_b128 v[72:75], v10 offset:2048
    v_mfma_f32_16x16x32_bf16 v[40:43], v[120:123], v[84:87], v[40:43]
    ds_read_b128 v[76:79], v10 offset:4096
    ds_read_b64_tr_b16 v[112:113], v13 offset:4096
    v_mfma_f32_16x16x32_bf16 v[48:51], v[120:123], v[88:91], v[48:51]
    ds_read_b64_tr_b16 v[114:115], v13 offset:5120
    ds_read_b64_tr_b16 v[116:117], v14 offset:4096
    v_mfma_f32_16x16x32_bf16 v[36:39], v[124:127], v[80:83], v[36:39]
    ds_read_b64_tr_b16 v[118:119], v14 offset:5120
    v_mfma_f32_16x16x32_bf16 v[44:47], v[124:127], v[84:87], v[44:47]
    v_mfma_f32_16x16x32_bf16 v[52:55], v[124:127], v[88:91], v[52:55]
    s_waitcnt lgkmcnt(14)
    v_mfma_f32_16x16x32_bf16 v[32:35], v[128:131], v[92:95], v[32:35]
    v_add_u32 v9, 0x5000, v7
    v_add_u32 v10, 0x5000, v8
    v_add_u32 v13, 0x5000, v11
    v_mfma_f32_16x16x32_bf16 v[40:43], v[128:131], v[96:99], v[40:43]
    v_add_u32 v14, 0x5000, v12
    ds_read_b128 v[80:83], v9 offset:0
    ds_read_b128 v[84:87], v9 offset:2048
    v_mfma_f32_16x16x32_bf16 v[48:51], v[128:131], v[100:103], v[48:51]
    ds_read_b128 v[88:91], v9 offset:4096
    ds_read_b64_tr_b16 v[120:121], v13 offset:0
    ds_read_b64_tr_b16 v[122:123], v13 offset:1024
    v_mfma_f32_16x16x32_bf16 v[36:39], v[132:135], v[92:95], v[36:39]
    ds_read_b64_tr_b16 v[124:125], v14 offset:0
    ds_read_b64_tr_b16 v[126:127], v14 offset:1024
    v_mfma_f32_16x16x32_bf16 v[44:47], v[132:135], v[96:99], v[44:47]
    v_mfma_f32_16x16x32_bf16 v[52:55], v[132:135], v[100:103], v[52:55]
    s_waitcnt lgkmcnt(14)
    v_mfma_f32_16x16x32_bf16 v[32:35], v[104:107], v[56:59], v[32:35]
    ds_read_b128 v[92:95], v10 offset:0
    ds_read_b128 v[96:99], v10 offset:2048
    v_mfma_f32_16x16x32_bf16 v[40:43], v[104:107], v[60:63], v[40:43]
    ds_read_b128 v[100:103], v10 offset:4096
    ds_read_b64_tr_b16 v[128:129], v13 offset:4096
    v_mfma_f32_16x16x32_bf16 v[48:51], v[104:107], v[64:67], v[48:51]
    ds_read_b64_tr_b16 v[130:131], v13 offset:5120
    ds_read_b64_tr_b16 v[132:133], v14 offset:4096
    v_mfma_f32_16x16x32_bf16 v[36:39], v[108:111], v[56:59], v[36:39]
    ds_read_b64_tr_b16 v[134:135], v14 offset:5120
    v_mfma_f32_16x16x32_bf16 v[44:47], v[108:111], v[60:63], v[44:47]
    v_mfma_f32_16x16x32_bf16 v[52:55], v[108:111], v[64:67], v[52:55]
    s_waitcnt lgkmcnt(14)
    v_mfma_f32_16x16x32_bf16 v[32:35], v[112:115], v[68:71], v[32:35]
    v_mfma_f32_16x16x32_bf16 v[40:43], v[112:115], v[72:75], v[40:43]
    v_mfma_f32_16x16x32_bf16 v[48:51], v[112:115], v[76:79], v[48:51]
    v_mfma_f32_16x16x32_bf16 v[36:39], v[116:119], v[68:71], v[36:39]
    v_mfma_f32_16x16x32_bf16 v[44:47], v[116:119], v[72:75], v[44:47]
    v_mfma_f32_16x16x32_bf16 v[52:55], v[116:119], v[76:79], v[52:55]
    s_waitcnt lgkmcnt(7)
    v_mfma_f32_16x16x32_bf16 v[32:35], v[120:123], v[80:83], v[32:35]
    v_mfma_f32_16x16x32_bf16 v[40:43], v[120:123], v[84:87], v[40:43]
    v_mfma_f32_16x16x32_bf16 v[48:51], v[120:123], v[88:91], v[48:51]
    v_mfma_f32_16x16x32_bf16 v[36:39], v[124:127], v[80:83], v[36:39]
    v_mfma_f32_16x16x32_bf16 v[44:47], v[124:127], v[84:87], v[44:47]
    v_mfma_f32_16x16x32_bf16 v[52:55], v[124:127], v[88:91], v[52:55]
    s_waitcnt lgkmcnt(0)
    v_mfma_f32_16x16x32_bf16 v[32:35], v[128:131], v[92:95], v[32:35]
    v_mfma_f32_16x16x32_bf16 v[40:43], v[128:131], v[96:99], v[40:43]
    v_mfma_f32_16x16x32_bf16 v[48:51], v[128:131], v[100:103], v[48:51]
    v_mfma_f32_16x16x32_bf16 v[36:39], v[132:135], v[92:95], v[36:39]
    v_mfma_f32_16x16x32_bf16 v[44:47], v[132:135], v[96:99], v[44:47]
    v_mfma_f32_16x16x32_bf16 v[52:55], v[132:135], v[100:103], v[52:55]
    s_mul_i32 s31, s38, 6912
    s_mul_i32 s32, s39, 64
    s_add_u32 s31, s31, s32
    s_add_u32 s31, s31, 0xa000
    v_mul_u32_u24 v136, 144, v2
    v_lshl_add_u32 v136, v1, 3, v136
    v_add_u32 v136, s31, v136
    v_cvt_pk_bf16_f32 v32, v32, v33
    v_cvt_pk_bf16_f32 v33, v34, v35
    ds_write_b64 v136, v[32:33] offset:0
    v_cvt_pk_bf16_f32 v40, v40, v41
    v_cvt_pk_bf16_f32 v41, v42, v43
    ds_write_b64 v136, v[40:41] offset:2304
    v_cvt_pk_bf16_f32 v48, v48, v49
    v_cvt_pk_bf16_f32 v49, v50, v51
    ds_write_b64 v136, v[48:49] offset:4608
    v_cvt_pk_bf16_f32 v36, v36, v37
    v_cvt_pk_bf16_f32 v37, v38, v39
    ds_write_b64 v136, v[36:37] offset:32
    v_cvt_pk_bf16_f32 v44, v44, v45
    v_cvt_pk_bf16_f32 v45, v46, v47
    ds_write_b64 v136, v[44:45] offset:2336
    v_cvt_pk_bf16_f32 v52, v52, v53
    v_cvt_pk_bf16_f32 v53, v54, v55
    ds_write_b64 v136, v[52:53] offset:4640
    s_mul_i32 s31, s30, 3456
    s_add_u32 s31, s31, 0xa000
    v_lshrrev_b32 v137, 3, v0
    v_mul_u32_u24 v137, 144, v137
    v_and_b32 v3, 7, v0
    v_lshl_add_u32 v137, v3, 4, v137
    v_add_u32 v137, s31, v137
    s_mov_b32 s31, 0xffff0000
    s_waitcnt lgkmcnt(0)
    s_barrier
    ds_read_b128 v[56:59], v137 offset:0
    ds_read_b128 v[60:63], v137 offset:1152
    ds_read_b128 v[68:71], v137 offset:2304
    s_waitcnt vmcnt(0)
    s_waitcnt lgkmcnt(2)
    v_lshlrev_b32 v3, 16, v56
    v_and_b32 v4, s31, v56
    v_lshlrev_b32 v5, 16, v20
    v_and_b32 v6, s31, v20
    v_add_f32 v3, v3, v5
    v_add_f32 v4, v4, v6
    v_cvt_pk_bf16_f32 v56, v3, v4
    v_lshlrev_b32 v3, 16, v57
    v_and_b32 v4, s31, v57
    v_lshlrev_b32 v5, 16, v21
    v_and_b32 v6, s31, v21
    v_add_f32 v3, v3, v5
    v_add_f32 v4, v4, v6
    v_cvt_pk_bf16_f32 v57, v3, v4
    v_lshlrev_b32 v3, 16, v58
    v_and_b32 v4, s31, v58
    v_lshlrev_b32 v5, 16, v22
    v_and_b32 v6, s31, v22
    v_add_f32 v3, v3, v5
    v_add_f32 v4, v4, v6
    v_cvt_pk_bf16_f32 v58, v3, v4
    v_lshlrev_b32 v3, 16, v59
    v_and_b32 v4, s31, v59
    v_lshlrev_b32 v5, 16, v23
    v_and_b32 v6, s31, v23
    v_add_f32 v3, v3, v5
    v_add_f32 v4, v4, v6
    v_cvt_pk_bf16_f32 v59, v3, v4
    buffer_store_dwordx4 v[56:59], v15, s[12:15], 0 offen sc1
    s_waitcnt lgkmcnt(1)
    v_lshlrev_b32 v3, 16, v60
    v_and_b32 v4, s31, v60
    v_lshlrev_b32 v5, 16, v24
    v_and_b32 v6, s31, v24
    v_add_f32 v3, v3, v5
    v_add_f32 v4, v4, v6
    v_cvt_pk_bf16_f32 v60, v3, v4
    v_lshlrev_b32 v3, 16, v61
    v_and_b32 v4, s31, v61
    v_lshlrev_b32 v5, 16, v25
    v_and_b32 v6, s31, v25
    v_add_f32 v3, v3, v5
    v_add_f32 v4, v4, v6
    v_cvt_pk_bf16_f32 v61, v3, v4
    v_lshlrev_b32 v3, 16, v62
    v_and_b32 v4, s31, v62
    v_lshlrev_b32 v5, 16, v26
    v_and_b32 v6, s31, v26
    v_add_f32 v3, v3, v5
    v_add_f32 v4, v4, v6
    v_cvt_pk_bf16_f32 v62, v3, v4
    v_lshlrev_b32 v3, 16, v63
    v_and_b32 v4, s31, v63
    v_lshlrev_b32 v5, 16, v27
    v_and_b32 v6, s31, v27
    v_add_f32 v3, v3, v5
    v_add_f32 v4, v4, v6
    v_cvt_pk_bf16_f32 v63, v3, v4
    buffer_store_dwordx4 v[60:63], v16, s[12:15], 0 offen sc1
    s_waitcnt lgkmcnt(0)
    v_lshlrev_b32 v3, 16, v68
    v_and_b32 v4, s31, v68
    v_lshlrev_b32 v5, 16, v28
    v_and_b32 v6, s31, v28
    v_add_f32 v3, v3, v5
    v_add_f32 v4, v4, v6
    v_cvt_pk_bf16_f32 v68, v3, v4
    v_lshlrev_b32 v3, 16, v69
    v_and_b32 v4, s31, v69
    v_lshlrev_b32 v5, 16, v29
    v_and_b32 v6, s31, v29
    v_add_f32 v3, v3, v5
    v_add_f32 v4, v4, v6
    v_cvt_pk_bf16_f32 v69, v3, v4
    v_lshlrev_b32 v3, 16, v70
    v_and_b32 v4, s31, v70
    v_lshlrev_b32 v5, 16, v30
    v_and_b32 v6, s31, v30
    v_add_f32 v3, v3, v5
    v_add_f32 v4, v4, v6
    v_cvt_pk_bf16_f32 v70, v3, v4
    v_lshlrev_b32 v3, 16, v71
    v_and_b32 v4, s31, v71
    v_lshlrev_b32 v5, 16, v31
    v_and_b32 v6, s31, v31
    v_add_f32 v3, v3, v5
    v_add_f32 v4, v4, v6
    v_cvt_pk_bf16_f32 v71, v3, v4
    buffer_store_dwordx4 v[68:71], v17, s[12:15], 0 offen sc1
    s_waitcnt vmcnt(0)
    s_barrier
    s_cmp_lg_u32 s80, 0
    s_cbranch_scc1 wo_kernel_sig
    s_waitcnt vmcnt(0)
    v_readfirstlane_b32 s81, v248
    s_nop 0
    s_cmp_eq_u32 s81, 0
    s_cselect_b32 s81, s82, s81
    s_lshl_b32 s31, s28, 4
    s_add_u32 s31, s31, s29
    s_lshl_b32 s31, s31, 3
    s_add_u32 s31, s31, 4096
    v_mov_b32 v3, s31
    v_mov_b32 v244, s81
    v_not_b32 v245, v244
    s_mov_b64 exec, 1
    buffer_store_dwordx2 v[244:245], v3, s[84:87], 0 offen sc1
    s_mov_b64 exec, -1
wo_kernel_sig:
    s_branch wo_kernel_end
wo_kernel_loader:
    s_setprio 1
    s_sub_u32 s30, s30, 4
    v_lshrrev_b32 v5, 3, v0
    v_and_b32 v6, 7, v0
    s_mul_i32 s31, s30, 24
    s_add_u32 s32, s31, 0
    v_add_u32 v1, s32, v5
    v_bfe_u32 v2, v1, 1, 3
    v_xor_b32 v2, v2, v6
    v_add_u32 v1, s40, v1
    v_mul_u32_u24 v7, 80, v1
    v_mov_b32 v10, v2
    s_add_u32 s32, s31, 8
    v_add_u32 v1, s32, v5
    v_bfe_u32 v2, v1, 1, 3
    v_xor_b32 v2, v2, v6
    v_add_u32 v1, s40, v1
    v_mul_u32_u24 v8, 80, v1
    v_mov_b32 v11, v2
    s_add_u32 s32, s31, 16
    v_add_u32 v1, s32, v5
    v_bfe_u32 v2, v1, 1, 3
    v_xor_b32 v2, v2, v6
    v_add_u32 v1, s40, v1
    v_mul_u32_u24 v9, 80, v1
    v_mov_b32 v12, v2
    s_lshl_b32 s31, s30, 4
    s_lshl_b32 s32, s41, 1
    v_add_u32 v1, 0, v0
    v_lshrrev_b32 v2, 3, v1
    v_and_b32 v1, 7, v1
    v_and_b32 v3, 6, v2
    v_xor_b32 v1, v1, v3
    v_and_b32 v3, 3, v2
    v_bfe_u32 v4, v2, 3, 1
    v_lshl_add_u32 v3, v4, 2, v3
    v_bfe_u32 v4, v2, 2, 1
    v_lshl_add_u32 v3, v4, 3, v3
    v_add_u32 v3, s31, v3
    v_mul_u32_u24 v3, 1280, v3
    v_lshl_add_u32 v3, v1, 4, v3
    v_add_u32 v16, s32, v3
    v_add_u32 v1, 64, v0
    v_lshrrev_b32 v2, 3, v1
    v_and_b32 v1, 7, v1
    v_and_b32 v3, 6, v2
    v_xor_b32 v1, v1, v3
    v_and_b32 v3, 3, v2
    v_bfe_u32 v4, v2, 3, 1
    v_lshl_add_u32 v3, v4, 2, v3
    v_bfe_u32 v4, v2, 2, 1
    v_lshl_add_u32 v3, v4, 3, v3
    v_add_u32 v3, s31, v3
    v_mul_u32_u24 v3, 1280, v3
    v_lshl_add_u32 v3, v1, 4, v3
    v_add_u32 v17, s32, v3
    s_mul_i32 s35, s30, 3072
    s_mul_i32 s36, s30, 2048
    s_mul_i32 s54, s54, 0
    s_mul_i32 s55, s55, 0
    s_add_u32 s37, s54, s55
    s_lshl_b32 s33, s37, 7
    s_mul_i32 s34, s37, 81920
    s_waitcnt lgkmcnt(0)
    s_add_u32 s4, s78, 0x800000
    s_addc_u32 s5, s79, 0
    s_and_b32 s5, s5, 0xffff
    s_mov_b32 s6, 0x280000
    s_mov_b32 s7, 0x20000
    s_mov_b32 s8, s68
    s_and_b32 s9, s69, 0xffff
    s_mov_b32 s10, 0xc8000
    s_mov_b32 s11, 0x20000
    s_add_u32 m0, s36, 0x3000
    s_nop 0
    buffer_load_dwordx4 v16, s[8:11], s34 offen lds
    s_add_u32 m0, s36, 0x3400
    s_nop 0
    buffer_load_dwordx4 v17, s[8:11], s34 offen lds
    s_add_u32 s34, s34, 81920
    s_cmp_eq_u32 s34, 819200
    s_cselect_b32 s34, 0, s34
    s_add_u32 m0, s36, 0x8000
    s_nop 0
    buffer_load_dwordx4 v16, s[8:11], s34 offen lds
    s_add_u32 m0, s36, 0x8400
    s_nop 0
    buffer_load_dwordx4 v17, s[8:11], s34 offen lds
    s_add_u32 s34, s34, 81920
    s_cmp_eq_u32 s34, 819200
    s_cselect_b32 s34, 0, s34
    s_add_u32 m0, s36, 0xd000
    s_nop 0
    buffer_load_dwordx4 v16, s[8:11], s34 offen lds
    s_add_u32 m0, s36, 0xd400
    s_nop 0
    buffer_load_dwordx4 v17, s[8:11], s34 offen lds
    s_add_u32 s34, s34, 81920
    s_cmp_eq_u32 s34, 819200
    s_cselect_b32 s34, 0, s34
    s_add_u32 m0, s36, 0x12000
    s_nop 0
    buffer_load_dwordx4 v16, s[8:11], s34 offen lds
    s_add_u32 m0, s36, 0x12400
    s_nop 0
    buffer_load_dwordx4 v17, s[8:11], s34 offen lds
    s_add_u32 s34, s34, 81920
    s_cmp_eq_u32 s34, 819200
    s_cselect_b32 s34, 0, s34
    s_add_u32 m0, s36, 0x17000
    s_nop 0
    buffer_load_dwordx4 v16, s[8:11], s34 offen lds
    s_add_u32 m0, s36, 0x17400
    s_nop 0
    buffer_load_dwordx4 v17, s[8:11], s34 offen lds
    s_add_u32 s34, s34, 81920
    s_cmp_eq_u32 s34, 819200
    s_cselect_b32 s34, 0, s34
    s_add_u32 m0, s36, 0x1c000
    s_nop 0
    buffer_load_dwordx4 v16, s[8:11], s34 offen lds
    s_add_u32 m0, s36, 0x1c400
    s_nop 0
    buffer_load_dwordx4 v17, s[8:11], s34 offen lds
    s_add_u32 s34, s34, 81920
    s_cmp_eq_u32 s34, 819200
    s_cselect_b32 s34, 0, s34
    s_barrier
    s_lshr_b32 s31, s33, 4
    v_add_u32 v1, s31, v10
    v_mul_u32_u24 v2, 205, v1
    v_lshrrev_b32 v2, 10, v2
    v_mul_u32_u24 v3, 5, v2
    v_sub_u32 v1, v1, v3
    v_mul_u32_u24 v2, 163840, v2
    v_lshl_add_u32 v2, v1, 4, v2
    v_add_u32 v13, v2, v7
    s_add_u32 m0, s35, 0x0
    s_nop 0
    buffer_load_dwordx4 v13, s[4:7], 0 offen sc1 lds
    s_lshr_b32 s31, s33, 4
    v_add_u32 v1, s31, v11
    v_mul_u32_u24 v2, 205, v1
    v_lshrrev_b32 v2, 10, v2
    v_mul_u32_u24 v3, 5, v2
    v_sub_u32 v1, v1, v3
    v_mul_u32_u24 v2, 163840, v2
    v_lshl_add_u32 v2, v1, 4, v2
    v_add_u32 v14, v2, v8
    s_add_u32 m0, s35, 0x400
    s_nop 0
    buffer_load_dwordx4 v14, s[4:7], 0 offen sc1 lds
    s_lshr_b32 s31, s33, 4
    v_add_u32 v1, s31, v12
    v_mul_u32_u24 v2, 205, v1
    v_lshrrev_b32 v2, 10, v2
    v_mul_u32_u24 v3, 5, v2
    v_sub_u32 v1, v1, v3
    v_mul_u32_u24 v2, 163840, v2
    v_lshl_add_u32 v2, v1, 4, v2
    v_add_u32 v15, v2, v9
    s_add_u32 m0, s35, 0x800
    s_nop 0
    buffer_load_dwordx4 v15, s[4:7], 0 offen sc1 lds
    s_add_u32 s33, s33, 128
    s_cmp_eq_u32 s33, 1280
    s_cselect_b32 s33, 0, s33
    s_lshr_b32 s31, s33, 4
    v_add_u32 v1, s31, v10
    v_mul_u32_u24 v2, 205, v1
    v_lshrrev_b32 v2, 10, v2
    v_mul_u32_u24 v3, 5, v2
    v_sub_u32 v1, v1, v3
    v_mul_u32_u24 v2, 163840, v2
    v_lshl_add_u32 v2, v1, 4, v2
    v_add_u32 v13, v2, v7
    s_add_u32 m0, s35, 0x5000
    s_nop 0
    buffer_load_dwordx4 v13, s[4:7], 0 offen sc1 lds
    s_lshr_b32 s31, s33, 4
    v_add_u32 v1, s31, v11
    v_mul_u32_u24 v2, 205, v1
    v_lshrrev_b32 v2, 10, v2
    v_mul_u32_u24 v3, 5, v2
    v_sub_u32 v1, v1, v3
    v_mul_u32_u24 v2, 163840, v2
    v_lshl_add_u32 v2, v1, 4, v2
    v_add_u32 v14, v2, v8
    s_add_u32 m0, s35, 0x5400
    s_nop 0
    buffer_load_dwordx4 v14, s[4:7], 0 offen sc1 lds
    s_lshr_b32 s31, s33, 4
    v_add_u32 v1, s31, v12
    v_mul_u32_u24 v2, 205, v1
    v_lshrrev_b32 v2, 10, v2
    v_mul_u32_u24 v3, 5, v2
    v_sub_u32 v1, v1, v3
    v_mul_u32_u24 v2, 163840, v2
    v_lshl_add_u32 v2, v1, 4, v2
    v_add_u32 v15, v2, v9
    s_add_u32 m0, s35, 0x5800
    s_nop 0
    buffer_load_dwordx4 v15, s[4:7], 0 offen sc1 lds
    s_add_u32 s33, s33, 128
    s_cmp_eq_u32 s33, 1280
    s_cselect_b32 s33, 0, s33
    s_lshr_b32 s31, s33, 4
    v_add_u32 v1, s31, v10
    v_mul_u32_u24 v2, 205, v1
    v_lshrrev_b32 v2, 10, v2
    v_mul_u32_u24 v3, 5, v2
    v_sub_u32 v1, v1, v3
    v_mul_u32_u24 v2, 163840, v2
    v_lshl_add_u32 v2, v1, 4, v2
    v_add_u32 v13, v2, v7
    s_add_u32 m0, s35, 0xa000
    s_nop 0
    buffer_load_dwordx4 v13, s[4:7], 0 offen sc1 lds
    s_lshr_b32 s31, s33, 4
    v_add_u32 v1, s31, v11
    v_mul_u32_u24 v2, 205, v1
    v_lshrrev_b32 v2, 10, v2
    v_mul_u32_u24 v3, 5, v2
    v_sub_u32 v1, v1, v3
    v_mul_u32_u24 v2, 163840, v2
    v_lshl_add_u32 v2, v1, 4, v2
    v_add_u32 v14, v2, v8
    s_add_u32 m0, s35, 0xa400
    s_nop 0
    buffer_load_dwordx4 v14, s[4:7], 0 offen sc1 lds
    s_lshr_b32 s31, s33, 4
    v_add_u32 v1, s31, v12
    v_mul_u32_u24 v2, 205, v1
    v_lshrrev_b32 v2, 10, v2
    v_mul_u32_u24 v3, 5, v2
    v_sub_u32 v1, v1, v3
    v_mul_u32_u24 v2, 163840, v2
    v_lshl_add_u32 v2, v1, 4, v2
    v_add_u32 v15, v2, v9
    s_add_u32 m0, s35, 0xa800
    s_nop 0
    buffer_load_dwordx4 v15, s[4:7], 0 offen sc1 lds
    s_add_u32 s33, s33, 128
    s_cmp_eq_u32 s33, 1280
    s_cselect_b32 s33, 0, s33
    s_lshr_b32 s31, s33, 4
    v_add_u32 v1, s31, v10
    v_mul_u32_u24 v2, 205, v1
    v_lshrrev_b32 v2, 10, v2
    v_mul_u32_u24 v3, 5, v2
    v_sub_u32 v1, v1, v3
    v_mul_u32_u24 v2, 163840, v2
    v_lshl_add_u32 v2, v1, 4, v2
    v_add_u32 v13, v2, v7
    s_add_u32 m0, s35, 0xf000
    s_nop 0
    buffer_load_dwordx4 v13, s[4:7], 0 offen sc1 lds
    s_lshr_b32 s31, s33, 4
    v_add_u32 v1, s31, v11
    v_mul_u32_u24 v2, 205, v1
    v_lshrrev_b32 v2, 10, v2
    v_mul_u32_u24 v3, 5, v2
    v_sub_u32 v1, v1, v3
    v_mul_u32_u24 v2, 163840, v2
    v_lshl_add_u32 v2, v1, 4, v2
    v_add_u32 v14, v2, v8
    s_add_u32 m0, s35, 0xf400
    s_nop 0
    buffer_load_dwordx4 v14, s[4:7], 0 offen sc1 lds
    s_lshr_b32 s31, s33, 4
    v_add_u32 v1, s31, v12
    v_mul_u32_u24 v2, 205, v1
    v_lshrrev_b32 v2, 10, v2
    v_mul_u32_u24 v3, 5, v2
    v_sub_u32 v1, v1, v3
    v_mul_u32_u24 v2, 163840, v2
    v_lshl_add_u32 v2, v1, 4, v2
    v_add_u32 v15, v2, v9
    s_add_u32 m0, s35, 0xf800
    s_nop 0
    buffer_load_dwordx4 v15, s[4:7], 0 offen sc1 lds
    s_add_u32 s33, s33, 128
    s_cmp_eq_u32 s33, 1280
    s_cselect_b32 s33, 0, s33
    s_lshr_b32 s31, s33, 4
    v_add_u32 v1, s31, v10
    v_mul_u32_u24 v2, 205, v1
    v_lshrrev_b32 v2, 10, v2
    v_mul_u32_u24 v3, 5, v2
    v_sub_u32 v1, v1, v3
    v_mul_u32_u24 v2, 163840, v2
    v_lshl_add_u32 v2, v1, 4, v2
    v_add_u32 v13, v2, v7
    s_add_u32 m0, s35, 0x14000
    s_nop 0
    buffer_load_dwordx4 v13, s[4:7], 0 offen sc1 lds
    s_lshr_b32 s31, s33, 4
    v_add_u32 v1, s31, v11
    v_mul_u32_u24 v2, 205, v1
    v_lshrrev_b32 v2, 10, v2
    v_mul_u32_u24 v3, 5, v2
    v_sub_u32 v1, v1, v3
    v_mul_u32_u24 v2, 163840, v2
    v_lshl_add_u32 v2, v1, 4, v2
    v_add_u32 v14, v2, v8
    s_add_u32 m0, s35, 0x14400
    s_nop 0
    buffer_load_dwordx4 v14, s[4:7], 0 offen sc1 lds
    s_lshr_b32 s31, s33, 4
    v_add_u32 v1, s31, v12
    v_mul_u32_u24 v2, 205, v1
    v_lshrrev_b32 v2, 10, v2
    v_mul_u32_u24 v3, 5, v2
    v_sub_u32 v1, v1, v3
    v_mul_u32_u24 v2, 163840, v2
    v_lshl_add_u32 v2, v1, 4, v2
    v_add_u32 v15, v2, v9
    s_add_u32 m0, s35, 0x14800
    s_nop 0
    buffer_load_dwordx4 v15, s[4:7], 0 offen sc1 lds
    s_add_u32 s33, s33, 128
    s_cmp_eq_u32 s33, 1280
    s_cselect_b32 s33, 0, s33
    s_lshr_b32 s31, s33, 4
    v_add_u32 v1, s31, v10
    v_mul_u32_u24 v2, 205, v1
    v_lshrrev_b32 v2, 10, v2
    v_mul_u32_u24 v3, 5, v2
    v_sub_u32 v1, v1, v3
    v_mul_u32_u24 v2, 163840, v2
    v_lshl_add_u32 v2, v1, 4, v2
    v_add_u32 v13, v2, v7
    s_add_u32 m0, s35, 0x19000
    s_nop 0
    buffer_load_dwordx4 v13, s[4:7], 0 offen sc1 lds
    s_lshr_b32 s31, s33, 4
    v_add_u32 v1, s31, v11
    v_mul_u32_u24 v2, 205, v1
    v_lshrrev_b32 v2, 10, v2
    v_mul_u32_u24 v3, 5, v2
    v_sub_u32 v1, v1, v3
    v_mul_u32_u24 v2, 163840, v2
    v_lshl_add_u32 v2, v1, 4, v2
    v_add_u32 v14, v2, v8
    s_add_u32 m0, s35, 0x19400
    s_nop 0
    buffer_load_dwordx4 v14, s[4:7], 0 offen sc1 lds
    s_lshr_b32 s31, s33, 4
    v_add_u32 v1, s31, v12
    v_mul_u32_u24 v2, 205, v1
    v_lshrrev_b32 v2, 10, v2
    v_mul_u32_u24 v3, 5, v2
    v_sub_u32 v1, v1, v3
    v_mul_u32_u24 v2, 163840, v2
    v_lshl_add_u32 v2, v1, 4, v2
    v_add_u32 v15, v2, v9
    s_add_u32 m0, s35, 0x19800
    s_nop 0
    buffer_load_dwordx4 v15, s[4:7], 0 offen sc1 lds
    s_add_u32 s33, s33, 128
    s_cmp_eq_u32 s33, 1280
    s_cselect_b32 s33, 0, s33
    s_waitcnt vmcnt(12)
    s_barrier
    s_add_u32 m0, s36, 0x21000
    s_nop 0
    buffer_load_dwordx4 v16, s[8:11], s34 offen lds
    s_add_u32 m0, s36, 0x21400
    s_nop 0
    buffer_load_dwordx4 v17, s[8:11], s34 offen lds
    s_add_u32 s34, s34, 81920
    s_cmp_eq_u32 s34, 819200
    s_cselect_b32 s34, 0, s34
    s_lshr_b32 s31, s33, 4
    v_add_u32 v1, s31, v10
    v_mul_u32_u24 v2, 205, v1
    v_lshrrev_b32 v2, 10, v2
    v_mul_u32_u24 v3, 5, v2
    v_sub_u32 v1, v1, v3
    v_mul_u32_u24 v2, 163840, v2
    v_lshl_add_u32 v2, v1, 4, v2
    v_add_u32 v13, v2, v7
    s_add_u32 m0, s35, 0x1e000
    s_nop 0
    buffer_load_dwordx4 v13, s[4:7], 0 offen sc1 lds
    s_lshr_b32 s31, s33, 4
    v_add_u32 v1, s31, v11
    v_mul_u32_u24 v2, 205, v1
    v_lshrrev_b32 v2, 10, v2
    v_mul_u32_u24 v3, 5, v2
    v_sub_u32 v1, v1, v3
    v_mul_u32_u24 v2, 163840, v2
    v_lshl_add_u32 v2, v1, 4, v2
    v_add_u32 v14, v2, v8
    s_add_u32 m0, s35, 0x1e400
    s_nop 0
    buffer_load_dwordx4 v14, s[4:7], 0 offen sc1 lds
    s_lshr_b32 s31, s33, 4
    v_add_u32 v1, s31, v12
    v_mul_u32_u24 v2, 205, v1
    v_lshrrev_b32 v2, 10, v2
    v_mul_u32_u24 v3, 5, v2
    v_sub_u32 v1, v1, v3
    v_mul_u32_u24 v2, 163840, v2
    v_lshl_add_u32 v2, v1, 4, v2
    v_add_u32 v15, v2, v9
    s_add_u32 m0, s35, 0x1e800
    s_nop 0
    buffer_load_dwordx4 v15, s[4:7], 0 offen sc1 lds
    s_add_u32 s33, s33, 128
    s_cmp_eq_u32 s33, 1280
    s_cselect_b32 s33, 0, s33
    s_add_u32 m0, s36, 0x26000
    s_nop 0
    buffer_load_dwordx4 v16, s[8:11], s34 offen lds
    s_add_u32 m0, s36, 0x26400
    s_nop 0
    buffer_load_dwordx4 v17, s[8:11], s34 offen lds
    s_add_u32 s34, s34, 81920
    s_cmp_eq_u32 s34, 819200
    s_cselect_b32 s34, 0, s34
    s_lshr_b32 s31, s33, 4
    v_add_u32 v1, s31, v10
    v_mul_u32_u24 v2, 205, v1
    v_lshrrev_b32 v2, 10, v2
    v_mul_u32_u24 v3, 5, v2
    v_sub_u32 v1, v1, v3
    v_mul_u32_u24 v2, 163840, v2
    v_lshl_add_u32 v2, v1, 4, v2
    v_add_u32 v13, v2, v7
    s_add_u32 m0, s35, 0x23000
    s_nop 0
    buffer_load_dwordx4 v13, s[4:7], 0 offen sc1 lds
    s_lshr_b32 s31, s33, 4
    v_add_u32 v1, s31, v11
    v_mul_u32_u24 v2, 205, v1
    v_lshrrev_b32 v2, 10, v2
    v_mul_u32_u24 v3, 5, v2
    v_sub_u32 v1, v1, v3
    v_mul_u32_u24 v2, 163840, v2
    v_lshl_add_u32 v2, v1, 4, v2
    v_add_u32 v14, v2, v8
    s_add_u32 m0, s35, 0x23400
    s_nop 0
    buffer_load_dwordx4 v14, s[4:7], 0 offen sc1 lds
    s_lshr_b32 s31, s33, 4
    v_add_u32 v1, s31, v12
    v_mul_u32_u24 v2, 205, v1
    v_lshrrev_b32 v2, 10, v2
    v_mul_u32_u24 v3, 5, v2
    v_sub_u32 v1, v1, v3
    v_mul_u32_u24 v2, 163840, v2
    v_lshl_add_u32 v2, v1, 4, v2
    v_add_u32 v15, v2, v9
    s_add_u32 m0, s35, 0x23800
    s_nop 0
    buffer_load_dwordx4 v15, s[4:7], 0 offen sc1 lds
    s_add_u32 s33, s33, 128
    s_cmp_eq_u32 s33, 1280
    s_cselect_b32 s33, 0, s33
    s_waitcnt vmcnt(16)
    s_barrier
    s_add_u32 m0, s36, 0x3000
    s_nop 0
    buffer_load_dwordx4 v16, s[8:11], s34 offen lds
    s_add_u32 m0, s36, 0x3400
    s_nop 0
    buffer_load_dwordx4 v17, s[8:11], s34 offen lds
    s_add_u32 s34, s34, 81920
    s_cmp_eq_u32 s34, 819200
    s_cselect_b32 s34, 0, s34
    s_lshr_b32 s31, s33, 4
    v_add_u32 v1, s31, v10
    v_mul_u32_u24 v2, 205, v1
    v_lshrrev_b32 v2, 10, v2
    v_mul_u32_u24 v3, 5, v2
    v_sub_u32 v1, v1, v3
    v_mul_u32_u24 v2, 163840, v2
    v_lshl_add_u32 v2, v1, 4, v2
    v_add_u32 v13, v2, v7
    s_add_u32 m0, s35, 0x0
    s_nop 0
    buffer_load_dwordx4 v13, s[4:7], 0 offen sc1 lds
    s_lshr_b32 s31, s33, 4
    v_add_u32 v1, s31, v11
    v_mul_u32_u24 v2, 205, v1
    v_lshrrev_b32 v2, 10, v2
    v_mul_u32_u24 v3, 5, v2
    v_sub_u32 v1, v1, v3
    v_mul_u32_u24 v2, 163840, v2
    v_lshl_add_u32 v2, v1, 4, v2
    v_add_u32 v14, v2, v8
    s_add_u32 m0, s35, 0x400
    s_nop 0
    buffer_load_dwordx4 v14, s[4:7], 0 offen sc1 lds
    s_lshr_b32 s31, s33, 4
    v_add_u32 v1, s31, v12
    v_mul_u32_u24 v2, 205, v1
    v_lshrrev_b32 v2, 10, v2
    v_mul_u32_u24 v3, 5, v2
    v_sub_u32 v1, v1, v3
    v_mul_u32_u24 v2, 163840, v2
    v_lshl_add_u32 v2, v1, 4, v2
    v_add_u32 v15, v2, v9
    s_add_u32 m0, s35, 0x800
    s_nop 0
    buffer_load_dwordx4 v15, s[4:7], 0 offen sc1 lds
    s_add_u32 s33, s33, 128
    s_cmp_eq_u32 s33, 1280
    s_cselect_b32 s33, 0, s33
    s_add_u32 m0, s36, 0x8000
    s_nop 0
    buffer_load_dwordx4 v16, s[8:11], s34 offen lds
    s_add_u32 m0, s36, 0x8400
    s_nop 0
    buffer_load_dwordx4 v17, s[8:11], s34 offen lds
    s_add_u32 s34, s34, 81920
    s_cmp_eq_u32 s34, 819200
    s_cselect_b32 s34, 0, s34
    s_lshr_b32 s31, s33, 4
    v_add_u32 v1, s31, v10
    v_mul_u32_u24 v2, 205, v1
    v_lshrrev_b32 v2, 10, v2
    v_mul_u32_u24 v3, 5, v2
    v_sub_u32 v1, v1, v3
    v_mul_u32_u24 v2, 163840, v2
    v_lshl_add_u32 v2, v1, 4, v2
    v_add_u32 v13, v2, v7
    s_add_u32 m0, s35, 0x5000
    s_nop 0
    buffer_load_dwordx4 v13, s[4:7], 0 offen sc1 lds
    s_lshr_b32 s31, s33, 4
    v_add_u32 v1, s31, v11
    v_mul_u32_u24 v2, 205, v1
    v_lshrrev_b32 v2, 10, v2
    v_mul_u32_u24 v3, 5, v2
    v_sub_u32 v1, v1, v3
    v_mul_u32_u24 v2, 163840, v2
    v_lshl_add_u32 v2, v1, 4, v2
    v_add_u32 v14, v2, v8
    s_add_u32 m0, s35, 0x5400
    s_nop 0
    buffer_load_dwordx4 v14, s[4:7], 0 offen sc1 lds
    s_lshr_b32 s31, s33, 4
    v_add_u32 v1, s31, v12
    v_mul_u32_u24 v2, 205, v1
    v_lshrrev_b32 v2, 10, v2
    v_mul_u32_u24 v3, 5, v2
    v_sub_u32 v1, v1, v3
    v_mul_u32_u24 v2, 163840, v2
    v_lshl_add_u32 v2, v1, 4, v2
    v_add_u32 v15, v2, v9
    s_add_u32 m0, s35, 0x5800
    s_nop 0
    buffer_load_dwordx4 v15, s[4:7], 0 offen sc1 lds
    s_add_u32 s33, s33, 128
    s_cmp_eq_u32 s33, 1280
    s_cselect_b32 s33, 0, s33
    s_waitcnt vmcnt(20)
    s_barrier
    s_waitcnt vmcnt(10)
    s_barrier
    s_waitcnt vmcnt(0)
    s_barrier
    s_barrier
    s_barrier
wo_kernel_end:
    s_setprio 0
w1_kernel:
    s_and_b32 s31, s2, 7
    s_lshr_b32 s32, s2, 3
    s_and_b32 s54, s32, 3
    s_lshr_b32 s55, s32, 2
    s_lshr_b32 s28, s31, 1
    s_mul_i32 s28, s28, 4
    s_add_u32 s28, s28, s54
    s_and_b32 s29, s31, 1
    s_mul_i32 s29, s29, 7
    s_cmp_ge_u32 s55, 7
    s_cbranch_scc1 w1_kernel_end
    s_add_u32 s29, s29, s55
    s_cmp_ge_u32 s29, 14
    s_cbranch_scc1 w1_kernel_end
    s_mov_b32 s30, s80
    s_mul_i32 s40, s28, 128
    s_mul_i32 s41, s29, 128
    s_cmp_ge_u32 s30, 4
    s_cbranch_scc1 w1_kernel_loader
    v_lshrrev_b32 v1, 4, v0
    v_and_b32 v2, 15, v0
    s_mov_b32 s38, s30
    s_mov_b32 s39, 0
    s_mul_i32 s31, s38, 4096
    v_lshrrev_b32 v3, 1, v2
    v_lshlrev_b32 v4, 7, v2
    v_add_u32 v4, s31, v4
    v_add_u32 v5, 0, v1
    v_xor_b32 v5, v5, v3
    v_lshl_add_u32 v7, v5, 4, v4
    v_add_u32 v5, 4, v1
    v_xor_b32 v5, v5, v3
    v_lshl_add_u32 v8, v5, 4, v4
    v_lshrrev_b32 v3, 2, v2
    v_and_b32 v4, 1, v1
    v_lshl_add_u32 v3, v4, 2, v3
    v_lshrrev_b32 v4, 1, v1
    v_lshl_add_u32 v4, v4, 4, v3
    v_mul_u32_u24 v4, 256, v4
    v_and_b32 v5, 1, v2
    v_lshl_add_u32 v4, v5, 3, v4
    v_bfe_u32 v5, v2, 1, 1
    v_lshl_add_u32 v4, v5, 4, v4
    v_add_u32 v4, 16384, v4
    v_lshlrev_b32 v3, 1, v3
    s_lshl_b32 s31, s30, 1
    s_add_u32 s31, s31, 0
    s_and_b32 s46, s31, 7
    s_lshl_b32 s31, s46, 1
    v_xor_b32 v5, s31, v3
    v_lshl_add_u32 v11, v5, 4, v4
    s_lshl_b32 s31, s30, 1
    s_add_u32 s31, s31, 1
    s_and_b32 s47, s31, 7
    s_lshl_b32 s31, s47, 1
    v_xor_b32 v5, s31, v3
    v_lshl_add_u32 v12, v5, 4, v4
    s_lshl_b32 s31, s30, 1
    s_add_u32 s31, s31, 2
    s_and_b32 s48, s31, 7
    s_lshl_b32 s31, s48, 1
    v_xor_b32 v5, s31, v3
    v_lshl_add_u32 v13, v5, 4, v4
    s_lshl_b32 s31, s30, 1
    s_add_u32 s31, s31, 3
    s_and_b32 s49, s31, 7
    s_lshl_b32 s31, s49, 1
    v_xor_b32 v5, s31, v3
    v_lshl_add_u32 v14, v5, 4, v4
    s_lshl_b32 s31, s30, 1
    s_add_u32 s31, s31, 4
    s_and_b32 s50, s31, 7
    s_lshl_b32 s31, s50, 1
    v_xor_b32 v5, s31, v3
    v_lshl_add_u32 v15, v5, 4, v4
    s_lshl_b32 s31, s30, 1
    s_add_u32 s31, s31, 5
    s_and_b32 s51, s31, 7
    s_lshl_b32 s31, s51, 1
    v_xor_b32 v5, s31, v3
    v_lshl_add_u32 v16, v5, 4, v4
    s_lshl_b32 s31, s30, 1
    s_add_u32 s31, s31, 6
    s_and_b32 s52, s31, 7
    s_lshl_b32 s31, s52, 1
    v_xor_b32 v5, s31, v3
    v_lshl_add_u32 v17, v5, 4, v4
    s_lshl_b32 s31, s30, 1
    s_add_u32 s31, s31, 7
    s_and_b32 s53, s31, 7
    s_lshl_b32 s31, s53, 1
    v_xor_b32 v5, s31, v3
    v_lshl_add_u32 v18, v5, 4, v4
    s_waitcnt lgkmcnt(0)
    s_add_u32 s12, s78, 0x1000000
    s_addc_u32 s13, s79, 0
    s_and_b32 s13, s13, 0xffff
    s_mov_b32 s14, 0x6c0000
    s_mov_b32 s15, 0x20000
    v_mov_b32 v172, 0x3f803f80
    v_mov_b32 v173, 0x3f803f80
    v_mov_b32 v174, 0x3f803f80
    v_mov_b32 v175, 0x3f803f80
    s_mul_i32 s31, s40, 10923
    s_lshr_b32 s31, s31, 20
    s_add_u32 s32, s40, 127
    s_mul_i32 s32, s32, 10923
    s_lshr_b32 s32, s32, 20
    s_min_u32 s32, s32, 21
    s_cmp_lg_u32 s80, 0
    s_cbranch_scc1 w1_kernel_dep_done
    s_waitcnt vmcnt(0)
    v_readfirstlane_b32 s81, v248
    s_nop 0
    s_cmp_eq_u32 s81, 0
    s_cselect_b32 s81, s82, s81
    v_lshrrev_b32 v3, 4, v0
    v_add_u32 v3, s31, v3
    v_and_b32 v4, 15, v0
    v_cmp_gt_u32 s[42:43], 10, v4
    v_cmp_le_i32 vcc, 0, v3
    s_and_b64 s[42:43], s[42:43], vcc
    v_cmp_ge_i32 vcc, s32, v3
    s_and_b64 s[42:43], s[42:43], vcc
    v_lshl_add_u32 v3, v3, 4, v4
    v_lshlrev_b32 v3, 3, v3
    v_add_u32 v3, 4096, v3
    s_mov_b32 s56, 0
    s_mov_b64 exec, s[42:43]
w1_kernel_dep_loop:
    buffer_load_dwordx2 v[244:245], v3, s[84:87], 0 offen sc1
    s_waitcnt vmcnt(0)
    v_not_b32 v245, v245
    v_xor_b32 v244, s81, v244
    v_xor_b32 v245, s81, v245
    v_or_b32 v244, v244, v245
    v_cmp_ne_u32 vcc, 0, v244
    s_nop 1
    s_cbranch_vccz w1_kernel_dep_ok
    s_sleep 1
    s_add_u32 s56, s56, 1
    s_cmp_lt_u32 s56, 200000
    s_cbranch_scc1 w1_kernel_dep_loop
w1_kernel_dep_ok:
    s_mov_b64 exec, -1
w1_kernel_dep_done:
    s_barrier
    s_barrier
    v_add_u32 v9, 0x0, v7
    v_add_u32 v10, 0x0, v8
    v_add_u32 v19, 0x0, v11
    v_add_u32 v20, 0x0, v12
    v_add_u32 v21, 0x0, v13
    v_add_u32 v22, 0x0, v14
    v_add_u32 v23, 0x0, v15
    v_add_u32 v24, 0x0, v16
    v_add_u32 v25, 0x0, v17
    v_add_u32 v26, 0x0, v18
    ds_read_b128 v[92:95], v9 offset:0
    ds_read_b128 v[96:99], v9 offset:2048
    ds_read_b64_tr_b16 v[108:109], v19 offset:0
    ds_read_b64_tr_b16 v[110:111], v19 offset:2048
    ds_read_b64_tr_b16 v[112:113], v20 offset:0
    ds_read_b64_tr_b16 v[114:115], v20 offset:2048
    ds_read_b64_tr_b16 v[116:117], v21 offset:0
    ds_read_b64_tr_b16 v[118:119], v21 offset:2048
    ds_read_b64_tr_b16 v[120:121], v22 offset:0
    ds_read_b64_tr_b16 v[122:123], v22 offset:2048
    ds_read_b64_tr_b16 v[124:125], v23 offset:0
    ds_read_b64_tr_b16 v[126:127], v23 offset:2048
    ds_read_b64_tr_b16 v[128:129], v24 offset:0
    ds_read_b64_tr_b16 v[130:131], v24 offset:2048
    ds_read_b64_tr_b16 v[132:133], v25 offset:0
    ds_read_b64_tr_b16 v[134:135], v25 offset:2048
    ds_read_b64_tr_b16 v[136:137], v26 offset:0
    ds_read_b64_tr_b16 v[138:139], v26 offset:2048
    s_waitcnt lgkmcnt(0)
    v_mfma_f32_16x16x32_bf16 v[28:31], v[108:111], v[92:95], 0
    ds_read_b128 v[100:103], v10 offset:0
    ds_read_b128 v[104:107], v10 offset:2048
    v_mfma_f32_16x16x32_bf16 v[60:63], v[108:111], v[96:99], 0
    ds_read_b64_tr_b16 v[140:141], v19 offset:8192
    v_mfma_f32_16x16x32_bf16 v[176:179], v[108:111], v[172:175], 0
    ds_read_b64_tr_b16 v[142:143], v19 offset:10240
    v_mfma_f32_16x16x32_bf16 v[32:35], v[112:115], v[92:95], 0
    ds_read_b64_tr_b16 v[144:145], v20 offset:8192
    v_mfma_f32_16x16x32_bf16 v[64:67], v[112:115], v[96:99], 0
    ds_read_b64_tr_b16 v[146:147], v20 offset:10240
    v_mfma_f32_16x16x32_bf16 v[180:183], v[112:115], v[172:175], 0
    ds_read_b64_tr_b16 v[148:149], v21 offset:8192
    v_mfma_f32_16x16x32_bf16 v[36:39], v[116:119], v[92:95], 0
    ds_read_b64_tr_b16 v[150:151], v21 offset:10240
    v_mfma_f32_16x16x32_bf16 v[68:71], v[116:119], v[96:99], 0
    ds_read_b64_tr_b16 v[152:153], v22 offset:8192
    v_mfma_f32_16x16x32_bf16 v[184:187], v[172:175], v[92:95], 0
    ds_read_b64_tr_b16 v[154:155], v22 offset:10240
    ds_read_b64_tr_b16 v[156:157], v23 offset:8192
    v_mfma_f32_16x16x32_bf16 v[40:43], v[120:123], v[92:95], 0
    ds_read_b64_tr_b16 v[158:159], v23 offset:10240
    v_mfma_f32_16x16x32_bf16 v[72:75], v[120:123], v[96:99], 0
    ds_read_b64_tr_b16 v[160:161], v24 offset:8192
    v_mfma_f32_16x16x32_bf16 v[188:191], v[172:175], v[96:99], 0
    ds_read_b64_tr_b16 v[162:163], v24 offset:10240
    v_mfma_f32_16x16x32_bf16 v[44:47], v[124:127], v[92:95], 0
    ds_read_b64_tr_b16 v[164:165], v25 offset:8192
    v_mfma_f32_16x16x32_bf16 v[76:79], v[124:127], v[96:99], 0
    ds_read_b64_tr_b16 v[166:167], v25 offset:10240
    v_mfma_f32_16x16x32_bf16 v[192:195], v[92:95], v[92:95], 0
    ds_read_b64_tr_b16 v[168:169], v26 offset:8192
    v_mfma_f32_16x16x32_bf16 v[48:51], v[128:131], v[92:95], 0
    ds_read_b64_tr_b16 v[170:171], v26 offset:10240
    v_mfma_f32_16x16x32_bf16 v[80:83], v[128:131], v[96:99], 0
    v_mfma_f32_16x16x32_bf16 v[196:199], v[96:99], v[96:99], 0
    v_mfma_f32_16x16x32_bf16 v[52:55], v[132:135], v[92:95], 0
    v_mfma_f32_16x16x32_bf16 v[84:87], v[132:135], v[96:99], 0
    v_mfma_f32_16x16x32_bf16 v[56:59], v[136:139], v[92:95], 0
    v_mfma_f32_16x16x32_bf16 v[88:91], v[136:139], v[96:99], 0
    s_waitcnt lgkmcnt(0)
    v_mfma_f32_16x16x32_bf16 v[28:31], v[140:143], v[100:103], v[28:31]
    v_mfma_f32_16x16x32_bf16 v[60:63], v[140:143], v[104:107], v[60:63]
    v_mfma_f32_16x16x32_bf16 v[176:179], v[140:143], v[172:175], v[176:179]
    v_mfma_f32_16x16x32_bf16 v[32:35], v[144:147], v[100:103], v[32:35]
    v_mfma_f32_16x16x32_bf16 v[64:67], v[144:147], v[104:107], v[64:67]
    s_waitcnt lgkmcnt(0)
    s_barrier
    v_mfma_f32_16x16x32_bf16 v[180:183], v[144:147], v[172:175], v[180:183]
    v_add_u32 v9, 0x8000, v7
    v_add_u32 v10, 0x8000, v8
    v_add_u32 v19, 0x8000, v11
    v_mfma_f32_16x16x32_bf16 v[36:39], v[148:151], v[100:103], v[36:39]
    v_add_u32 v20, 0x8000, v12
    v_add_u32 v21, 0x8000, v13
    v_mfma_f32_16x16x32_bf16 v[68:71], v[148:151], v[104:107], v[68:71]
    v_add_u32 v22, 0x8000, v14
    v_add_u32 v23, 0x8000, v15
    v_mfma_f32_16x16x32_bf16 v[184:187], v[172:175], v[100:103], v[184:187]
    v_add_u32 v24, 0x8000, v16
    v_add_u32 v25, 0x8000, v17
    v_add_u32 v26, 0x8000, v18
    v_mfma_f32_16x16x32_bf16 v[40:43], v[152:155], v[100:103], v[40:43]
    ds_read_b128 v[92:95], v9 offset:0
    ds_read_b128 v[96:99], v9 offset:2048
    v_mfma_f32_16x16x32_bf16 v[72:75], v[152:155], v[104:107], v[72:75]
    ds_read_b64_tr_b16 v[108:109], v19 offset:0
    ds_read_b64_tr_b16 v[110:111], v19 offset:2048
    v_mfma_f32_16x16x32_bf16 v[188:191], v[172:175], v[104:107], v[188:191]
    ds_read_b64_tr_b16 v[112:113], v20 offset:0
    ds_read_b64_tr_b16 v[114:115], v20 offset:2048
    ds_read_b64_tr_b16 v[116:117], v21 offset:0
    v_mfma_f32_16x16x32_bf16 v[44:47], v[156:159], v[100:103], v[44:47]
    ds_read_b64_tr_b16 v[118:119], v21 offset:2048
    ds_read_b64_tr_b16 v[120:121], v22 offset:0
    v_mfma_f32_16x16x32_bf16 v[76:79], v[156:159], v[104:107], v[76:79]
    ds_read_b64_tr_b16 v[122:123], v22 offset:2048
    ds_read_b64_tr_b16 v[124:125], v23 offset:0
    v_mfma_f32_16x16x32_bf16 v[192:195], v[100:103], v[100:103], v[192:195]
    ds_read_b64_tr_b16 v[126:127], v23 offset:2048
    ds_read_b64_tr_b16 v[128:129], v24 offset:0
    ds_read_b64_tr_b16 v[130:131], v24 offset:2048
    v_mfma_f32_16x16x32_bf16 v[48:51], v[160:163], v[100:103], v[48:51]
    ds_read_b64_tr_b16 v[132:133], v25 offset:0
    ds_read_b64_tr_b16 v[134:135], v25 offset:2048
    v_mfma_f32_16x16x32_bf16 v[80:83], v[160:163], v[104:107], v[80:83]
    ds_read_b64_tr_b16 v[136:137], v26 offset:0
    ds_read_b64_tr_b16 v[138:139], v26 offset:2048
    v_mfma_f32_16x16x32_bf16 v[196:199], v[104:107], v[104:107], v[196:199]
    v_mfma_f32_16x16x32_bf16 v[52:55], v[164:167], v[100:103], v[52:55]
    v_mfma_f32_16x16x32_bf16 v[84:87], v[164:167], v[104:107], v[84:87]
    v_mfma_f32_16x16x32_bf16 v[56:59], v[168:171], v[100:103], v[56:59]
    v_mfma_f32_16x16x32_bf16 v[88:91], v[168:171], v[104:107], v[88:91]
    s_waitcnt lgkmcnt(0)
    v_mfma_f32_16x16x32_bf16 v[28:31], v[108:111], v[92:95], v[28:31]
    ds_read_b128 v[100:103], v10 offset:0
    ds_read_b128 v[104:107], v10 offset:2048
    v_mfma_f32_16x16x32_bf16 v[60:63], v[108:111], v[96:99], v[60:63]
    ds_read_b64_tr_b16 v[140:141], v19 offset:8192
    v_mfma_f32_16x16x32_bf16 v[176:179], v[108:111], v[172:175], v[176:179]
    ds_read_b64_tr_b16 v[142:143], v19 offset:10240
    v_mfma_f32_16x16x32_bf16 v[32:35], v[112:115], v[92:95], v[32:35]
    ds_read_b64_tr_b16 v[144:145], v20 offset:8192
    v_mfma_f32_16x16x32_bf16 v[64:67], v[112:115], v[96:99], v[64:67]
    ds_read_b64_tr_b16 v[146:147], v20 offset:10240
    v_mfma_f32_16x16x32_bf16 v[180:183], v[112:115], v[172:175], v[180:183]
    ds_read_b64_tr_b16 v[148:149], v21 offset:8192
    v_mfma_f32_16x16x32_bf16 v[36:39], v[116:119], v[92:95], v[36:39]
    ds_read_b64_tr_b16 v[150:151], v21 offset:10240
    v_mfma_f32_16x16x32_bf16 v[68:71], v[116:119], v[96:99], v[68:71]
    ds_read_b64_tr_b16 v[152:153], v22 offset:8192
    v_mfma_f32_16x16x32_bf16 v[184:187], v[172:175], v[92:95], v[184:187]
    ds_read_b64_tr_b16 v[154:155], v22 offset:10240
    ds_read_b64_tr_b16 v[156:157], v23 offset:8192
    v_mfma_f32_16x16x32_bf16 v[40:43], v[120:123], v[92:95], v[40:43]
    ds_read_b64_tr_b16 v[158:159], v23 offset:10240
    v_mfma_f32_16x16x32_bf16 v[72:75], v[120:123], v[96:99], v[72:75]
    ds_read_b64_tr_b16 v[160:161], v24 offset:8192
    v_mfma_f32_16x16x32_bf16 v[188:191], v[172:175], v[96:99], v[188:191]
    ds_read_b64_tr_b16 v[162:163], v24 offset:10240
    v_mfma_f32_16x16x32_bf16 v[44:47], v[124:127], v[92:95], v[44:47]
    ds_read_b64_tr_b16 v[164:165], v25 offset:8192
    v_mfma_f32_16x16x32_bf16 v[76:79], v[124:127], v[96:99], v[76:79]
    ds_read_b64_tr_b16 v[166:167], v25 offset:10240
    v_mfma_f32_16x16x32_bf16 v[192:195], v[92:95], v[92:95], v[192:195]
    ds_read_b64_tr_b16 v[168:169], v26 offset:8192
    v_mfma_f32_16x16x32_bf16 v[48:51], v[128:131], v[92:95], v[48:51]
    ds_read_b64_tr_b16 v[170:171], v26 offset:10240
    v_mfma_f32_16x16x32_bf16 v[80:83], v[128:131], v[96:99], v[80:83]
    v_mfma_f32_16x16x32_bf16 v[196:199], v[96:99], v[96:99], v[196:199]
    v_mfma_f32_16x16x32_bf16 v[52:55], v[132:135], v[92:95], v[52:55]
    v_mfma_f32_16x16x32_bf16 v[84:87], v[132:135], v[96:99], v[84:87]
    v_mfma_f32_16x16x32_bf16 v[56:59], v[136:139], v[92:95], v[56:59]
    v_mfma_f32_16x16x32_bf16 v[88:91], v[136:139], v[96:99], v[88:91]
    s_waitcnt lgkmcnt(0)
    v_mfma_f32_16x16x32_bf16 v[28:31], v[140:143], v[100:103], v[28:31]
    v_mfma_f32_16x16x32_bf16 v[60:63], v[140:143], v[104:107], v[60:63]
    v_mfma_f32_16x16x32_bf16 v[176:179], v[140:143], v[172:175], v[176:179]
    v_mfma_f32_16x16x32_bf16 v[32:35], v[144:147], v[100:103], v[32:35]
    v_mfma_f32_16x16x32_bf16 v[64:67], v[144:147], v[104:107], v[64:67]
    s_waitcnt lgkmcnt(0)
    s_barrier
    v_mfma_f32_16x16x32_bf16 v[180:183], v[144:147], v[172:175], v[180:183]
    v_add_u32 v9, 0x10000, v7
    v_add_u32 v10, 0x10000, v8
    v_add_u32 v19, 0x10000, v11
    v_mfma_f32_16x16x32_bf16 v[36:39], v[148:151], v[100:103], v[36:39]
    v_add_u32 v20, 0x10000, v12
    v_add_u32 v21, 0x10000, v13
    v_mfma_f32_16x16x32_bf16 v[68:71], v[148:151], v[104:107], v[68:71]
    v_add_u32 v22, 0x10000, v14
    v_add_u32 v23, 0x10000, v15
    v_mfma_f32_16x16x32_bf16 v[184:187], v[172:175], v[100:103], v[184:187]
    v_add_u32 v24, 0x10000, v16
    v_add_u32 v25, 0x10000, v17
    v_add_u32 v26, 0x10000, v18
    v_mfma_f32_16x16x32_bf16 v[40:43], v[152:155], v[100:103], v[40:43]
    ds_read_b128 v[92:95], v9 offset:0
    ds_read_b128 v[96:99], v9 offset:2048
    v_mfma_f32_16x16x32_bf16 v[72:75], v[152:155], v[104:107], v[72:75]
    ds_read_b64_tr_b16 v[108:109], v19 offset:0
    ds_read_b64_tr_b16 v[110:111], v19 offset:2048
    v_mfma_f32_16x16x32_bf16 v[188:191], v[172:175], v[104:107], v[188:191]
    ds_read_b64_tr_b16 v[112:113], v20 offset:0
    ds_read_b64_tr_b16 v[114:115], v20 offset:2048
    ds_read_b64_tr_b16 v[116:117], v21 offset:0
    v_mfma_f32_16x16x32_bf16 v[44:47], v[156:159], v[100:103], v[44:47]
    ds_read_b64_tr_b16 v[118:119], v21 offset:2048
    ds_read_b64_tr_b16 v[120:121], v22 offset:0
    v_mfma_f32_16x16x32_bf16 v[76:79], v[156:159], v[104:107], v[76:79]
    ds_read_b64_tr_b16 v[122:123], v22 offset:2048
    ds_read_b64_tr_b16 v[124:125], v23 offset:0
    v_mfma_f32_16x16x32_bf16 v[192:195], v[100:103], v[100:103], v[192:195]
    ds_read_b64_tr_b16 v[126:127], v23 offset:2048
    ds_read_b64_tr_b16 v[128:129], v24 offset:0
    ds_read_b64_tr_b16 v[130:131], v24 offset:2048
    v_mfma_f32_16x16x32_bf16 v[48:51], v[160:163], v[100:103], v[48:51]
    ds_read_b64_tr_b16 v[132:133], v25 offset:0
    ds_read_b64_tr_b16 v[134:135], v25 offset:2048
    v_mfma_f32_16x16x32_bf16 v[80:83], v[160:163], v[104:107], v[80:83]
    ds_read_b64_tr_b16 v[136:137], v26 offset:0
    ds_read_b64_tr_b16 v[138:139], v26 offset:2048
    v_mfma_f32_16x16x32_bf16 v[196:199], v[104:107], v[104:107], v[196:199]
    v_mfma_f32_16x16x32_bf16 v[52:55], v[164:167], v[100:103], v[52:55]
    v_mfma_f32_16x16x32_bf16 v[84:87], v[164:167], v[104:107], v[84:87]
    v_mfma_f32_16x16x32_bf16 v[56:59], v[168:171], v[100:103], v[56:59]
    v_mfma_f32_16x16x32_bf16 v[88:91], v[168:171], v[104:107], v[88:91]
    s_waitcnt lgkmcnt(0)
    v_mfma_f32_16x16x32_bf16 v[28:31], v[108:111], v[92:95], v[28:31]
    ds_read_b128 v[100:103], v10 offset:0
    ds_read_b128 v[104:107], v10 offset:2048
    v_mfma_f32_16x16x32_bf16 v[60:63], v[108:111], v[96:99], v[60:63]
    ds_read_b64_tr_b16 v[140:141], v19 offset:8192
    v_mfma_f32_16x16x32_bf16 v[176:179], v[108:111], v[172:175], v[176:179]
    ds_read_b64_tr_b16 v[142:143], v19 offset:10240
    v_mfma_f32_16x16x32_bf16 v[32:35], v[112:115], v[92:95], v[32:35]
    ds_read_b64_tr_b16 v[144:145], v20 offset:8192
    v_mfma_f32_16x16x32_bf16 v[64:67], v[112:115], v[96:99], v[64:67]
    ds_read_b64_tr_b16 v[146:147], v20 offset:10240
    v_mfma_f32_16x16x32_bf16 v[180:183], v[112:115], v[172:175], v[180:183]
    ds_read_b64_tr_b16 v[148:149], v21 offset:8192
    v_mfma_f32_16x16x32_bf16 v[36:39], v[116:119], v[92:95], v[36:39]
    ds_read_b64_tr_b16 v[150:151], v21 offset:10240
    v_mfma_f32_16x16x32_bf16 v[68:71], v[116:119], v[96:99], v[68:71]
    ds_read_b64_tr_b16 v[152:153], v22 offset:8192
    v_mfma_f32_16x16x32_bf16 v[184:187], v[172:175], v[92:95], v[184:187]
    ds_read_b64_tr_b16 v[154:155], v22 offset:10240
    ds_read_b64_tr_b16 v[156:157], v23 offset:8192
    v_mfma_f32_16x16x32_bf16 v[40:43], v[120:123], v[92:95], v[40:43]
    ds_read_b64_tr_b16 v[158:159], v23 offset:10240
    v_mfma_f32_16x16x32_bf16 v[72:75], v[120:123], v[96:99], v[72:75]
    ds_read_b64_tr_b16 v[160:161], v24 offset:8192
    v_mfma_f32_16x16x32_bf16 v[188:191], v[172:175], v[96:99], v[188:191]
    ds_read_b64_tr_b16 v[162:163], v24 offset:10240
    v_mfma_f32_16x16x32_bf16 v[44:47], v[124:127], v[92:95], v[44:47]
    ds_read_b64_tr_b16 v[164:165], v25 offset:8192
    v_mfma_f32_16x16x32_bf16 v[76:79], v[124:127], v[96:99], v[76:79]
    ds_read_b64_tr_b16 v[166:167], v25 offset:10240
    v_mfma_f32_16x16x32_bf16 v[192:195], v[92:95], v[92:95], v[192:195]
    ds_read_b64_tr_b16 v[168:169], v26 offset:8192
    v_mfma_f32_16x16x32_bf16 v[48:51], v[128:131], v[92:95], v[48:51]
    ds_read_b64_tr_b16 v[170:171], v26 offset:10240
    v_mfma_f32_16x16x32_bf16 v[80:83], v[128:131], v[96:99], v[80:83]
    v_mfma_f32_16x16x32_bf16 v[196:199], v[96:99], v[96:99], v[196:199]
    v_mfma_f32_16x16x32_bf16 v[52:55], v[132:135], v[92:95], v[52:55]
    v_mfma_f32_16x16x32_bf16 v[84:87], v[132:135], v[96:99], v[84:87]
    v_mfma_f32_16x16x32_bf16 v[56:59], v[136:139], v[92:95], v[56:59]
    v_mfma_f32_16x16x32_bf16 v[88:91], v[136:139], v[96:99], v[88:91]
    s_waitcnt lgkmcnt(0)
    v_mfma_f32_16x16x32_bf16 v[28:31], v[140:143], v[100:103], v[28:31]
    v_mfma_f32_16x16x32_bf16 v[60:63], v[140:143], v[104:107], v[60:63]
    v_mfma_f32_16x16x32_bf16 v[176:179], v[140:143], v[172:175], v[176:179]
    v_mfma_f32_16x16x32_bf16 v[32:35], v[144:147], v[100:103], v[32:35]
    v_mfma_f32_16x16x32_bf16 v[64:67], v[144:147], v[104:107], v[64:67]
    s_waitcnt lgkmcnt(0)
    s_barrier
    v_mfma_f32_16x16x32_bf16 v[180:183], v[144:147], v[172:175], v[180:183]
    v_add_u32 v9, 0x18000, v7
    v_add_u32 v10, 0x18000, v8
    v_add_u32 v19, 0x18000, v11
    v_mfma_f32_16x16x32_bf16 v[36:39], v[148:151], v[100:103], v[36:39]
    v_add_u32 v20, 0x18000, v12
    v_add_u32 v21, 0x18000, v13
    v_mfma_f32_16x16x32_bf16 v[68:71], v[148:151], v[104:107], v[68:71]
    v_add_u32 v22, 0x18000, v14
    v_add_u32 v23, 0x18000, v15
    v_mfma_f32_16x16x32_bf16 v[184:187], v[172:175], v[100:103], v[184:187]
    v_add_u32 v24, 0x18000, v16
    v_add_u32 v25, 0x18000, v17
    v_add_u32 v26, 0x18000, v18
    v_mfma_f32_16x16x32_bf16 v[40:43], v[152:155], v[100:103], v[40:43]
    ds_read_b128 v[92:95], v9 offset:0
    ds_read_b128 v[96:99], v9 offset:2048
    v_mfma_f32_16x16x32_bf16 v[72:75], v[152:155], v[104:107], v[72:75]
    ds_read_b64_tr_b16 v[108:109], v19 offset:0
    ds_read_b64_tr_b16 v[110:111], v19 offset:2048
    v_mfma_f32_16x16x32_bf16 v[188:191], v[172:175], v[104:107], v[188:191]
    ds_read_b64_tr_b16 v[112:113], v20 offset:0
    ds_read_b64_tr_b16 v[114:115], v20 offset:2048
    ds_read_b64_tr_b16 v[116:117], v21 offset:0
    v_mfma_f32_16x16x32_bf16 v[44:47], v[156:159], v[100:103], v[44:47]
    ds_read_b64_tr_b16 v[118:119], v21 offset:2048
    ds_read_b64_tr_b16 v[120:121], v22 offset:0
    v_mfma_f32_16x16x32_bf16 v[76:79], v[156:159], v[104:107], v[76:79]
    ds_read_b64_tr_b16 v[122:123], v22 offset:2048
    ds_read_b64_tr_b16 v[124:125], v23 offset:0
    v_mfma_f32_16x16x32_bf16 v[192:195], v[100:103], v[100:103], v[192:195]
    ds_read_b64_tr_b16 v[126:127], v23 offset:2048
    ds_read_b64_tr_b16 v[128:129], v24 offset:0
    ds_read_b64_tr_b16 v[130:131], v24 offset:2048
    v_mfma_f32_16x16x32_bf16 v[48:51], v[160:163], v[100:103], v[48:51]
    ds_read_b64_tr_b16 v[132:133], v25 offset:0
    ds_read_b64_tr_b16 v[134:135], v25 offset:2048
    v_mfma_f32_16x16x32_bf16 v[80:83], v[160:163], v[104:107], v[80:83]
    ds_read_b64_tr_b16 v[136:137], v26 offset:0
    ds_read_b64_tr_b16 v[138:139], v26 offset:2048
    v_mfma_f32_16x16x32_bf16 v[196:199], v[104:107], v[104:107], v[196:199]
    v_mfma_f32_16x16x32_bf16 v[52:55], v[164:167], v[100:103], v[52:55]
    v_mfma_f32_16x16x32_bf16 v[84:87], v[164:167], v[104:107], v[84:87]
    v_mfma_f32_16x16x32_bf16 v[56:59], v[168:171], v[100:103], v[56:59]
    v_mfma_f32_16x16x32_bf16 v[88:91], v[168:171], v[104:107], v[88:91]
    s_waitcnt lgkmcnt(0)
    v_mfma_f32_16x16x32_bf16 v[28:31], v[108:111], v[92:95], v[28:31]
    ds_read_b128 v[100:103], v10 offset:0
    ds_read_b128 v[104:107], v10 offset:2048
    v_mfma_f32_16x16x32_bf16 v[60:63], v[108:111], v[96:99], v[60:63]
    ds_read_b64_tr_b16 v[140:141], v19 offset:8192
    v_mfma_f32_16x16x32_bf16 v[176:179], v[108:111], v[172:175], v[176:179]
    ds_read_b64_tr_b16 v[142:143], v19 offset:10240
    v_mfma_f32_16x16x32_bf16 v[32:35], v[112:115], v[92:95], v[32:35]
    ds_read_b64_tr_b16 v[144:145], v20 offset:8192
    v_mfma_f32_16x16x32_bf16 v[64:67], v[112:115], v[96:99], v[64:67]
    ds_read_b64_tr_b16 v[146:147], v20 offset:10240
    v_mfma_f32_16x16x32_bf16 v[180:183], v[112:115], v[172:175], v[180:183]
    ds_read_b64_tr_b16 v[148:149], v21 offset:8192
    v_mfma_f32_16x16x32_bf16 v[36:39], v[116:119], v[92:95], v[36:39]
    ds_read_b64_tr_b16 v[150:151], v21 offset:10240
    v_mfma_f32_16x16x32_bf16 v[68:71], v[116:119], v[96:99], v[68:71]
    ds_read_b64_tr_b16 v[152:153], v22 offset:8192
    v_mfma_f32_16x16x32_bf16 v[184:187], v[172:175], v[92:95], v[184:187]
    ds_read_b64_tr_b16 v[154:155], v22 offset:10240
    ds_read_b64_tr_b16 v[156:157], v23 offset:8192
    v_mfma_f32_16x16x32_bf16 v[40:43], v[120:123], v[92:95], v[40:43]
    ds_read_b64_tr_b16 v[158:159], v23 offset:10240
    v_mfma_f32_16x16x32_bf16 v[72:75], v[120:123], v[96:99], v[72:75]
    ds_read_b64_tr_b16 v[160:161], v24 offset:8192
    v_mfma_f32_16x16x32_bf16 v[188:191], v[172:175], v[96:99], v[188:191]
    ds_read_b64_tr_b16 v[162:163], v24 offset:10240
    v_mfma_f32_16x16x32_bf16 v[44:47], v[124:127], v[92:95], v[44:47]
    ds_read_b64_tr_b16 v[164:165], v25 offset:8192
    v_mfma_f32_16x16x32_bf16 v[76:79], v[124:127], v[96:99], v[76:79]
    ds_read_b64_tr_b16 v[166:167], v25 offset:10240
    v_mfma_f32_16x16x32_bf16 v[192:195], v[92:95], v[92:95], v[192:195]
    ds_read_b64_tr_b16 v[168:169], v26 offset:8192
    v_mfma_f32_16x16x32_bf16 v[48:51], v[128:131], v[92:95], v[48:51]
    ds_read_b64_tr_b16 v[170:171], v26 offset:10240
    v_mfma_f32_16x16x32_bf16 v[80:83], v[128:131], v[96:99], v[80:83]
    v_mfma_f32_16x16x32_bf16 v[196:199], v[96:99], v[96:99], v[196:199]
    v_mfma_f32_16x16x32_bf16 v[52:55], v[132:135], v[92:95], v[52:55]
    v_mfma_f32_16x16x32_bf16 v[84:87], v[132:135], v[96:99], v[84:87]
    v_mfma_f32_16x16x32_bf16 v[56:59], v[136:139], v[92:95], v[56:59]
    v_mfma_f32_16x16x32_bf16 v[88:91], v[136:139], v[96:99], v[88:91]
    s_waitcnt lgkmcnt(0)
    v_mfma_f32_16x16x32_bf16 v[28:31], v[140:143], v[100:103], v[28:31]
    v_mfma_f32_16x16x32_bf16 v[60:63], v[140:143], v[104:107], v[60:63]
    v_mfma_f32_16x16x32_bf16 v[176:179], v[140:143], v[172:175], v[176:179]
    v_mfma_f32_16x16x32_bf16 v[32:35], v[144:147], v[100:103], v[32:35]
    v_mfma_f32_16x16x32_bf16 v[64:67], v[144:147], v[104:107], v[64:67]
    s_waitcnt lgkmcnt(0)
    s_barrier
    v_mfma_f32_16x16x32_bf16 v[180:183], v[144:147], v[172:175], v[180:183]
    v_add_u32 v9, 0x0, v7
    v_add_u32 v10, 0x0, v8
    v_add_u32 v19, 0x0, v11
    v_mfma_f32_16x16x32_bf16 v[36:39], v[148:151], v[100:103], v[36:39]
    v_add_u32 v20, 0x0, v12
    v_add_u32 v21, 0x0, v13
    v_mfma_f32_16x16x32_bf16 v[68:71], v[148:151], v[104:107], v[68:71]
    v_add_u32 v22, 0x0, v14
    v_add_u32 v23, 0x0, v15
    v_mfma_f32_16x16x32_bf16 v[184:187], v[172:175], v[100:103], v[184:187]
    v_add_u32 v24, 0x0, v16
    v_add_u32 v25, 0x0, v17
    v_add_u32 v26, 0x0, v18
    v_mfma_f32_16x16x32_bf16 v[40:43], v[152:155], v[100:103], v[40:43]
    ds_read_b128 v[92:95], v9 offset:0
    ds_read_b128 v[96:99], v9 offset:2048
    v_mfma_f32_16x16x32_bf16 v[72:75], v[152:155], v[104:107], v[72:75]
    ds_read_b64_tr_b16 v[108:109], v19 offset:0
    ds_read_b64_tr_b16 v[110:111], v19 offset:2048
    v_mfma_f32_16x16x32_bf16 v[188:191], v[172:175], v[104:107], v[188:191]
    ds_read_b64_tr_b16 v[112:113], v20 offset:0
    ds_read_b64_tr_b16 v[114:115], v20 offset:2048
    ds_read_b64_tr_b16 v[116:117], v21 offset:0
    v_mfma_f32_16x16x32_bf16 v[44:47], v[156:159], v[100:103], v[44:47]
    ds_read_b64_tr_b16 v[118:119], v21 offset:2048
    ds_read_b64_tr_b16 v[120:121], v22 offset:0
    v_mfma_f32_16x16x32_bf16 v[76:79], v[156:159], v[104:107], v[76:79]
    ds_read_b64_tr_b16 v[122:123], v22 offset:2048
    ds_read_b64_tr_b16 v[124:125], v23 offset:0
    v_mfma_f32_16x16x32_bf16 v[192:195], v[100:103], v[100:103], v[192:195]
    ds_read_b64_tr_b16 v[126:127], v23 offset:2048
    ds_read_b64_tr_b16 v[128:129], v24 offset:0
    ds_read_b64_tr_b16 v[130:131], v24 offset:2048
    v_mfma_f32_16x16x32_bf16 v[48:51], v[160:163], v[100:103], v[48:51]
    ds_read_b64_tr_b16 v[132:133], v25 offset:0
    ds_read_b64_tr_b16 v[134:135], v25 offset:2048
    v_mfma_f32_16x16x32_bf16 v[80:83], v[160:163], v[104:107], v[80:83]
    ds_read_b64_tr_b16 v[136:137], v26 offset:0
    ds_read_b64_tr_b16 v[138:139], v26 offset:2048
    v_mfma_f32_16x16x32_bf16 v[196:199], v[104:107], v[104:107], v[196:199]
    v_mfma_f32_16x16x32_bf16 v[52:55], v[164:167], v[100:103], v[52:55]
    v_mfma_f32_16x16x32_bf16 v[84:87], v[164:167], v[104:107], v[84:87]
    v_mfma_f32_16x16x32_bf16 v[56:59], v[168:171], v[100:103], v[56:59]
    v_mfma_f32_16x16x32_bf16 v[88:91], v[168:171], v[104:107], v[88:91]
    s_waitcnt lgkmcnt(0)
    v_mfma_f32_16x16x32_bf16 v[28:31], v[108:111], v[92:95], v[28:31]
    ds_read_b128 v[100:103], v10 offset:0
    ds_read_b128 v[104:107], v10 offset:2048
    v_mfma_f32_16x16x32_bf16 v[60:63], v[108:111], v[96:99], v[60:63]
    ds_read_b64_tr_b16 v[140:141], v19 offset:8192
    v_mfma_f32_16x16x32_bf16 v[176:179], v[108:111], v[172:175], v[176:179]
    ds_read_b64_tr_b16 v[142:143], v19 offset:10240
    v_mfma_f32_16x16x32_bf16 v[32:35], v[112:115], v[92:95], v[32:35]
    ds_read_b64_tr_b16 v[144:145], v20 offset:8192
    v_mfma_f32_16x16x32_bf16 v[64:67], v[112:115], v[96:99], v[64:67]
    ds_read_b64_tr_b16 v[146:147], v20 offset:10240
    v_mfma_f32_16x16x32_bf16 v[180:183], v[112:115], v[172:175], v[180:183]
    ds_read_b64_tr_b16 v[148:149], v21 offset:8192
    v_mfma_f32_16x16x32_bf16 v[36:39], v[116:119], v[92:95], v[36:39]
    ds_read_b64_tr_b16 v[150:151], v21 offset:10240
    v_mfma_f32_16x16x32_bf16 v[68:71], v[116:119], v[96:99], v[68:71]
    ds_read_b64_tr_b16 v[152:153], v22 offset:8192
    v_mfma_f32_16x16x32_bf16 v[184:187], v[172:175], v[92:95], v[184:187]
    ds_read_b64_tr_b16 v[154:155], v22 offset:10240
    ds_read_b64_tr_b16 v[156:157], v23 offset:8192
    v_mfma_f32_16x16x32_bf16 v[40:43], v[120:123], v[92:95], v[40:43]
    ds_read_b64_tr_b16 v[158:159], v23 offset:10240
    v_mfma_f32_16x16x32_bf16 v[72:75], v[120:123], v[96:99], v[72:75]
    ds_read_b64_tr_b16 v[160:161], v24 offset:8192
    v_mfma_f32_16x16x32_bf16 v[188:191], v[172:175], v[96:99], v[188:191]
    ds_read_b64_tr_b16 v[162:163], v24 offset:10240
    v_mfma_f32_16x16x32_bf16 v[44:47], v[124:127], v[92:95], v[44:47]
    ds_read_b64_tr_b16 v[164:165], v25 offset:8192
    v_mfma_f32_16x16x32_bf16 v[76:79], v[124:127], v[96:99], v[76:79]
    ds_read_b64_tr_b16 v[166:167], v25 offset:10240
    v_mfma_f32_16x16x32_bf16 v[192:195], v[92:95], v[92:95], v[192:195]
    ds_read_b64_tr_b16 v[168:169], v26 offset:8192
    v_mfma_f32_16x16x32_bf16 v[48:51], v[128:131], v[92:95], v[48:51]
    ds_read_b64_tr_b16 v[170:171], v26 offset:10240
    v_mfma_f32_16x16x32_bf16 v[80:83], v[128:131], v[96:99], v[80:83]
    v_mfma_f32_16x16x32_bf16 v[196:199], v[96:99], v[96:99], v[196:199]
    v_mfma_f32_16x16x32_bf16 v[52:55], v[132:135], v[92:95], v[52:55]
    v_mfma_f32_16x16x32_bf16 v[84:87], v[132:135], v[96:99], v[84:87]
    v_mfma_f32_16x16x32_bf16 v[56:59], v[136:139], v[92:95], v[56:59]
    v_mfma_f32_16x16x32_bf16 v[88:91], v[136:139], v[96:99], v[88:91]
    s_waitcnt lgkmcnt(0)
    v_mfma_f32_16x16x32_bf16 v[28:31], v[140:143], v[100:103], v[28:31]
    v_mfma_f32_16x16x32_bf16 v[60:63], v[140:143], v[104:107], v[60:63]
    v_mfma_f32_16x16x32_bf16 v[176:179], v[140:143], v[172:175], v[176:179]
    v_mfma_f32_16x16x32_bf16 v[32:35], v[144:147], v[100:103], v[32:35]
    v_mfma_f32_16x16x32_bf16 v[64:67], v[144:147], v[104:107], v[64:67]
    s_waitcnt lgkmcnt(0)
    s_barrier
    v_mfma_f32_16x16x32_bf16 v[180:183], v[144:147], v[172:175], v[180:183]
    v_add_u32 v9, 0x8000, v7
    v_add_u32 v10, 0x8000, v8
    v_add_u32 v19, 0x8000, v11
    v_mfma_f32_16x16x32_bf16 v[36:39], v[148:151], v[100:103], v[36:39]
    v_add_u32 v20, 0x8000, v12
    v_add_u32 v21, 0x8000, v13
    v_mfma_f32_16x16x32_bf16 v[68:71], v[148:151], v[104:107], v[68:71]
    v_add_u32 v22, 0x8000, v14
    v_add_u32 v23, 0x8000, v15
    v_mfma_f32_16x16x32_bf16 v[184:187], v[172:175], v[100:103], v[184:187]
    v_add_u32 v24, 0x8000, v16
    v_add_u32 v25, 0x8000, v17
    v_add_u32 v26, 0x8000, v18
    v_mfma_f32_16x16x32_bf16 v[40:43], v[152:155], v[100:103], v[40:43]
    ds_read_b128 v[92:95], v9 offset:0
    ds_read_b128 v[96:99], v9 offset:2048
    v_mfma_f32_16x16x32_bf16 v[72:75], v[152:155], v[104:107], v[72:75]
    ds_read_b64_tr_b16 v[108:109], v19 offset:0
    ds_read_b64_tr_b16 v[110:111], v19 offset:2048
    v_mfma_f32_16x16x32_bf16 v[188:191], v[172:175], v[104:107], v[188:191]
    ds_read_b64_tr_b16 v[112:113], v20 offset:0
    ds_read_b64_tr_b16 v[114:115], v20 offset:2048
    ds_read_b64_tr_b16 v[116:117], v21 offset:0
    v_mfma_f32_16x16x32_bf16 v[44:47], v[156:159], v[100:103], v[44:47]
    ds_read_b64_tr_b16 v[118:119], v21 offset:2048
    ds_read_b64_tr_b16 v[120:121], v22 offset:0
    v_mfma_f32_16x16x32_bf16 v[76:79], v[156:159], v[104:107], v[76:79]
    ds_read_b64_tr_b16 v[122:123], v22 offset:2048
    ds_read_b64_tr_b16 v[124:125], v23 offset:0
    v_mfma_f32_16x16x32_bf16 v[192:195], v[100:103], v[100:103], v[192:195]
    ds_read_b64_tr_b16 v[126:127], v23 offset:2048
    ds_read_b64_tr_b16 v[128:129], v24 offset:0
    ds_read_b64_tr_b16 v[130:131], v24 offset:2048
    v_mfma_f32_16x16x32_bf16 v[48:51], v[160:163], v[100:103], v[48:51]
    ds_read_b64_tr_b16 v[132:133], v25 offset:0
    ds_read_b64_tr_b16 v[134:135], v25 offset:2048
    v_mfma_f32_16x16x32_bf16 v[80:83], v[160:163], v[104:107], v[80:83]
    ds_read_b64_tr_b16 v[136:137], v26 offset:0
    ds_read_b64_tr_b16 v[138:139], v26 offset:2048
    v_mfma_f32_16x16x32_bf16 v[196:199], v[104:107], v[104:107], v[196:199]
    v_mfma_f32_16x16x32_bf16 v[52:55], v[164:167], v[100:103], v[52:55]
    v_mfma_f32_16x16x32_bf16 v[84:87], v[164:167], v[104:107], v[84:87]
    v_mfma_f32_16x16x32_bf16 v[56:59], v[168:171], v[100:103], v[56:59]
    v_mfma_f32_16x16x32_bf16 v[88:91], v[168:171], v[104:107], v[88:91]
    s_waitcnt lgkmcnt(0)
    v_mfma_f32_16x16x32_bf16 v[28:31], v[108:111], v[92:95], v[28:31]
    ds_read_b128 v[100:103], v10 offset:0
    ds_read_b128 v[104:107], v10 offset:2048
    v_mfma_f32_16x16x32_bf16 v[60:63], v[108:111], v[96:99], v[60:63]
    ds_read_b64_tr_b16 v[140:141], v19 offset:8192
    v_mfma_f32_16x16x32_bf16 v[176:179], v[108:111], v[172:175], v[176:179]
    ds_read_b64_tr_b16 v[142:143], v19 offset:10240
    v_mfma_f32_16x16x32_bf16 v[32:35], v[112:115], v[92:95], v[32:35]
    ds_read_b64_tr_b16 v[144:145], v20 offset:8192
    v_mfma_f32_16x16x32_bf16 v[64:67], v[112:115], v[96:99], v[64:67]
    ds_read_b64_tr_b16 v[146:147], v20 offset:10240
    v_mfma_f32_16x16x32_bf16 v[180:183], v[112:115], v[172:175], v[180:183]
    ds_read_b64_tr_b16 v[148:149], v21 offset:8192
    v_mfma_f32_16x16x32_bf16 v[36:39], v[116:119], v[92:95], v[36:39]
    ds_read_b64_tr_b16 v[150:151], v21 offset:10240
    v_mfma_f32_16x16x32_bf16 v[68:71], v[116:119], v[96:99], v[68:71]
    ds_read_b64_tr_b16 v[152:153], v22 offset:8192
    v_mfma_f32_16x16x32_bf16 v[184:187], v[172:175], v[92:95], v[184:187]
    ds_read_b64_tr_b16 v[154:155], v22 offset:10240
    ds_read_b64_tr_b16 v[156:157], v23 offset:8192
    v_mfma_f32_16x16x32_bf16 v[40:43], v[120:123], v[92:95], v[40:43]
    ds_read_b64_tr_b16 v[158:159], v23 offset:10240
    v_mfma_f32_16x16x32_bf16 v[72:75], v[120:123], v[96:99], v[72:75]
    ds_read_b64_tr_b16 v[160:161], v24 offset:8192
    v_mfma_f32_16x16x32_bf16 v[188:191], v[172:175], v[96:99], v[188:191]
    ds_read_b64_tr_b16 v[162:163], v24 offset:10240
    v_mfma_f32_16x16x32_bf16 v[44:47], v[124:127], v[92:95], v[44:47]
    ds_read_b64_tr_b16 v[164:165], v25 offset:8192
    v_mfma_f32_16x16x32_bf16 v[76:79], v[124:127], v[96:99], v[76:79]
    ds_read_b64_tr_b16 v[166:167], v25 offset:10240
    v_mfma_f32_16x16x32_bf16 v[192:195], v[92:95], v[92:95], v[192:195]
    ds_read_b64_tr_b16 v[168:169], v26 offset:8192
    v_mfma_f32_16x16x32_bf16 v[48:51], v[128:131], v[92:95], v[48:51]
    ds_read_b64_tr_b16 v[170:171], v26 offset:10240
    v_mfma_f32_16x16x32_bf16 v[80:83], v[128:131], v[96:99], v[80:83]
    v_mfma_f32_16x16x32_bf16 v[196:199], v[96:99], v[96:99], v[196:199]
    v_mfma_f32_16x16x32_bf16 v[52:55], v[132:135], v[92:95], v[52:55]
    v_mfma_f32_16x16x32_bf16 v[84:87], v[132:135], v[96:99], v[84:87]
    v_mfma_f32_16x16x32_bf16 v[56:59], v[136:139], v[92:95], v[56:59]
    v_mfma_f32_16x16x32_bf16 v[88:91], v[136:139], v[96:99], v[88:91]
    s_waitcnt lgkmcnt(0)
    v_mfma_f32_16x16x32_bf16 v[28:31], v[140:143], v[100:103], v[28:31]
    v_mfma_f32_16x16x32_bf16 v[60:63], v[140:143], v[104:107], v[60:63]
    v_mfma_f32_16x16x32_bf16 v[176:179], v[140:143], v[172:175], v[176:179]
    v_mfma_f32_16x16x32_bf16 v[32:35], v[144:147], v[100:103], v[32:35]
    v_mfma_f32_16x16x32_bf16 v[64:67], v[144:147], v[104:107], v[64:67]
    s_waitcnt lgkmcnt(0)
    s_barrier
    v_mfma_f32_16x16x32_bf16 v[180:183], v[144:147], v[172:175], v[180:183]
    v_add_u32 v9, 0x10000, v7
    v_add_u32 v10, 0x10000, v8
    v_add_u32 v19, 0x10000, v11
    v_mfma_f32_16x16x32_bf16 v[36:39], v[148:151], v[100:103], v[36:39]
    v_add_u32 v20, 0x10000, v12
    v_add_u32 v21, 0x10000, v13
    v_mfma_f32_16x16x32_bf16 v[68:71], v[148:151], v[104:107], v[68:71]
    v_add_u32 v22, 0x10000, v14
    v_add_u32 v23, 0x10000, v15
    v_mfma_f32_16x16x32_bf16 v[184:187], v[172:175], v[100:103], v[184:187]
    v_add_u32 v24, 0x10000, v16
    v_add_u32 v25, 0x10000, v17
    v_add_u32 v26, 0x10000, v18
    v_mfma_f32_16x16x32_bf16 v[40:43], v[152:155], v[100:103], v[40:43]
    ds_read_b128 v[92:95], v9 offset:0
    ds_read_b128 v[96:99], v9 offset:2048
    v_mfma_f32_16x16x32_bf16 v[72:75], v[152:155], v[104:107], v[72:75]
    ds_read_b64_tr_b16 v[108:109], v19 offset:0
    ds_read_b64_tr_b16 v[110:111], v19 offset:2048
    v_mfma_f32_16x16x32_bf16 v[188:191], v[172:175], v[104:107], v[188:191]
    ds_read_b64_tr_b16 v[112:113], v20 offset:0
    ds_read_b64_tr_b16 v[114:115], v20 offset:2048
    ds_read_b64_tr_b16 v[116:117], v21 offset:0
    v_mfma_f32_16x16x32_bf16 v[44:47], v[156:159], v[100:103], v[44:47]
    ds_read_b64_tr_b16 v[118:119], v21 offset:2048
    ds_read_b64_tr_b16 v[120:121], v22 offset:0
    v_mfma_f32_16x16x32_bf16 v[76:79], v[156:159], v[104:107], v[76:79]
    ds_read_b64_tr_b16 v[122:123], v22 offset:2048
    ds_read_b64_tr_b16 v[124:125], v23 offset:0
    v_mfma_f32_16x16x32_bf16 v[192:195], v[100:103], v[100:103], v[192:195]
    ds_read_b64_tr_b16 v[126:127], v23 offset:2048
    ds_read_b64_tr_b16 v[128:129], v24 offset:0
    ds_read_b64_tr_b16 v[130:131], v24 offset:2048
    v_mfma_f32_16x16x32_bf16 v[48:51], v[160:163], v[100:103], v[48:51]
    ds_read_b64_tr_b16 v[132:133], v25 offset:0
    ds_read_b64_tr_b16 v[134:135], v25 offset:2048
    v_mfma_f32_16x16x32_bf16 v[80:83], v[160:163], v[104:107], v[80:83]
    ds_read_b64_tr_b16 v[136:137], v26 offset:0
    ds_read_b64_tr_b16 v[138:139], v26 offset:2048
    v_mfma_f32_16x16x32_bf16 v[196:199], v[104:107], v[104:107], v[196:199]
    v_mfma_f32_16x16x32_bf16 v[52:55], v[164:167], v[100:103], v[52:55]
    v_mfma_f32_16x16x32_bf16 v[84:87], v[164:167], v[104:107], v[84:87]
    v_mfma_f32_16x16x32_bf16 v[56:59], v[168:171], v[100:103], v[56:59]
    v_mfma_f32_16x16x32_bf16 v[88:91], v[168:171], v[104:107], v[88:91]
    s_waitcnt lgkmcnt(0)
    v_mfma_f32_16x16x32_bf16 v[28:31], v[108:111], v[92:95], v[28:31]
    ds_read_b128 v[100:103], v10 offset:0
    ds_read_b128 v[104:107], v10 offset:2048
    v_mfma_f32_16x16x32_bf16 v[60:63], v[108:111], v[96:99], v[60:63]
    ds_read_b64_tr_b16 v[140:141], v19 offset:8192
    v_mfma_f32_16x16x32_bf16 v[176:179], v[108:111], v[172:175], v[176:179]
    ds_read_b64_tr_b16 v[142:143], v19 offset:10240
    v_mfma_f32_16x16x32_bf16 v[32:35], v[112:115], v[92:95], v[32:35]
    ds_read_b64_tr_b16 v[144:145], v20 offset:8192
    v_mfma_f32_16x16x32_bf16 v[64:67], v[112:115], v[96:99], v[64:67]
    ds_read_b64_tr_b16 v[146:147], v20 offset:10240
    v_mfma_f32_16x16x32_bf16 v[180:183], v[112:115], v[172:175], v[180:183]
    ds_read_b64_tr_b16 v[148:149], v21 offset:8192
    v_mfma_f32_16x16x32_bf16 v[36:39], v[116:119], v[92:95], v[36:39]
    ds_read_b64_tr_b16 v[150:151], v21 offset:10240
    v_mfma_f32_16x16x32_bf16 v[68:71], v[116:119], v[96:99], v[68:71]
    ds_read_b64_tr_b16 v[152:153], v22 offset:8192
    v_mfma_f32_16x16x32_bf16 v[184:187], v[172:175], v[92:95], v[184:187]
    ds_read_b64_tr_b16 v[154:155], v22 offset:10240
    ds_read_b64_tr_b16 v[156:157], v23 offset:8192
    v_mfma_f32_16x16x32_bf16 v[40:43], v[120:123], v[92:95], v[40:43]
    ds_read_b64_tr_b16 v[158:159], v23 offset:10240
    v_mfma_f32_16x16x32_bf16 v[72:75], v[120:123], v[96:99], v[72:75]
    ds_read_b64_tr_b16 v[160:161], v24 offset:8192
    v_mfma_f32_16x16x32_bf16 v[188:191], v[172:175], v[96:99], v[188:191]
    ds_read_b64_tr_b16 v[162:163], v24 offset:10240
    v_mfma_f32_16x16x32_bf16 v[44:47], v[124:127], v[92:95], v[44:47]
    ds_read_b64_tr_b16 v[164:165], v25 offset:8192
    v_mfma_f32_16x16x32_bf16 v[76:79], v[124:127], v[96:99], v[76:79]
    ds_read_b64_tr_b16 v[166:167], v25 offset:10240
    v_mfma_f32_16x16x32_bf16 v[192:195], v[92:95], v[92:95], v[192:195]
    ds_read_b64_tr_b16 v[168:169], v26 offset:8192
    v_mfma_f32_16x16x32_bf16 v[48:51], v[128:131], v[92:95], v[48:51]
    ds_read_b64_tr_b16 v[170:171], v26 offset:10240
    v_mfma_f32_16x16x32_bf16 v[80:83], v[128:131], v[96:99], v[80:83]
    v_mfma_f32_16x16x32_bf16 v[196:199], v[96:99], v[96:99], v[196:199]
    v_mfma_f32_16x16x32_bf16 v[52:55], v[132:135], v[92:95], v[52:55]
    v_mfma_f32_16x16x32_bf16 v[84:87], v[132:135], v[96:99], v[84:87]
    v_mfma_f32_16x16x32_bf16 v[56:59], v[136:139], v[92:95], v[56:59]
    v_mfma_f32_16x16x32_bf16 v[88:91], v[136:139], v[96:99], v[88:91]
    s_waitcnt lgkmcnt(0)
    v_mfma_f32_16x16x32_bf16 v[28:31], v[140:143], v[100:103], v[28:31]
    v_mfma_f32_16x16x32_bf16 v[60:63], v[140:143], v[104:107], v[60:63]
    v_mfma_f32_16x16x32_bf16 v[176:179], v[140:143], v[172:175], v[176:179]
    v_mfma_f32_16x16x32_bf16 v[32:35], v[144:147], v[100:103], v[32:35]
    v_mfma_f32_16x16x32_bf16 v[64:67], v[144:147], v[104:107], v[64:67]
    s_waitcnt lgkmcnt(0)
    s_barrier
    v_mfma_f32_16x16x32_bf16 v[180:183], v[144:147], v[172:175], v[180:183]
    v_add_u32 v9, 0x18000, v7
    v_add_u32 v10, 0x18000, v8
    v_add_u32 v19, 0x18000, v11
    v_mfma_f32_16x16x32_bf16 v[36:39], v[148:151], v[100:103], v[36:39]
    v_add_u32 v20, 0x18000, v12
    v_add_u32 v21, 0x18000, v13
    v_mfma_f32_16x16x32_bf16 v[68:71], v[148:151], v[104:107], v[68:71]
    v_add_u32 v22, 0x18000, v14
    v_add_u32 v23, 0x18000, v15
    v_mfma_f32_16x16x32_bf16 v[184:187], v[172:175], v[100:103], v[184:187]
    v_add_u32 v24, 0x18000, v16
    v_add_u32 v25, 0x18000, v17
    v_add_u32 v26, 0x18000, v18
    v_mfma_f32_16x16x32_bf16 v[40:43], v[152:155], v[100:103], v[40:43]
    ds_read_b128 v[92:95], v9 offset:0
    ds_read_b128 v[96:99], v9 offset:2048
    v_mfma_f32_16x16x32_bf16 v[72:75], v[152:155], v[104:107], v[72:75]
    ds_read_b64_tr_b16 v[108:109], v19 offset:0
    ds_read_b64_tr_b16 v[110:111], v19 offset:2048
    v_mfma_f32_16x16x32_bf16 v[188:191], v[172:175], v[104:107], v[188:191]
    ds_read_b64_tr_b16 v[112:113], v20 offset:0
    ds_read_b64_tr_b16 v[114:115], v20 offset:2048
    ds_read_b64_tr_b16 v[116:117], v21 offset:0
    v_mfma_f32_16x16x32_bf16 v[44:47], v[156:159], v[100:103], v[44:47]
    ds_read_b64_tr_b16 v[118:119], v21 offset:2048
    ds_read_b64_tr_b16 v[120:121], v22 offset:0
    v_mfma_f32_16x16x32_bf16 v[76:79], v[156:159], v[104:107], v[76:79]
    ds_read_b64_tr_b16 v[122:123], v22 offset:2048
    ds_read_b64_tr_b16 v[124:125], v23 offset:0
    v_mfma_f32_16x16x32_bf16 v[192:195], v[100:103], v[100:103], v[192:195]
    ds_read_b64_tr_b16 v[126:127], v23 offset:2048
    ds_read_b64_tr_b16 v[128:129], v24 offset:0
    ds_read_b64_tr_b16 v[130:131], v24 offset:2048
    v_mfma_f32_16x16x32_bf16 v[48:51], v[160:163], v[100:103], v[48:51]
    ds_read_b64_tr_b16 v[132:133], v25 offset:0
    ds_read_b64_tr_b16 v[134:135], v25 offset:2048
    v_mfma_f32_16x16x32_bf16 v[80:83], v[160:163], v[104:107], v[80:83]
    ds_read_b64_tr_b16 v[136:137], v26 offset:0
    ds_read_b64_tr_b16 v[138:139], v26 offset:2048
    v_mfma_f32_16x16x32_bf16 v[196:199], v[104:107], v[104:107], v[196:199]
    v_mfma_f32_16x16x32_bf16 v[52:55], v[164:167], v[100:103], v[52:55]
    v_mfma_f32_16x16x32_bf16 v[84:87], v[164:167], v[104:107], v[84:87]
    v_mfma_f32_16x16x32_bf16 v[56:59], v[168:171], v[100:103], v[56:59]
    v_mfma_f32_16x16x32_bf16 v[88:91], v[168:171], v[104:107], v[88:91]
    s_waitcnt lgkmcnt(0)
    v_mfma_f32_16x16x32_bf16 v[28:31], v[108:111], v[92:95], v[28:31]
    ds_read_b128 v[100:103], v10 offset:0
    ds_read_b128 v[104:107], v10 offset:2048
    v_mfma_f32_16x16x32_bf16 v[60:63], v[108:111], v[96:99], v[60:63]
    ds_read_b64_tr_b16 v[140:141], v19 offset:8192
    v_mfma_f32_16x16x32_bf16 v[176:179], v[108:111], v[172:175], v[176:179]
    ds_read_b64_tr_b16 v[142:143], v19 offset:10240
    v_mfma_f32_16x16x32_bf16 v[32:35], v[112:115], v[92:95], v[32:35]
    ds_read_b64_tr_b16 v[144:145], v20 offset:8192
    v_mfma_f32_16x16x32_bf16 v[64:67], v[112:115], v[96:99], v[64:67]
    ds_read_b64_tr_b16 v[146:147], v20 offset:10240
    v_mfma_f32_16x16x32_bf16 v[180:183], v[112:115], v[172:175], v[180:183]
    ds_read_b64_tr_b16 v[148:149], v21 offset:8192
    v_mfma_f32_16x16x32_bf16 v[36:39], v[116:119], v[92:95], v[36:39]
    ds_read_b64_tr_b16 v[150:151], v21 offset:10240
    v_mfma_f32_16x16x32_bf16 v[68:71], v[116:119], v[96:99], v[68:71]
    ds_read_b64_tr_b16 v[152:153], v22 offset:8192
    v_mfma_f32_16x16x32_bf16 v[184:187], v[172:175], v[92:95], v[184:187]
    ds_read_b64_tr_b16 v[154:155], v22 offset:10240
    ds_read_b64_tr_b16 v[156:157], v23 offset:8192
    v_mfma_f32_16x16x32_bf16 v[40:43], v[120:123], v[92:95], v[40:43]
    ds_read_b64_tr_b16 v[158:159], v23 offset:10240
    v_mfma_f32_16x16x32_bf16 v[72:75], v[120:123], v[96:99], v[72:75]
    ds_read_b64_tr_b16 v[160:161], v24 offset:8192
    v_mfma_f32_16x16x32_bf16 v[188:191], v[172:175], v[96:99], v[188:191]
    ds_read_b64_tr_b16 v[162:163], v24 offset:10240
    v_mfma_f32_16x16x32_bf16 v[44:47], v[124:127], v[92:95], v[44:47]
    ds_read_b64_tr_b16 v[164:165], v25 offset:8192
    v_mfma_f32_16x16x32_bf16 v[76:79], v[124:127], v[96:99], v[76:79]
    ds_read_b64_tr_b16 v[166:167], v25 offset:10240
    v_mfma_f32_16x16x32_bf16 v[192:195], v[92:95], v[92:95], v[192:195]
    ds_read_b64_tr_b16 v[168:169], v26 offset:8192
    v_mfma_f32_16x16x32_bf16 v[48:51], v[128:131], v[92:95], v[48:51]
    ds_read_b64_tr_b16 v[170:171], v26 offset:10240
    v_mfma_f32_16x16x32_bf16 v[80:83], v[128:131], v[96:99], v[80:83]
    v_mfma_f32_16x16x32_bf16 v[196:199], v[96:99], v[96:99], v[196:199]
    v_mfma_f32_16x16x32_bf16 v[52:55], v[132:135], v[92:95], v[52:55]
    v_mfma_f32_16x16x32_bf16 v[84:87], v[132:135], v[96:99], v[84:87]
    v_mfma_f32_16x16x32_bf16 v[56:59], v[136:139], v[92:95], v[56:59]
    v_mfma_f32_16x16x32_bf16 v[88:91], v[136:139], v[96:99], v[88:91]
    s_waitcnt lgkmcnt(0)
    v_mfma_f32_16x16x32_bf16 v[28:31], v[140:143], v[100:103], v[28:31]
    v_mfma_f32_16x16x32_bf16 v[60:63], v[140:143], v[104:107], v[60:63]
    v_mfma_f32_16x16x32_bf16 v[176:179], v[140:143], v[172:175], v[176:179]
    v_mfma_f32_16x16x32_bf16 v[32:35], v[144:147], v[100:103], v[32:35]
    v_mfma_f32_16x16x32_bf16 v[64:67], v[144:147], v[104:107], v[64:67]
    s_waitcnt lgkmcnt(0)
    s_barrier
    v_mfma_f32_16x16x32_bf16 v[180:183], v[144:147], v[172:175], v[180:183]
    v_add_u32 v9, 0x0, v7
    v_add_u32 v10, 0x0, v8
    v_add_u32 v19, 0x0, v11
    v_mfma_f32_16x16x32_bf16 v[36:39], v[148:151], v[100:103], v[36:39]
    v_add_u32 v20, 0x0, v12
    v_add_u32 v21, 0x0, v13
    v_mfma_f32_16x16x32_bf16 v[68:71], v[148:151], v[104:107], v[68:71]
    v_add_u32 v22, 0x0, v14
    v_add_u32 v23, 0x0, v15
    v_mfma_f32_16x16x32_bf16 v[184:187], v[172:175], v[100:103], v[184:187]
    v_add_u32 v24, 0x0, v16
    v_add_u32 v25, 0x0, v17
    v_add_u32 v26, 0x0, v18
    v_mfma_f32_16x16x32_bf16 v[40:43], v[152:155], v[100:103], v[40:43]
    ds_read_b128 v[92:95], v9 offset:0
    ds_read_b128 v[96:99], v9 offset:2048
    v_mfma_f32_16x16x32_bf16 v[72:75], v[152:155], v[104:107], v[72:75]
    ds_read_b64_tr_b16 v[108:109], v19 offset:0
    ds_read_b64_tr_b16 v[110:111], v19 offset:2048
    v_mfma_f32_16x16x32_bf16 v[188:191], v[172:175], v[104:107], v[188:191]
    ds_read_b64_tr_b16 v[112:113], v20 offset:0
    ds_read_b64_tr_b16 v[114:115], v20 offset:2048
    ds_read_b64_tr_b16 v[116:117], v21 offset:0
    v_mfma_f32_16x16x32_bf16 v[44:47], v[156:159], v[100:103], v[44:47]
    ds_read_b64_tr_b16 v[118:119], v21 offset:2048
    ds_read_b64_tr_b16 v[120:121], v22 offset:0
    v_mfma_f32_16x16x32_bf16 v[76:79], v[156:159], v[104:107], v[76:79]
    ds_read_b64_tr_b16 v[122:123], v22 offset:2048
    ds_read_b64_tr_b16 v[124:125], v23 offset:0
    v_mfma_f32_16x16x32_bf16 v[192:195], v[100:103], v[100:103], v[192:195]
    ds_read_b64_tr_b16 v[126:127], v23 offset:2048
    ds_read_b64_tr_b16 v[128:129], v24 offset:0
    ds_read_b64_tr_b16 v[130:131], v24 offset:2048
    v_mfma_f32_16x16x32_bf16 v[48:51], v[160:163], v[100:103], v[48:51]
    ds_read_b64_tr_b16 v[132:133], v25 offset:0
    ds_read_b64_tr_b16 v[134:135], v25 offset:2048
    v_mfma_f32_16x16x32_bf16 v[80:83], v[160:163], v[104:107], v[80:83]
    ds_read_b64_tr_b16 v[136:137], v26 offset:0
    ds_read_b64_tr_b16 v[138:139], v26 offset:2048
    v_mfma_f32_16x16x32_bf16 v[196:199], v[104:107], v[104:107], v[196:199]
    v_mfma_f32_16x16x32_bf16 v[52:55], v[164:167], v[100:103], v[52:55]
    v_mfma_f32_16x16x32_bf16 v[84:87], v[164:167], v[104:107], v[84:87]
    v_mfma_f32_16x16x32_bf16 v[56:59], v[168:171], v[100:103], v[56:59]
    v_mfma_f32_16x16x32_bf16 v[88:91], v[168:171], v[104:107], v[88:91]
    s_waitcnt lgkmcnt(0)
    v_mfma_f32_16x16x32_bf16 v[28:31], v[108:111], v[92:95], v[28:31]
    ds_read_b128 v[100:103], v10 offset:0
    ds_read_b128 v[104:107], v10 offset:2048
    v_mfma_f32_16x16x32_bf16 v[60:63], v[108:111], v[96:99], v[60:63]
    ds_read_b64_tr_b16 v[140:141], v19 offset:8192
    v_mfma_f32_16x16x32_bf16 v[176:179], v[108:111], v[172:175], v[176:179]
    ds_read_b64_tr_b16 v[142:143], v19 offset:10240
    v_mfma_f32_16x16x32_bf16 v[32:35], v[112:115], v[92:95], v[32:35]
    ds_read_b64_tr_b16 v[144:145], v20 offset:8192
    v_mfma_f32_16x16x32_bf16 v[64:67], v[112:115], v[96:99], v[64:67]
    ds_read_b64_tr_b16 v[146:147], v20 offset:10240
    v_mfma_f32_16x16x32_bf16 v[180:183], v[112:115], v[172:175], v[180:183]
    ds_read_b64_tr_b16 v[148:149], v21 offset:8192
    v_mfma_f32_16x16x32_bf16 v[36:39], v[116:119], v[92:95], v[36:39]
    ds_read_b64_tr_b16 v[150:151], v21 offset:10240
    v_mfma_f32_16x16x32_bf16 v[68:71], v[116:119], v[96:99], v[68:71]
    ds_read_b64_tr_b16 v[152:153], v22 offset:8192
    v_mfma_f32_16x16x32_bf16 v[184:187], v[172:175], v[92:95], v[184:187]
    ds_read_b64_tr_b16 v[154:155], v22 offset:10240
    ds_read_b64_tr_b16 v[156:157], v23 offset:8192
    v_mfma_f32_16x16x32_bf16 v[40:43], v[120:123], v[92:95], v[40:43]
    ds_read_b64_tr_b16 v[158:159], v23 offset:10240
    v_mfma_f32_16x16x32_bf16 v[72:75], v[120:123], v[96:99], v[72:75]
    ds_read_b64_tr_b16 v[160:161], v24 offset:8192
    v_mfma_f32_16x16x32_bf16 v[188:191], v[172:175], v[96:99], v[188:191]
    ds_read_b64_tr_b16 v[162:163], v24 offset:10240
    v_mfma_f32_16x16x32_bf16 v[44:47], v[124:127], v[92:95], v[44:47]
    ds_read_b64_tr_b16 v[164:165], v25 offset:8192
    v_mfma_f32_16x16x32_bf16 v[76:79], v[124:127], v[96:99], v[76:79]
    ds_read_b64_tr_b16 v[166:167], v25 offset:10240
    v_mfma_f32_16x16x32_bf16 v[192:195], v[92:95], v[92:95], v[192:195]
    ds_read_b64_tr_b16 v[168:169], v26 offset:8192
    v_mfma_f32_16x16x32_bf16 v[48:51], v[128:131], v[92:95], v[48:51]
    ds_read_b64_tr_b16 v[170:171], v26 offset:10240
    v_mfma_f32_16x16x32_bf16 v[80:83], v[128:131], v[96:99], v[80:83]
    v_mfma_f32_16x16x32_bf16 v[196:199], v[96:99], v[96:99], v[196:199]
    v_mfma_f32_16x16x32_bf16 v[52:55], v[132:135], v[92:95], v[52:55]
    v_mfma_f32_16x16x32_bf16 v[84:87], v[132:135], v[96:99], v[84:87]
    v_mfma_f32_16x16x32_bf16 v[56:59], v[136:139], v[92:95], v[56:59]
    v_mfma_f32_16x16x32_bf16 v[88:91], v[136:139], v[96:99], v[88:91]
    s_waitcnt lgkmcnt(0)
    v_mfma_f32_16x16x32_bf16 v[28:31], v[140:143], v[100:103], v[28:31]
    v_mfma_f32_16x16x32_bf16 v[60:63], v[140:143], v[104:107], v[60:63]
    v_mfma_f32_16x16x32_bf16 v[176:179], v[140:143], v[172:175], v[176:179]
    v_mfma_f32_16x16x32_bf16 v[32:35], v[144:147], v[100:103], v[32:35]
    v_mfma_f32_16x16x32_bf16 v[64:67], v[144:147], v[104:107], v[64:67]
    s_waitcnt lgkmcnt(0)
    s_barrier
    v_mfma_f32_16x16x32_bf16 v[180:183], v[144:147], v[172:175], v[180:183]
    v_add_u32 v9, 0x8000, v7
    v_add_u32 v10, 0x8000, v8
    v_add_u32 v19, 0x8000, v11
    v_mfma_f32_16x16x32_bf16 v[36:39], v[148:151], v[100:103], v[36:39]
    v_add_u32 v20, 0x8000, v12
    v_add_u32 v21, 0x8000, v13
    v_mfma_f32_16x16x32_bf16 v[68:71], v[148:151], v[104:107], v[68:71]
    v_add_u32 v22, 0x8000, v14
    v_add_u32 v23, 0x8000, v15
    v_mfma_f32_16x16x32_bf16 v[184:187], v[172:175], v[100:103], v[184:187]
    v_add_u32 v24, 0x8000, v16
    v_add_u32 v25, 0x8000, v17
    v_add_u32 v26, 0x8000, v18
    v_mfma_f32_16x16x32_bf16 v[40:43], v[152:155], v[100:103], v[40:43]
    ds_read_b128 v[92:95], v9 offset:0
    ds_read_b128 v[96:99], v9 offset:2048
    v_mfma_f32_16x16x32_bf16 v[72:75], v[152:155], v[104:107], v[72:75]
    ds_read_b64_tr_b16 v[108:109], v19 offset:0
    ds_read_b64_tr_b16 v[110:111], v19 offset:2048
    v_mfma_f32_16x16x32_bf16 v[188:191], v[172:175], v[104:107], v[188:191]
    ds_read_b64_tr_b16 v[112:113], v20 offset:0
    ds_read_b64_tr_b16 v[114:115], v20 offset:2048
    ds_read_b64_tr_b16 v[116:117], v21 offset:0
    v_mfma_f32_16x16x32_bf16 v[44:47], v[156:159], v[100:103], v[44:47]
    ds_read_b64_tr_b16 v[118:119], v21 offset:2048
    ds_read_b64_tr_b16 v[120:121], v22 offset:0
    v_mfma_f32_16x16x32_bf16 v[76:79], v[156:159], v[104:107], v[76:79]
    ds_read_b64_tr_b16 v[122:123], v22 offset:2048
    ds_read_b64_tr_b16 v[124:125], v23 offset:0
    v_mfma_f32_16x16x32_bf16 v[192:195], v[100:103], v[100:103], v[192:195]
    ds_read_b64_tr_b16 v[126:127], v23 offset:2048
    ds_read_b64_tr_b16 v[128:129], v24 offset:0
    ds_read_b64_tr_b16 v[130:131], v24 offset:2048
    v_mfma_f32_16x16x32_bf16 v[48:51], v[160:163], v[100:103], v[48:51]
    ds_read_b64_tr_b16 v[132:133], v25 offset:0
    ds_read_b64_tr_b16 v[134:135], v25 offset:2048
    v_mfma_f32_16x16x32_bf16 v[80:83], v[160:163], v[104:107], v[80:83]
    ds_read_b64_tr_b16 v[136:137], v26 offset:0
    ds_read_b64_tr_b16 v[138:139], v26 offset:2048
    v_mfma_f32_16x16x32_bf16 v[196:199], v[104:107], v[104:107], v[196:199]
    v_mfma_f32_16x16x32_bf16 v[52:55], v[164:167], v[100:103], v[52:55]
    v_mfma_f32_16x16x32_bf16 v[84:87], v[164:167], v[104:107], v[84:87]
    v_mfma_f32_16x16x32_bf16 v[56:59], v[168:171], v[100:103], v[56:59]
    v_mfma_f32_16x16x32_bf16 v[88:91], v[168:171], v[104:107], v[88:91]
    s_waitcnt lgkmcnt(0)
    v_mfma_f32_16x16x32_bf16 v[28:31], v[108:111], v[92:95], v[28:31]
    ds_read_b128 v[100:103], v10 offset:0
    ds_read_b128 v[104:107], v10 offset:2048
    v_mfma_f32_16x16x32_bf16 v[60:63], v[108:111], v[96:99], v[60:63]
    ds_read_b64_tr_b16 v[140:141], v19 offset:8192
    v_mfma_f32_16x16x32_bf16 v[176:179], v[108:111], v[172:175], v[176:179]
    ds_read_b64_tr_b16 v[142:143], v19 offset:10240
    v_mfma_f32_16x16x32_bf16 v[32:35], v[112:115], v[92:95], v[32:35]
    ds_read_b64_tr_b16 v[144:145], v20 offset:8192
    v_mfma_f32_16x16x32_bf16 v[64:67], v[112:115], v[96:99], v[64:67]
    ds_read_b64_tr_b16 v[146:147], v20 offset:10240
    v_mfma_f32_16x16x32_bf16 v[180:183], v[112:115], v[172:175], v[180:183]
    ds_read_b64_tr_b16 v[148:149], v21 offset:8192
    v_mfma_f32_16x16x32_bf16 v[36:39], v[116:119], v[92:95], v[36:39]
    ds_read_b64_tr_b16 v[150:151], v21 offset:10240
    v_mfma_f32_16x16x32_bf16 v[68:71], v[116:119], v[96:99], v[68:71]
    ds_read_b64_tr_b16 v[152:153], v22 offset:8192
    v_mfma_f32_16x16x32_bf16 v[184:187], v[172:175], v[92:95], v[184:187]
    ds_read_b64_tr_b16 v[154:155], v22 offset:10240
    ds_read_b64_tr_b16 v[156:157], v23 offset:8192
    v_mfma_f32_16x16x32_bf16 v[40:43], v[120:123], v[92:95], v[40:43]
    ds_read_b64_tr_b16 v[158:159], v23 offset:10240
    v_mfma_f32_16x16x32_bf16 v[72:75], v[120:123], v[96:99], v[72:75]
    ds_read_b64_tr_b16 v[160:161], v24 offset:8192
    v_mfma_f32_16x16x32_bf16 v[188:191], v[172:175], v[96:99], v[188:191]
    ds_read_b64_tr_b16 v[162:163], v24 offset:10240
    v_mfma_f32_16x16x32_bf16 v[44:47], v[124:127], v[92:95], v[44:47]
    ds_read_b64_tr_b16 v[164:165], v25 offset:8192
    v_mfma_f32_16x16x32_bf16 v[76:79], v[124:127], v[96:99], v[76:79]
    ds_read_b64_tr_b16 v[166:167], v25 offset:10240
    v_mfma_f32_16x16x32_bf16 v[192:195], v[92:95], v[92:95], v[192:195]
    ds_read_b64_tr_b16 v[168:169], v26 offset:8192
    v_mfma_f32_16x16x32_bf16 v[48:51], v[128:131], v[92:95], v[48:51]
    ds_read_b64_tr_b16 v[170:171], v26 offset:10240
    v_mfma_f32_16x16x32_bf16 v[80:83], v[128:131], v[96:99], v[80:83]
    v_mfma_f32_16x16x32_bf16 v[196:199], v[96:99], v[96:99], v[196:199]
    v_mfma_f32_16x16x32_bf16 v[52:55], v[132:135], v[92:95], v[52:55]
    v_mfma_f32_16x16x32_bf16 v[84:87], v[132:135], v[96:99], v[84:87]
    v_mfma_f32_16x16x32_bf16 v[56:59], v[136:139], v[92:95], v[56:59]
    v_mfma_f32_16x16x32_bf16 v[88:91], v[136:139], v[96:99], v[88:91]
    s_waitcnt lgkmcnt(0)
    v_mfma_f32_16x16x32_bf16 v[28:31], v[140:143], v[100:103], v[28:31]
    v_mfma_f32_16x16x32_bf16 v[60:63], v[140:143], v[104:107], v[60:63]
    v_mfma_f32_16x16x32_bf16 v[176:179], v[140:143], v[172:175], v[176:179]
    v_mfma_f32_16x16x32_bf16 v[32:35], v[144:147], v[100:103], v[32:35]
    v_mfma_f32_16x16x32_bf16 v[64:67], v[144:147], v[104:107], v[64:67]
    v_mfma_f32_16x16x32_bf16 v[180:183], v[144:147], v[172:175], v[180:183]
    v_mfma_f32_16x16x32_bf16 v[36:39], v[148:151], v[100:103], v[36:39]
    v_mfma_f32_16x16x32_bf16 v[68:71], v[148:151], v[104:107], v[68:71]
    v_mfma_f32_16x16x32_bf16 v[184:187], v[172:175], v[100:103], v[184:187]
    v_mfma_f32_16x16x32_bf16 v[40:43], v[152:155], v[100:103], v[40:43]
    v_mfma_f32_16x16x32_bf16 v[72:75], v[152:155], v[104:107], v[72:75]
    v_mfma_f32_16x16x32_bf16 v[188:191], v[172:175], v[104:107], v[188:191]
    v_mfma_f32_16x16x32_bf16 v[44:47], v[156:159], v[100:103], v[44:47]
    v_mfma_f32_16x16x32_bf16 v[76:79], v[156:159], v[104:107], v[76:79]
    v_mfma_f32_16x16x32_bf16 v[192:195], v[100:103], v[100:103], v[192:195]
    v_mfma_f32_16x16x32_bf16 v[48:51], v[160:163], v[100:103], v[48:51]
    v_mfma_f32_16x16x32_bf16 v[80:83], v[160:163], v[104:107], v[80:83]
    v_mfma_f32_16x16x32_bf16 v[196:199], v[104:107], v[104:107], v[196:199]
    v_mfma_f32_16x16x32_bf16 v[52:55], v[164:167], v[100:103], v[52:55]
    v_mfma_f32_16x16x32_bf16 v[84:87], v[164:167], v[104:107], v[84:87]
    v_mfma_f32_16x16x32_bf16 v[56:59], v[168:171], v[100:103], v[56:59]
    v_mfma_f32_16x16x32_bf16 v[88:91], v[168:171], v[104:107], v[88:91]
    s_lshl_b32 s31, s46, 6
    v_lshl_add_u32 v3, v1, 4, s31
    v_add_u32 v3, 0x20000, v3
    ds_write_b128 v3, v[176:179]
    s_lshl_b32 s31, s47, 6
    v_lshl_add_u32 v3, v1, 4, s31
    v_add_u32 v3, 0x20000, v3
    ds_write_b128 v3, v[180:183]
    v_and_b32 v3, 3, v2
    v_lshrrev_b32 v4, 2, v2
    v_cmp_eq_u32 s[42:43], 1, v3
    v_cmp_eq_u32 s[44:45], 2, v3
    v_cmp_eq_u32 vcc, 3, v3
    v_cmp_eq_u32 s[58:59], v4, v1
    s_mov_b32 s32, 0x3acccccd
    v_mov_b32 v5, 0
    s_waitcnt lgkmcnt(0)
    s_barrier
    s_lshl_b32 s31, s46, 6
    v_lshl_add_u32 v3, v1, 4, s31
    v_add_u32 v3, 0x20000, v3
    ds_read_b128 v[208:211], v3
    s_lshl_b32 s31, s47, 6
    v_lshl_add_u32 v3, v1, 4, s31
    v_add_u32 v3, 0x20000, v3
    ds_read_b128 v[212:215], v3
    s_lshl_b32 s31, s48, 6
    v_lshl_add_u32 v3, v1, 4, s31
    v_add_u32 v3, 0x20000, v3
    ds_read_b128 v[216:219], v3
    s_lshl_b32 s31, s49, 6
    v_lshl_add_u32 v3, v1, 4, s31
    v_add_u32 v3, 0x20000, v3
    ds_read_b128 v[220:223], v3
    s_lshl_b32 s31, s50, 6
    v_lshl_add_u32 v3, v1, 4, s31
    v_add_u32 v3, 0x20000, v3
    ds_read_b128 v[224:227], v3
    s_lshl_b32 s31, s51, 6
    v_lshl_add_u32 v3, v1, 4, s31
    v_add_u32 v3, 0x20000, v3
    ds_read_b128 v[228:231], v3
    s_lshl_b32 s31, s52, 6
    v_lshl_add_u32 v3, v1, 4, s31
    v_add_u32 v3, 0x20000, v3
    ds_read_b128 v[232:235], v3
    s_lshl_b32 s31, s53, 6
    v_lshl_add_u32 v3, v1, 4, s31
    v_add_u32 v3, 0x20000, v3
    ds_read_b128 v[236:239], v3
    v_cndmask_b32 v112, v192, v193, s[42:43]
    v_cndmask_b32 v112, v112, v194, s[44:45]
    v_cndmask_b32 v112, v112, v195, vcc
    v_cndmask_b32 v112, v5, v112, s[58:59]
    v_mov_b32 v108, v112
    s_nop 1
    v_permlane32_swap_b32 v112, v108
    v_add_f32 v112, v112, v108
    v_mov_b32 v108, v112
    s_nop 1
    v_permlane16_swap_b32 v112, v108
    v_add_f32 v112, v112, v108
    v_mul_f32 v108, s32, v184
    v_mul_f32 v112, s32, v112
    v_fma_f32 v112, -v108, v108, v112
    v_max_f32 v112, 0, v112
    v_cvt_pk_bf16_f32 v200, v108, v108
    v_lshlrev_b32 v200, 16, v200
    v_xor_b32 v200, 0x80000000, v200
    v_cvt_pk_bf16_f32 v112, v112, v112
    v_lshlrev_b32 v112, 16, v112
    v_add_f32 v112, 0x3727c5ac, v112
    v_cvt_pk_bf16_f32 v112, v112, v112
    v_lshlrev_b32 v112, 16, v112
    v_sqrt_f32 v112, v112
    s_nop 0
    v_cvt_pk_bf16_f32 v112, v112, v112
    v_lshlrev_b32 v112, 16, v112
    v_rcp_f32 v204, v112
    v_cndmask_b32 v112, v196, v197, s[42:43]
    v_cndmask_b32 v112, v112, v198, s[44:45]
    v_cndmask_b32 v112, v112, v199, vcc
    v_cndmask_b32 v112, v5, v112, s[58:59]
    v_mov_b32 v108, v112
    s_nop 1
    v_permlane32_swap_b32 v112, v108
    v_add_f32 v112, v112, v108
    v_mov_b32 v108, v112
    s_nop 1
    v_permlane16_swap_b32 v112, v108
    v_add_f32 v112, v112, v108
    v_mul_f32 v108, s32, v188
    v_mul_f32 v112, s32, v112
    v_fma_f32 v112, -v108, v108, v112
    v_max_f32 v112, 0, v112
    v_cvt_pk_bf16_f32 v202, v108, v108
    v_lshlrev_b32 v202, 16, v202
    v_xor_b32 v202, 0x80000000, v202
    v_cvt_pk_bf16_f32 v112, v112, v112
    v_lshlrev_b32 v112, 16, v112
    v_add_f32 v112, 0x3727c5ac, v112
    v_cvt_pk_bf16_f32 v112, v112, v112
    v_lshlrev_b32 v112, 16, v112
    v_sqrt_f32 v112, v112
    s_nop 0
    v_cvt_pk_bf16_f32 v112, v112, v112
    v_lshlrev_b32 v112, 16, v112
    v_rcp_f32 v206, v112
    s_waitcnt lgkmcnt(0)
    s_mul_i32 s33, s30, 8704
    s_add_u32 s33, s33, 0x10000
    v_mul_u32_u24 v240, 272, v2
    v_lshl_add_u32 v240, v1, 3, v240
    v_add_u32 v240, s33, v240
    s_lshl_b32 s31, s46, 5
    v_add_u32 v11, s31, v240
    s_lshl_b32 s31, s47, 5
    v_add_u32 v12, s31, v240
    s_lshl_b32 s31, s48, 5
    v_add_u32 v13, s31, v240
    s_lshl_b32 s31, s49, 5
    v_add_u32 v14, s31, v240
    s_lshl_b32 s31, s50, 5
    v_add_u32 v15, s31, v240
    s_lshl_b32 s31, s51, 5
    v_add_u32 v16, s31, v240
    s_lshl_b32 s31, s52, 5
    v_add_u32 v17, s31, v240
    s_lshl_b32 s31, s53, 5
    v_add_u32 v18, s31, v240
    v_pk_fma_f32 v[28:29], v[208:209], v[200:201], v[28:29] op_sel_hi:[1,0,1]
    v_pk_fma_f32 v[30:31], v[210:211], v[200:201], v[30:31] op_sel_hi:[1,0,1]
    v_pk_mul_f32 v[28:29], v[28:29], v[204:205] op_sel_hi:[1,0]
    v_pk_mul_f32 v[30:31], v[30:31], v[204:205] op_sel_hi:[1,0]
    v_cvt_pk_bf16_f32 v28, v28, v29
    v_cvt_pk_bf16_f32 v29, v30, v31
    v_pk_max_i16 v28, v28, 0
    v_pk_max_i16 v29, v29, 0
    ds_write_b64 v11, v[28:29] offset:0
    v_pk_fma_f32 v[60:61], v[208:209], v[202:203], v[60:61] op_sel_hi:[1,0,1]
    v_pk_fma_f32 v[62:63], v[210:211], v[202:203], v[62:63] op_sel_hi:[1,0,1]
    v_pk_mul_f32 v[60:61], v[60:61], v[206:207] op_sel_hi:[1,0]
    v_pk_mul_f32 v[62:63], v[62:63], v[206:207] op_sel_hi:[1,0]
    v_cvt_pk_bf16_f32 v60, v60, v61
    v_cvt_pk_bf16_f32 v61, v62, v63
    v_pk_max_i16 v60, v60, 0
    v_pk_max_i16 v61, v61, 0
    ds_write_b64 v11, v[60:61] offset:4352
    v_pk_fma_f32 v[32:33], v[212:213], v[200:201], v[32:33] op_sel_hi:[1,0,1]
    v_pk_fma_f32 v[34:35], v[214:215], v[200:201], v[34:35] op_sel_hi:[1,0,1]
    v_pk_mul_f32 v[32:33], v[32:33], v[204:205] op_sel_hi:[1,0]
    v_pk_mul_f32 v[34:35], v[34:35], v[204:205] op_sel_hi:[1,0]
    v_cvt_pk_bf16_f32 v32, v32, v33
    v_cvt_pk_bf16_f32 v33, v34, v35
    v_pk_max_i16 v32, v32, 0
    v_pk_max_i16 v33, v33, 0
    ds_write_b64 v12, v[32:33] offset:0
    v_pk_fma_f32 v[64:65], v[212:213], v[202:203], v[64:65] op_sel_hi:[1,0,1]
    v_pk_fma_f32 v[66:67], v[214:215], v[202:203], v[66:67] op_sel_hi:[1,0,1]
    v_pk_mul_f32 v[64:65], v[64:65], v[206:207] op_sel_hi:[1,0]
    v_pk_mul_f32 v[66:67], v[66:67], v[206:207] op_sel_hi:[1,0]
    v_cvt_pk_bf16_f32 v64, v64, v65
    v_cvt_pk_bf16_f32 v65, v66, v67
    v_pk_max_i16 v64, v64, 0
    v_pk_max_i16 v65, v65, 0
    ds_write_b64 v12, v[64:65] offset:4352
    v_pk_fma_f32 v[36:37], v[216:217], v[200:201], v[36:37] op_sel_hi:[1,0,1]
    v_pk_fma_f32 v[38:39], v[218:219], v[200:201], v[38:39] op_sel_hi:[1,0,1]
    v_pk_mul_f32 v[36:37], v[36:37], v[204:205] op_sel_hi:[1,0]
    v_pk_mul_f32 v[38:39], v[38:39], v[204:205] op_sel_hi:[1,0]
    v_cvt_pk_bf16_f32 v36, v36, v37
    v_cvt_pk_bf16_f32 v37, v38, v39
    v_pk_max_i16 v36, v36, 0
    v_pk_max_i16 v37, v37, 0
    ds_write_b64 v13, v[36:37] offset:0
    v_pk_fma_f32 v[68:69], v[216:217], v[202:203], v[68:69] op_sel_hi:[1,0,1]
    v_pk_fma_f32 v[70:71], v[218:219], v[202:203], v[70:71] op_sel_hi:[1,0,1]
    v_pk_mul_f32 v[68:69], v[68:69], v[206:207] op_sel_hi:[1,0]
    v_pk_mul_f32 v[70:71], v[70:71], v[206:207] op_sel_hi:[1,0]
    v_cvt_pk_bf16_f32 v68, v68, v69
    v_cvt_pk_bf16_f32 v69, v70, v71
    v_pk_max_i16 v68, v68, 0
    v_pk_max_i16 v69, v69, 0
    ds_write_b64 v13, v[68:69] offset:4352
    v_pk_fma_f32 v[40:41], v[220:221], v[200:201], v[40:41] op_sel_hi:[1,0,1]
    v_pk_fma_f32 v[42:43], v[222:223], v[200:201], v[42:43] op_sel_hi:[1,0,1]
    v_pk_mul_f32 v[40:41], v[40:41], v[204:205] op_sel_hi:[1,0]
    v_pk_mul_f32 v[42:43], v[42:43], v[204:205] op_sel_hi:[1,0]
    v_cvt_pk_bf16_f32 v40, v40, v41
    v_cvt_pk_bf16_f32 v41, v42, v43
    v_pk_max_i16 v40, v40, 0
    v_pk_max_i16 v41, v41, 0
    ds_write_b64 v14, v[40:41] offset:0
    v_pk_fma_f32 v[72:73], v[220:221], v[202:203], v[72:73] op_sel_hi:[1,0,1]
    v_pk_fma_f32 v[74:75], v[222:223], v[202:203], v[74:75] op_sel_hi:[1,0,1]
    v_pk_mul_f32 v[72:73], v[72:73], v[206:207] op_sel_hi:[1,0]
    v_pk_mul_f32 v[74:75], v[74:75], v[206:207] op_sel_hi:[1,0]
    v_cvt_pk_bf16_f32 v72, v72, v73
    v_cvt_pk_bf16_f32 v73, v74, v75
    v_pk_max_i16 v72, v72, 0
    v_pk_max_i16 v73, v73, 0
    ds_write_b64 v14, v[72:73] offset:4352
    v_pk_fma_f32 v[44:45], v[224:225], v[200:201], v[44:45] op_sel_hi:[1,0,1]
    v_pk_fma_f32 v[46:47], v[226:227], v[200:201], v[46:47] op_sel_hi:[1,0,1]
    v_pk_mul_f32 v[44:45], v[44:45], v[204:205] op_sel_hi:[1,0]
    v_pk_mul_f32 v[46:47], v[46:47], v[204:205] op_sel_hi:[1,0]
    v_cvt_pk_bf16_f32 v44, v44, v45
    v_cvt_pk_bf16_f32 v45, v46, v47
    v_pk_max_i16 v44, v44, 0
    v_pk_max_i16 v45, v45, 0
    ds_write_b64 v15, v[44:45] offset:0
    v_pk_fma_f32 v[76:77], v[224:225], v[202:203], v[76:77] op_sel_hi:[1,0,1]
    v_pk_fma_f32 v[78:79], v[226:227], v[202:203], v[78:79] op_sel_hi:[1,0,1]
    v_pk_mul_f32 v[76:77], v[76:77], v[206:207] op_sel_hi:[1,0]
    v_pk_mul_f32 v[78:79], v[78:79], v[206:207] op_sel_hi:[1,0]
    v_cvt_pk_bf16_f32 v76, v76, v77
    v_cvt_pk_bf16_f32 v77, v78, v79
    v_pk_max_i16 v76, v76, 0
    v_pk_max_i16 v77, v77, 0
    ds_write_b64 v15, v[76:77] offset:4352
    v_pk_fma_f32 v[48:49], v[228:229], v[200:201], v[48:49] op_sel_hi:[1,0,1]
    v_pk_fma_f32 v[50:51], v[230:231], v[200:201], v[50:51] op_sel_hi:[1,0,1]
    v_pk_mul_f32 v[48:49], v[48:49], v[204:205] op_sel_hi:[1,0]
    v_pk_mul_f32 v[50:51], v[50:51], v[204:205] op_sel_hi:[1,0]
    v_cvt_pk_bf16_f32 v48, v48, v49
    v_cvt_pk_bf16_f32 v49, v50, v51
    v_pk_max_i16 v48, v48, 0
    v_pk_max_i16 v49, v49, 0
    ds_write_b64 v16, v[48:49] offset:0
    v_pk_fma_f32 v[80:81], v[228:229], v[202:203], v[80:81] op_sel_hi:[1,0,1]
    v_pk_fma_f32 v[82:83], v[230:231], v[202:203], v[82:83] op_sel_hi:[1,0,1]
    v_pk_mul_f32 v[80:81], v[80:81], v[206:207] op_sel_hi:[1,0]
    v_pk_mul_f32 v[82:83], v[82:83], v[206:207] op_sel_hi:[1,0]
    v_cvt_pk_bf16_f32 v80, v80, v81
    v_cvt_pk_bf16_f32 v81, v82, v83
    v_pk_max_i16 v80, v80, 0
    v_pk_max_i16 v81, v81, 0
    ds_write_b64 v16, v[80:81] offset:4352
    v_pk_fma_f32 v[52:53], v[232:233], v[200:201], v[52:53] op_sel_hi:[1,0,1]
    v_pk_fma_f32 v[54:55], v[234:235], v[200:201], v[54:55] op_sel_hi:[1,0,1]
    v_pk_mul_f32 v[52:53], v[52:53], v[204:205] op_sel_hi:[1,0]
    v_pk_mul_f32 v[54:55], v[54:55], v[204:205] op_sel_hi:[1,0]
    v_cvt_pk_bf16_f32 v52, v52, v53
    v_cvt_pk_bf16_f32 v53, v54, v55
    v_pk_max_i16 v52, v52, 0
    v_pk_max_i16 v53, v53, 0
    ds_write_b64 v17, v[52:53] offset:0
    v_pk_fma_f32 v[84:85], v[232:233], v[202:203], v[84:85] op_sel_hi:[1,0,1]
    v_pk_fma_f32 v[86:87], v[234:235], v[202:203], v[86:87] op_sel_hi:[1,0,1]
    v_pk_mul_f32 v[84:85], v[84:85], v[206:207] op_sel_hi:[1,0]
    v_pk_mul_f32 v[86:87], v[86:87], v[206:207] op_sel_hi:[1,0]
    v_cvt_pk_bf16_f32 v84, v84, v85
    v_cvt_pk_bf16_f32 v85, v86, v87
    v_pk_max_i16 v84, v84, 0
    v_pk_max_i16 v85, v85, 0
    ds_write_b64 v17, v[84:85] offset:4352
    v_pk_fma_f32 v[56:57], v[236:237], v[200:201], v[56:57] op_sel_hi:[1,0,1]
    v_pk_fma_f32 v[58:59], v[238:239], v[200:201], v[58:59] op_sel_hi:[1,0,1]
    v_pk_mul_f32 v[56:57], v[56:57], v[204:205] op_sel_hi:[1,0]
    v_pk_mul_f32 v[58:59], v[58:59], v[204:205] op_sel_hi:[1,0]
    v_cvt_pk_bf16_f32 v56, v56, v57
    v_cvt_pk_bf16_f32 v57, v58, v59
    v_pk_max_i16 v56, v56, 0
    v_pk_max_i16 v57, v57, 0
    ds_write_b64 v18, v[56:57] offset:0
    v_pk_fma_f32 v[88:89], v[236:237], v[202:203], v[88:89] op_sel_hi:[1,0,1]
    v_pk_fma_f32 v[90:91], v[238:239], v[202:203], v[90:91] op_sel_hi:[1,0,1]
    v_pk_mul_f32 v[88:89], v[88:89], v[206:207] op_sel_hi:[1,0]
    v_pk_mul_f32 v[90:91], v[90:91], v[206:207] op_sel_hi:[1,0]
    v_cvt_pk_bf16_f32 v88, v88, v89
    v_cvt_pk_bf16_f32 v89, v90, v91
    v_pk_max_i16 v88, v88, 0
    v_pk_max_i16 v89, v89, 0
    ds_write_b64 v18, v[88:89] offset:4352
    v_mul_u32_u24 v241, 272, v1
    v_lshl_add_u32 v241, v2, 4, v241
    v_add_u32 v241, s33, v241
    s_lshl_b32 s31, s30, 5
    s_add_u32 s31, s31, s40
    v_add_u32 v242, s31, v1
    v_mul_u32_u24 v242, 3456, v242
    v_lshl_add_u32 v242, v2, 4, v242
    s_lshl_b32 s31, s41, 1
    v_add_u32 v242, s31, v242
    s_cmp_eq_u32 s29, 13
    s_cselect_b32 s32, 8, 16
    v_cmp_gt_u32 vcc, s32, v2
    s_waitcnt lgkmcnt(0)
    ds_read_b128 v[92:95], v241 offset:0
    ds_read_b128 v[96:99], v241 offset:1088
    ds_read_b128 v[100:103], v241 offset:2176
    ds_read_b128 v[104:107], v241 offset:3264
    ds_read_b128 v[140:143], v241 offset:4352
    ds_read_b128 v[144:147], v241 offset:5440
    ds_read_b128 v[148:151], v241 offset:6528
    ds_read_b128 v[152:155], v241 offset:7616
    s_and_saveexec_b64 s[42:43], vcc
    s_mov_b32 s31, 0
    s_waitcnt lgkmcnt(7)
    buffer_store_dwordx4 v[92:95], v242, s[12:15], s31 offen sc1
    s_mov_b32 s31, 13824
    s_waitcnt lgkmcnt(6)
    buffer_store_dwordx4 v[96:99], v242, s[12:15], s31 offen sc1
    s_mov_b32 s31, 27648
    s_waitcnt lgkmcnt(5)
    buffer_store_dwordx4 v[100:103], v242, s[12:15], s31 offen sc1
    s_mov_b32 s31, 41472
    s_waitcnt lgkmcnt(4)
    buffer_store_dwordx4 v[104:107], v242, s[12:15], s31 offen sc1
    s_mov_b32 s31, 55296
    s_waitcnt lgkmcnt(3)
    buffer_store_dwordx4 v[140:143], v242, s[12:15], s31 offen sc1
    s_mov_b32 s31, 69120
    s_waitcnt lgkmcnt(2)
    buffer_store_dwordx4 v[144:147], v242, s[12:15], s31 offen sc1
    s_mov_b32 s31, 82944
    s_waitcnt lgkmcnt(1)
    buffer_store_dwordx4 v[148:151], v242, s[12:15], s31 offen sc1
    s_mov_b32 s31, 96768
    s_waitcnt lgkmcnt(0)
    buffer_store_dwordx4 v[152:155], v242, s[12:15], s31 offen sc1
    s_mov_b64 exec, s[42:43]
    s_waitcnt vmcnt(0)
    s_barrier
    s_cmp_lg_u32 s80, 0
    s_cbranch_scc1 w1_kernel_sig
    s_waitcnt vmcnt(0)
    v_readfirstlane_b32 s81, v248
    s_nop 0
    s_cmp_eq_u32 s81, 0
    s_cselect_b32 s81, s82, s81
    s_lshl_b32 s31, s28, 4
    s_add_u32 s31, s31, s29
    s_lshl_b32 s31, s31, 3
    s_add_u32 s31, s31, 8192
    v_mov_b32 v3, s31
    v_mov_b32 v244, s81
    v_not_b32 v245, v244
    s_mov_b64 exec, 1
    buffer_store_dwordx2 v[244:245], v3, s[84:87], 0 offen sc1
    s_mov_b64 exec, -1
w1_kernel_sig:
    s_branch w1_kernel_end
w1_kernel_loader:
    s_setprio 1
    s_sub_u32 s30, s30, 4
    v_lshrrev_b32 v5, 3, v0
    v_and_b32 v6, 7, v0
    s_mul_i32 s31, s30, 32
    s_add_u32 s32, s31, 0
    v_add_u32 v1, s32, v5
    v_bfe_u32 v2, v1, 1, 3
    v_xor_b32 v2, v2, v6
    v_add_u32 v1, s40, v1
    v_mul_u32_u24 v1, 1280, v1
    v_lshl_add_u32 v7, v2, 4, v1
    s_add_u32 s32, s31, 8
    v_add_u32 v1, s32, v5
    v_bfe_u32 v2, v1, 1, 3
    v_xor_b32 v2, v2, v6
    v_add_u32 v1, s40, v1
    v_mul_u32_u24 v1, 1280, v1
    v_lshl_add_u32 v8, v2, 4, v1
    s_add_u32 s32, s31, 16
    v_add_u32 v1, s32, v5
    v_bfe_u32 v2, v1, 1, 3
    v_xor_b32 v2, v2, v6
    v_add_u32 v1, s40, v1
    v_mul_u32_u24 v1, 1280, v1
    v_lshl_add_u32 v9, v2, 4, v1
    s_add_u32 s32, s31, 24
    v_add_u32 v1, s32, v5
    v_bfe_u32 v2, v1, 1, 3
    v_xor_b32 v2, v2, v6
    v_add_u32 v1, s40, v1
    v_mul_u32_u24 v1, 1280, v1
    v_lshl_add_u32 v10, v2, 4, v1
    s_lshl_b32 s31, s30, 4
    s_lshl_b32 s32, s41, 1
    v_add_u32 v1, 0, v0
    v_lshrrev_b32 v2, 4, v1
    v_and_b32 v1, 15, v1
    v_and_b32 v3, 7, v2
    v_lshlrev_b32 v3, 1, v3
    v_xor_b32 v1, v1, v3
    v_and_b32 v3, 3, v2
    v_bfe_u32 v4, v2, 3, 1
    v_lshl_add_u32 v3, v4, 2, v3
    v_bfe_u32 v4, v2, 2, 1
    v_lshl_add_u32 v3, v4, 3, v3
    v_add_u32 v3, s31, v3
    v_mul_u32_u24 v3, 3456, v3
    v_lshl_add_u32 v3, v1, 4, v3
    v_add_u32 v19, s32, v3
    v_add_u32 v1, 64, v0
    v_lshrrev_b32 v2, 4, v1
    v_and_b32 v1, 15, v1
    v_and_b32 v3, 7, v2
    v_lshlrev_b32 v3, 1, v3
    v_xor_b32 v1, v1, v3
    v_and_b32 v3, 3, v2
    v_bfe_u32 v4, v2, 3, 1
    v_lshl_add_u32 v3, v4, 2, v3
    v_bfe_u32 v4, v2, 2, 1
    v_lshl_add_u32 v3, v4, 3, v3
    v_add_u32 v3, s31, v3
    v_mul_u32_u24 v3, 3456, v3
    v_lshl_add_u32 v3, v1, 4, v3
    v_add_u32 v20, s32, v3
    v_add_u32 v1, 128, v0
    v_lshrrev_b32 v2, 4, v1
    v_and_b32 v1, 15, v1
    v_and_b32 v3, 7, v2
    v_lshlrev_b32 v3, 1, v3
    v_xor_b32 v1, v1, v3
    v_and_b32 v3, 3, v2
    v_bfe_u32 v4, v2, 3, 1
    v_lshl_add_u32 v3, v4, 2, v3
    v_bfe_u32 v4, v2, 2, 1
    v_lshl_add_u32 v3, v4, 3, v3
    v_add_u32 v3, s31, v3
    v_mul_u32_u24 v3, 3456, v3
    v_lshl_add_u32 v3, v1, 4, v3
    v_add_u32 v21, s32, v3
    v_add_u32 v1, 192, v0
    v_lshrrev_b32 v2, 4, v1
    v_and_b32 v1, 15, v1
    v_and_b32 v3, 7, v2
    v_lshlrev_b32 v3, 1, v3
    v_xor_b32 v1, v1, v3
    v_and_b32 v3, 3, v2
    v_bfe_u32 v4, v2, 3, 1
    v_lshl_add_u32 v3, v4, 2, v3
    v_bfe_u32 v4, v2, 2, 1
    v_lshl_add_u32 v3, v4, 3, v3
    v_add_u32 v3, s31, v3
    v_mul_u32_u24 v3, 3456, v3
    v_lshl_add_u32 v3, v1, 4, v3
    v_add_u32 v22, s32, v3
    s_mul_i32 s35, s30, 4096
    s_mul_i32 s36, s30, 4096
    s_mul_i32 s54, s54, 0
    s_mul_i32 s55, s55, 0
    s_add_u32 s37, s54, s55
    s_lshl_b32 s33, s37, 7
    s_mul_i32 s34, s37, 221184
    s_waitcnt lgkmcnt(0)
    s_add_u32 s4, s78, 0xb00000
    s_addc_u32 s5, s79, 0
    s_and_b32 s5, s5, 0xffff
    s_mov_b32 s6, 0x280000
    s_mov_b32 s7, 0x20000
    s_mov_b32 s8, s70
    s_and_b32 s9, s71, 0xffff
    s_mov_b32 s10, 0x21c000
    s_mov_b32 s11, 0x20000
    s_add_u32 m0, s36, 0x4000
    s_nop 0
    buffer_load_dwordx4 v19, s[8:11], s34 offen lds
    s_add_u32 m0, s36, 0x4400
    s_nop 0
    buffer_load_dwordx4 v20, s[8:11], s34 offen lds
    s_add_u32 m0, s36, 0x4800
    s_nop 0
    buffer_load_dwordx4 v21, s[8:11], s34 offen lds
    s_add_u32 m0, s36, 0x4c00
    s_nop 0
    buffer_load_dwordx4 v22, s[8:11], s34 offen lds
    s_add_u32 s34, s34, 221184
    s_cmp_eq_u32 s34, 2211840
    s_cselect_b32 s34, 0, s34
    s_add_u32 m0, s36, 0xc000
    s_nop 0
    buffer_load_dwordx4 v19, s[8:11], s34 offen lds
    s_add_u32 m0, s36, 0xc400
    s_nop 0
    buffer_load_dwordx4 v20, s[8:11], s34 offen lds
    s_add_u32 m0, s36, 0xc800
    s_nop 0
    buffer_load_dwordx4 v21, s[8:11], s34 offen lds
    s_add_u32 m0, s36, 0xcc00
    s_nop 0
    buffer_load_dwordx4 v22, s[8:11], s34 offen lds
    s_add_u32 s34, s34, 221184
    s_cmp_eq_u32 s34, 2211840
    s_cselect_b32 s34, 0, s34
    s_add_u32 m0, s36, 0x14000
    s_nop 0
    buffer_load_dwordx4 v19, s[8:11], s34 offen lds
    s_add_u32 m0, s36, 0x14400
    s_nop 0
    buffer_load_dwordx4 v20, s[8:11], s34 offen lds
    s_add_u32 m0, s36, 0x14800
    s_nop 0
    buffer_load_dwordx4 v21, s[8:11], s34 offen lds
    s_add_u32 m0, s36, 0x14c00
    s_nop 0
    buffer_load_dwordx4 v22, s[8:11], s34 offen lds
    s_add_u32 s34, s34, 221184
    s_cmp_eq_u32 s34, 2211840
    s_cselect_b32 s34, 0, s34
    s_barrier
    s_add_u32 m0, s35, 0x0
    s_nop 0
    buffer_load_dwordx4 v7, s[4:7], s33 offen sc1 lds
    s_add_u32 m0, s35, 0x400
    s_nop 0
    buffer_load_dwordx4 v8, s[4:7], s33 offen sc1 lds
    s_add_u32 m0, s35, 0x800
    s_nop 0
    buffer_load_dwordx4 v9, s[4:7], s33 offen sc1 lds
    s_add_u32 m0, s35, 0xc00
    s_nop 0
    buffer_load_dwordx4 v10, s[4:7], s33 offen sc1 lds
    s_add_u32 s33, s33, 128
    s_cmp_eq_u32 s33, 1280
    s_cselect_b32 s33, 0, s33
    s_add_u32 m0, s35, 0x8000
    s_nop 0
    buffer_load_dwordx4 v7, s[4:7], s33 offen sc1 lds
    s_add_u32 m0, s35, 0x8400
    s_nop 0
    buffer_load_dwordx4 v8, s[4:7], s33 offen sc1 lds
    s_add_u32 m0, s35, 0x8800
    s_nop 0
    buffer_load_dwordx4 v9, s[4:7], s33 offen sc1 lds
    s_add_u32 m0, s35, 0x8c00
    s_nop 0
    buffer_load_dwordx4 v10, s[4:7], s33 offen sc1 lds
    s_add_u32 s33, s33, 128
    s_cmp_eq_u32 s33, 1280
    s_cselect_b32 s33, 0, s33
    s_add_u32 m0, s35, 0x10000
    s_nop 0
    buffer_load_dwordx4 v7, s[4:7], s33 offen sc1 lds
    s_add_u32 m0, s35, 0x10400
    s_nop 0
    buffer_load_dwordx4 v8, s[4:7], s33 offen sc1 lds
    s_add_u32 m0, s35, 0x10800
    s_nop 0
    buffer_load_dwordx4 v9, s[4:7], s33 offen sc1 lds
    s_add_u32 m0, s35, 0x10c00
    s_nop 0
    buffer_load_dwordx4 v10, s[4:7], s33 offen sc1 lds
    s_add_u32 s33, s33, 128
    s_cmp_eq_u32 s33, 1280
    s_cselect_b32 s33, 0, s33
    s_waitcnt vmcnt(8)
    s_barrier
    s_add_u32 m0, s36, 0x1c000
    s_nop 0
    buffer_load_dwordx4 v19, s[8:11], s34 offen lds
    s_add_u32 m0, s36, 0x1c400
    s_nop 0
    buffer_load_dwordx4 v20, s[8:11], s34 offen lds
    s_add_u32 m0, s36, 0x1c800
    s_nop 0
    buffer_load_dwordx4 v21, s[8:11], s34 offen lds
    s_add_u32 m0, s36, 0x1cc00
    s_nop 0
    buffer_load_dwordx4 v22, s[8:11], s34 offen lds
    s_add_u32 s34, s34, 221184
    s_cmp_eq_u32 s34, 2211840
    s_cselect_b32 s34, 0, s34
    s_add_u32 m0, s35, 0x18000
    s_nop 0
    buffer_load_dwordx4 v7, s[4:7], s33 offen sc1 lds
    s_add_u32 m0, s35, 0x18400
    s_nop 0
    buffer_load_dwordx4 v8, s[4:7], s33 offen sc1 lds
    s_add_u32 m0, s35, 0x18800
    s_nop 0
    buffer_load_dwordx4 v9, s[4:7], s33 offen sc1 lds
    s_add_u32 m0, s35, 0x18c00
    s_nop 0
    buffer_load_dwordx4 v10, s[4:7], s33 offen sc1 lds
    s_add_u32 s33, s33, 128
    s_cmp_eq_u32 s33, 1280
    s_cselect_b32 s33, 0, s33
    s_waitcnt vmcnt(12)
    s_barrier
    s_add_u32 m0, s36, 0x4000
    s_nop 0
    buffer_load_dwordx4 v19, s[8:11], s34 offen lds
    s_add_u32 m0, s36, 0x4400
    s_nop 0
    buffer_load_dwordx4 v20, s[8:11], s34 offen lds
    s_add_u32 m0, s36, 0x4800
    s_nop 0
    buffer_load_dwordx4 v21, s[8:11], s34 offen lds
    s_add_u32 m0, s36, 0x4c00
    s_nop 0
    buffer_load_dwordx4 v22, s[8:11], s34 offen lds
    s_add_u32 s34, s34, 221184
    s_cmp_eq_u32 s34, 2211840
    s_cselect_b32 s34, 0, s34
    s_add_u32 m0, s35, 0x0
    s_nop 0
    buffer_load_dwordx4 v7, s[4:7], s33 offen sc1 lds
    s_add_u32 m0, s35, 0x400
    s_nop 0
    buffer_load_dwordx4 v8, s[4:7], s33 offen sc1 lds
    s_add_u32 m0, s35, 0x800
    s_nop 0
    buffer_load_dwordx4 v9, s[4:7], s33 offen sc1 lds
    s_add_u32 m0, s35, 0xc00
    s_nop 0
    buffer_load_dwordx4 v10, s[4:7], s33 offen sc1 lds
    s_add_u32 s33, s33, 128
    s_cmp_eq_u32 s33, 1280
    s_cselect_b32 s33, 0, s33
    s_waitcnt vmcnt(16)
    s_barrier
    s_add_u32 m0, s36, 0xc000
    s_nop 0
    buffer_load_dwordx4 v19, s[8:11], s34 offen lds
    s_add_u32 m0, s36, 0xc400
    s_nop 0
    buffer_load_dwordx4 v20, s[8:11], s34 offen lds
    s_add_u32 m0, s36, 0xc800
    s_nop 0
    buffer_load_dwordx4 v21, s[8:11], s34 offen lds
    s_add_u32 m0, s36, 0xcc00
    s_nop 0
    buffer_load_dwordx4 v22, s[8:11], s34 offen lds
    s_add_u32 s34, s34, 221184
    s_cmp_eq_u32 s34, 2211840
    s_cselect_b32 s34, 0, s34
    s_add_u32 m0, s35, 0x8000
    s_nop 0
    buffer_load_dwordx4 v7, s[4:7], s33 offen sc1 lds
    s_add_u32 m0, s35, 0x8400
    s_nop 0
    buffer_load_dwordx4 v8, s[4:7], s33 offen sc1 lds
    s_add_u32 m0, s35, 0x8800
    s_nop 0
    buffer_load_dwordx4 v9, s[4:7], s33 offen sc1 lds
    s_add_u32 m0, s35, 0x8c00
    s_nop 0
    buffer_load_dwordx4 v10, s[4:7], s33 offen sc1 lds
    s_add_u32 s33, s33, 128
    s_cmp_eq_u32 s33, 1280
    s_cselect_b32 s33, 0, s33
    s_waitcnt vmcnt(16)
    s_barrier
    s_add_u32 m0, s36, 0x14000
    s_nop 0
    buffer_load_dwordx4 v19, s[8:11], s34 offen lds
    s_add_u32 m0, s36, 0x14400
    s_nop 0
    buffer_load_dwordx4 v20, s[8:11], s34 offen lds
    s_add_u32 m0, s36, 0x14800
    s_nop 0
    buffer_load_dwordx4 v21, s[8:11], s34 offen lds
    s_add_u32 m0, s36, 0x14c00
    s_nop 0
    buffer_load_dwordx4 v22, s[8:11], s34 offen lds
    s_add_u32 s34, s34, 221184
    s_cmp_eq_u32 s34, 2211840
    s_cselect_b32 s34, 0, s34
    s_add_u32 m0, s35, 0x10000
    s_nop 0
    buffer_load_dwordx4 v7, s[4:7], s33 offen sc1 lds
    s_add_u32 m0, s35, 0x10400
    s_nop 0
    buffer_load_dwordx4 v8, s[4:7], s33 offen sc1 lds
    s_add_u32 m0, s35, 0x10800
    s_nop 0
    buffer_load_dwordx4 v9, s[4:7], s33 offen sc1 lds
    s_add_u32 m0, s35, 0x10c00
    s_nop 0
    buffer_load_dwordx4 v10, s[4:7], s33 offen sc1 lds
    s_add_u32 s33, s33, 128
    s_cmp_eq_u32 s33, 1280
    s_cselect_b32 s33, 0, s33
    s_waitcnt vmcnt(16)
    s_barrier
    s_add_u32 m0, s36, 0x1c000
    s_nop 0
    buffer_load_dwordx4 v19, s[8:11], s34 offen lds
    s_add_u32 m0, s36, 0x1c400
    s_nop 0
    buffer_load_dwordx4 v20, s[8:11], s34 offen lds
    s_add_u32 m0, s36, 0x1c800
    s_nop 0
    buffer_load_dwordx4 v21, s[8:11], s34 offen lds
    s_add_u32 m0, s36, 0x1cc00
    s_nop 0
    buffer_load_dwordx4 v22, s[8:11], s34 offen lds
    s_add_u32 s34, s34, 221184
    s_cmp_eq_u32 s34, 2211840
    s_cselect_b32 s34, 0, s34
    s_add_u32 m0, s35, 0x18000
    s_nop 0
    buffer_load_dwordx4 v7, s[4:7], s33 offen sc1 lds
    s_add_u32 m0, s35, 0x18400
    s_nop 0
    buffer_load_dwordx4 v8, s[4:7], s33 offen sc1 lds
    s_add_u32 m0, s35, 0x18800
    s_nop 0
    buffer_load_dwordx4 v9, s[4:7], s33 offen sc1 lds
    s_add_u32 m0, s35, 0x18c00
    s_nop 0
    buffer_load_dwordx4 v10, s[4:7], s33 offen sc1 lds
    s_add_u32 s33, s33, 128
    s_cmp_eq_u32 s33, 1280
    s_cselect_b32 s33, 0, s33
    s_waitcnt vmcnt(16)
    s_barrier
    s_add_u32 m0, s36, 0x4000
    s_nop 0
    buffer_load_dwordx4 v19, s[8:11], s34 offen lds
    s_add_u32 m0, s36, 0x4400
    s_nop 0
    buffer_load_dwordx4 v20, s[8:11], s34 offen lds
    s_add_u32 m0, s36, 0x4800
    s_nop 0
    buffer_load_dwordx4 v21, s[8:11], s34 offen lds
    s_add_u32 m0, s36, 0x4c00
    s_nop 0
    buffer_load_dwordx4 v22, s[8:11], s34 offen lds
    s_add_u32 s34, s34, 221184
    s_cmp_eq_u32 s34, 2211840
    s_cselect_b32 s34, 0, s34
    s_add_u32 m0, s35, 0x0
    s_nop 0
    buffer_load_dwordx4 v7, s[4:7], s33 offen sc1 lds
    s_add_u32 m0, s35, 0x400
    s_nop 0
    buffer_load_dwordx4 v8, s[4:7], s33 offen sc1 lds
    s_add_u32 m0, s35, 0x800
    s_nop 0
    buffer_load_dwordx4 v9, s[4:7], s33 offen sc1 lds
    s_add_u32 m0, s35, 0xc00
    s_nop 0
    buffer_load_dwordx4 v10, s[4:7], s33 offen sc1 lds
    s_add_u32 s33, s33, 128
    s_cmp_eq_u32 s33, 1280
    s_cselect_b32 s33, 0, s33
    s_waitcnt vmcnt(16)
    s_barrier
    s_add_u32 m0, s36, 0xc000
    s_nop 0
    buffer_load_dwordx4 v19, s[8:11], s34 offen lds
    s_add_u32 m0, s36, 0xc400
    s_nop 0
    buffer_load_dwordx4 v20, s[8:11], s34 offen lds
    s_add_u32 m0, s36, 0xc800
    s_nop 0
    buffer_load_dwordx4 v21, s[8:11], s34 offen lds
    s_add_u32 m0, s36, 0xcc00
    s_nop 0
    buffer_load_dwordx4 v22, s[8:11], s34 offen lds
    s_add_u32 s34, s34, 221184
    s_cmp_eq_u32 s34, 2211840
    s_cselect_b32 s34, 0, s34
    s_add_u32 m0, s35, 0x8000
    s_nop 0
    buffer_load_dwordx4 v7, s[4:7], s33 offen sc1 lds
    s_add_u32 m0, s35, 0x8400
    s_nop 0
    buffer_load_dwordx4 v8, s[4:7], s33 offen sc1 lds
    s_add_u32 m0, s35, 0x8800
    s_nop 0
    buffer_load_dwordx4 v9, s[4:7], s33 offen sc1 lds
    s_add_u32 m0, s35, 0x8c00
    s_nop 0
    buffer_load_dwordx4 v10, s[4:7], s33 offen sc1 lds
    s_add_u32 s33, s33, 128
    s_cmp_eq_u32 s33, 1280
    s_cselect_b32 s33, 0, s33
    v_lshl_add_u32 v23, s30, 6, v0
    s_lshr_b32 s31, s2, 3
    s_mul_i32 s31, s31, 270
    s_add_u32 s32, s31, 270
    s_min_u32 s32, s32, 8640
    s_and_b32 s54, s2, 1
    s_mul_i32 s54, s54, 640
    s_mov_b32 s12, s72
    s_and_b32 s13, s73, 0xffff
    s_mov_b32 s14, 0x21c000
    s_mov_b32 s15, 0x20000
    v_add_u32 v1, s31, v23
    v_mul_u32_u24 v2, 13108, v1
    v_lshrrev_b32 v2, 16, v2
    v_mul_u32_u24 v3, 5, v2
    v_sub_u32 v3, v1, v3
    v_mul_u32_u24 v2, 1280, v2
    v_lshl_add_u32 v2, v3, 7, v2
    v_cmp_gt_u32 vcc, s32, v1
    v_mov_b32 v3, -1
    s_nop 0
    v_cndmask_b32 v2, v3, v2, vcc
    buffer_load_dword v4, v2, s[12:15], s54 offen
    v_add_u32 v1, s31, v23
    v_add_u32 v1, 256, v1
    v_mul_u32_u24 v2, 13108, v1
    v_lshrrev_b32 v2, 16, v2
    v_mul_u32_u24 v3, 5, v2
    v_sub_u32 v3, v1, v3
    v_mul_u32_u24 v2, 1280, v2
    v_lshl_add_u32 v2, v3, 7, v2
    v_cmp_gt_u32 vcc, s32, v1
    v_mov_b32 v3, -1
    s_nop 0
    v_cndmask_b32 v2, v3, v2, vcc
    buffer_load_dword v4, v2, s[12:15], s54 offen
    s_waitcnt vmcnt(18)
    s_barrier
    s_waitcnt vmcnt(10)
    s_barrier
    s_waitcnt vmcnt(2)
    s_barrier
    s_barrier
    s_barrier
w1_kernel_end:
    s_setprio 0
w2_kernel:
    s_and_b32 s31, s2, 7
    s_lshr_b32 s32, s2, 3
    s_mul_i32 s54, s32, 205
    s_lshr_b32 s54, s54, 10
    s_mul_i32 s55, s54, 5
    s_sub_u32 s55, s32, s55
    s_lshr_b32 s32, s31, 1
    s_mul_i32 s28, s32, 11
    s_add_u32 s56, s28, 12
    s_lshr_b32 s56, s56, 1
    s_add_u32 s28, s28, 1
    s_lshr_b32 s28, s28, 1
    s_add_u32 s28, s28, s54
    s_cmp_ge_u32 s28, s56
    s_cbranch_scc1 w2_kernel_end
    s_and_b32 s29, s31, 1
    s_mul_i32 s29, s29, 5
    s_add_u32 s29, s29, s55
    s_mov_b32 s30, s80
    s_mul_i32 s40, s28, 96
    s_mul_i32 s41, s29, 64
    s_cmp_ge_u32 s30, 4
    s_cbranch_scc1 w2_kernel_loader
    v_lshrrev_b32 v1, 4, v0
    v_and_b32 v2, 15, v0
    s_lshr_b32 s38, s30, 1
    s_and_b32 s39, s30, 1
    s_mul_i32 s31, s38, 6144
    v_lshrrev_b32 v3, 1, v2
    v_lshlrev_b32 v4, 7, v2
    v_add_u32 v4, s31, v4
    v_add_u32 v5, 0, v1
    v_xor_b32 v5, v5, v3
    v_lshl_add_u32 v7, v5, 4, v4
    v_add_u32 v5, 4, v1
    v_xor_b32 v5, v5, v3
    v_lshl_add_u32 v8, v5, 4, v4
    v_lshrrev_b32 v3, 2, v2
    v_and_b32 v4, 1, v1
    v_lshl_add_u32 v3, v4, 2, v3
    v_lshrrev_b32 v4, 1, v1
    v_lshl_add_u32 v4, v4, 4, v3
    v_mul_u32_u24 v4, 128, v4
    v_and_b32 v5, 1, v2
    v_lshl_add_u32 v4, v5, 3, v4
    v_bfe_u32 v5, v2, 1, 1
    v_lshl_add_u32 v4, v5, 4, v4
    v_add_u32 v4, 12288, v4
    v_and_b32 v3, 6, v3
    s_mul_i32 s31, s39, 2
    s_add_u32 s46, s31, 0
    s_lshl_b32 s31, s46, 1
    v_xor_b32 v5, s31, v3
    v_lshl_add_u32 v11, v5, 4, v4
    s_mul_i32 s31, s39, 2
    s_add_u32 s47, s31, 1
    s_lshl_b32 s31, s47, 1
    v_xor_b32 v5, s31, v3
    v_lshl_add_u32 v12, v5, 4, v4
    s_waitcnt lgkmcnt(0)
    s_mov_b32 s12, s74
    s_and_b32 s13, s75, 0xffff
    s_mov_b32 s14, 0x280000
    s_mov_b32 s15, 0x20000
    s_add_u32 s16, s78, 0xb00000
    s_addc_u32 s17, s79, 0
    s_and_b32 s17, s17, 0xffff
    s_mov_b32 s18, 0x280000
    s_mov_b32 s19, 0x20000
    s_mul_i32 s31, s30, 24
    s_add_u32 s31, s31, s40
    v_lshrrev_b32 v3, 3, v0
    v_add_u32 v3, s31, v3
    v_mul_u32_u24 v3, 1280, v3
    v_and_b32 v4, 7, v0
    v_lshl_add_u32 v3, v4, 4, v3
    s_lshl_b32 s31, s41, 1
    v_add_u32 v15, s31, v3
    v_add_u32 v16, 10240, v15
    v_add_u32 v17, 20480, v15
    buffer_load_dwordx4 v[20:23], v15, s[16:19], 0 offen sc1
    buffer_load_dwordx4 v[24:27], v16, s[16:19], 0 offen sc1
    buffer_load_dwordx4 v[28:31], v17, s[16:19], 0 offen sc1
    s_mul_i32 s31, s40, 8193
    s_lshr_b32 s31, s31, 20
    s_add_u32 s32, s40, 95
    s_mul_i32 s32, s32, 8193
    s_lshr_b32 s32, s32, 20
    s_min_u32 s32, s32, 15
    s_cmp_lg_u32 s80, 0
    s_cbranch_scc1 w2_kernel_dep_done
    s_waitcnt vmcnt(0)
    v_readfirstlane_b32 s81, v248
    s_nop 0
    s_cmp_eq_u32 s81, 0
    s_cselect_b32 s81, s82, s81
    v_lshrrev_b32 v3, 4, v0
    v_add_u32 v3, s31, v3
    v_and_b32 v4, 15, v0
    v_cmp_gt_u32 s[42:43], 14, v4
    v_cmp_le_i32 vcc, 0, v3
    s_and_b64 s[42:43], s[42:43], vcc
    v_cmp_ge_i32 vcc, s32, v3
    s_and_b64 s[42:43], s[42:43], vcc
    v_lshl_add_u32 v3, v3, 4, v4
    v_lshlrev_b32 v3, 3, v3
    v_add_u32 v3, 8192, v3
    s_mov_b32 s56, 0
    s_mov_b64 exec, s[42:43]
w2_kernel_dep_loop:
    buffer_load_dwordx2 v[244:245], v3, s[84:87], 0 offen sc1
    s_waitcnt vmcnt(0)
    v_not_b32 v245, v245
    v_xor_b32 v244, s81, v244
    v_xor_b32 v245, s81, v245
    v_or_b32 v244, v244, v245
    v_cmp_ne_u32 vcc, 0, v244
    s_nop 1
    s_cbranch_vccz w2_kernel_dep_ok
    s_sleep 1
    s_add_u32 s56, s56, 1
    s_cmp_lt_u32 s56, 200000
    s_cbranch_scc1 w2_kernel_dep_loop
w2_kernel_dep_ok:
    s_mov_b64 exec, -1
w2_kernel_dep_done:
    s_barrier
    s_barrier
    v_add_u32 v9, 0x0, v7
    v_add_u32 v10, 0x0, v8
    v_add_u32 v13, 0x0, v11
    v_add_u32 v14, 0x0, v12
    ds_read_b128 v[56:59], v9 offset:0
    ds_read_b128 v[60:63], v9 offset:2048
    ds_read_b128 v[64:67], v9 offset:4096
    ds_read_b64_tr_b16 v[104:105], v13 offset:0
    ds_read_b64_tr_b16 v[106:107], v13 offset:1024
    ds_read_b64_tr_b16 v[108:109], v14 offset:0
    ds_read_b64_tr_b16 v[110:111], v14 offset:1024
    ds_read_b128 v[68:71], v10 offset:0
    ds_read_b128 v[72:75], v10 offset:2048
    ds_read_b128 v[76:79], v10 offset:4096
    ds_read_b64_tr_b16 v[112:113], v13 offset:4096
    ds_read_b64_tr_b16 v[114:115], v13 offset:5120
    ds_read_b64_tr_b16 v[116:117], v14 offset:4096
    ds_read_b64_tr_b16 v[118:119], v14 offset:5120
    v_add_u32 v9, 0x5000, v7
    v_add_u32 v10, 0x5000, v8
    v_add_u32 v13, 0x5000, v11
    v_add_u32 v14, 0x5000, v12
    ds_read_b128 v[80:83], v9 offset:0
    ds_read_b128 v[84:87], v9 offset:2048
    ds_read_b128 v[88:91], v9 offset:4096
    ds_read_b64_tr_b16 v[120:121], v13 offset:0
    ds_read_b64_tr_b16 v[122:123], v13 offset:1024
    ds_read_b64_tr_b16 v[124:125], v14 offset:0
    ds_read_b64_tr_b16 v[126:127], v14 offset:1024
    s_waitcnt lgkmcnt(14)
    v_mfma_f32_16x16x32_bf16 v[32:35], v[104:107], v[56:59], 0
    ds_read_b128 v[92:95], v10 offset:0
    ds_read_b128 v[96:99], v10 offset:2048
    v_mfma_f32_16x16x32_bf16 v[40:43], v[104:107], v[60:63], 0
    ds_read_b128 v[100:103], v10 offset:4096
    ds_read_b64_tr_b16 v[128:129], v13 offset:4096
    v_mfma_f32_16x16x32_bf16 v[48:51], v[104:107], v[64:67], 0
    ds_read_b64_tr_b16 v[130:131], v13 offset:5120
    ds_read_b64_tr_b16 v[132:133], v14 offset:4096
    v_mfma_f32_16x16x32_bf16 v[36:39], v[108:111], v[56:59], 0
    ds_read_b64_tr_b16 v[134:135], v14 offset:5120
    v_mfma_f32_16x16x32_bf16 v[44:47], v[108:111], v[60:63], 0
    v_mfma_f32_16x16x32_bf16 v[52:55], v[108:111], v[64:67], 0
    s_waitcnt lgkmcnt(14)
    v_mfma_f32_16x16x32_bf16 v[32:35], v[112:115], v[68:71], v[32:35]
    s_waitcnt lgkmcnt(0)
    s_barrier
    v_mfma_f32_16x16x32_bf16 v[40:43], v[112:115], v[72:75], v[40:43]
    v_add_u32 v9, 0xa000, v7
    v_add_u32 v10, 0xa000, v8
    v_add_u32 v13, 0xa000, v11
    v_add_u32 v14, 0xa000, v12
    v_mfma_f32_16x16x32_bf16 v[48:51], v[112:115], v[76:79], v[48:51]
    ds_read_b128 v[56:59], v9 offset:0
    ds_read_b128 v[60:63], v9 offset:2048
    ds_read_b128 v[64:67], v9 offset:4096
    ds_read_b64_tr_b16 v[104:105], v13 offset:0
    v_mfma_f32_16x16x32_bf16 v[36:39], v[116:119], v[68:71], v[36:39]
    ds_read_b64_tr_b16 v[106:107], v13 offset:1024
    ds_read_b64_tr_b16 v[108:109], v14 offset:0
    ds_read_b64_tr_b16 v[110:111], v14 offset:1024
    v_mfma_f32_16x16x32_bf16 v[44:47], v[116:119], v[72:75], v[44:47]
    v_mfma_f32_16x16x32_bf16 v[52:55], v[116:119], v[76:79], v[52:55]
    s_waitcnt lgkmcnt(14)
    v_mfma_f32_16x16x32_bf16 v[32:35], v[120:123], v[80:83], v[32:35]
    ds_read_b128 v[68:71], v10 offset:0
    ds_read_b128 v[72:75], v10 offset:2048
    v_mfma_f32_16x16x32_bf16 v[40:43], v[120:123], v[84:87], v[40:43]
    ds_read_b128 v[76:79], v10 offset:4096
    ds_read_b64_tr_b16 v[112:113], v13 offset:4096
    v_mfma_f32_16x16x32_bf16 v[48:51], v[120:123], v[88:91], v[48:51]
    ds_read_b64_tr_b16 v[114:115], v13 offset:5120
    ds_read_b64_tr_b16 v[116:117], v14 offset:4096
    v_mfma_f32_16x16x32_bf16 v[36:39], v[124:127], v[80:83], v[36:39]
    ds_read_b64_tr_b16 v[118:119], v14 offset:5120
    v_mfma_f32_16x16x32_bf16 v[44:47], v[124:127], v[84:87], v[44:47]
    v_mfma_f32_16x16x32_bf16 v[52:55], v[124:127], v[88:91], v[52:55]
    s_waitcnt lgkmcnt(14)
    v_mfma_f32_16x16x32_bf16 v[32:35], v[128:131], v[92:95], v[32:35]
    v_add_u32 v9, 0xf000, v7
    v_add_u32 v10, 0xf000, v8
    v_add_u32 v13, 0xf000, v11
    v_mfma_f32_16x16x32_bf16 v[40:43], v[128:131], v[96:99], v[40:43]
    v_add_u32 v14, 0xf000, v12
    ds_read_b128 v[80:83], v9 offset:0
    ds_read_b128 v[84:87], v9 offset:2048
    v_mfma_f32_16x16x32_bf16 v[48:51], v[128:131], v[100:103], v[48:51]
    ds_read_b128 v[88:91], v9 offset:4096
    ds_read_b64_tr_b16 v[120:121], v13 offset:0
    ds_read_b64_tr_b16 v[122:123], v13 offset:1024
    v_mfma_f32_16x16x32_bf16 v[36:39], v[132:135], v[92:95], v[36:39]
    ds_read_b64_tr_b16 v[124:125], v14 offset:0
    ds_read_b64_tr_b16 v[126:127], v14 offset:1024
    v_mfma_f32_16x16x32_bf16 v[44:47], v[132:135], v[96:99], v[44:47]
    v_mfma_f32_16x16x32_bf16 v[52:55], v[132:135], v[100:103], v[52:55]
    s_waitcnt lgkmcnt(14)
    v_mfma_f32_16x16x32_bf16 v[32:35], v[104:107], v[56:59], v[32:35]
    ds_read_b128 v[92:95], v10 offset:0
    ds_read_b128 v[96:99], v10 offset:2048
    v_mfma_f32_16x16x32_bf16 v[40:43], v[104:107], v[60:63], v[40:43]
    ds_read_b128 v[100:103], v10 offset:4096
    ds_read_b64_tr_b16 v[128:129], v13 offset:4096
    v_mfma_f32_16x16x32_bf16 v[48:51], v[104:107], v[64:67], v[48:51]
    ds_read_b64_tr_b16 v[130:131], v13 offset:5120
    ds_read_b64_tr_b16 v[132:133], v14 offset:4096
    v_mfma_f32_16x16x32_bf16 v[36:39], v[108:111], v[56:59], v[36:39]
    ds_read_b64_tr_b16 v[134:135], v14 offset:5120
    v_mfma_f32_16x16x32_bf16 v[44:47], v[108:111], v[60:63], v[44:47]
    v_mfma_f32_16x16x32_bf16 v[52:55], v[108:111], v[64:67], v[52:55]
    s_waitcnt lgkmcnt(14)
    v_mfma_f32_16x16x32_bf16 v[32:35], v[112:115], v[68:71], v[32:35]
    s_waitcnt lgkmcnt(0)
    s_barrier
    v_mfma_f32_16x16x32_bf16 v[40:43], v[112:115], v[72:75], v[40:43]
    v_add_u32 v9, 0x14000, v7
    v_add_u32 v10, 0x14000, v8
    v_add_u32 v13, 0x14000, v11
    v_add_u32 v14, 0x14000, v12
    v_mfma_f32_16x16x32_bf16 v[48:51], v[112:115], v[76:79], v[48:51]
    ds_read_b128 v[56:59], v9 offset:0
    ds_read_b128 v[60:63], v9 offset:2048
    ds_read_b128 v[64:67], v9 offset:4096
    ds_read_b64_tr_b16 v[104:105], v13 offset:0
    v_mfma_f32_16x16x32_bf16 v[36:39], v[116:119], v[68:71], v[36:39]
    ds_read_b64_tr_b16 v[106:107], v13 offset:1024
    ds_read_b64_tr_b16 v[108:109], v14 offset:0
    ds_read_b64_tr_b16 v[110:111], v14 offset:1024
    v_mfma_f32_16x16x32_bf16 v[44:47], v[116:119], v[72:75], v[44:47]
    v_mfma_f32_16x16x32_bf16 v[52:55], v[116:119], v[76:79], v[52:55]
    s_waitcnt lgkmcnt(14)
    v_mfma_f32_16x16x32_bf16 v[32:35], v[120:123], v[80:83], v[32:35]
    ds_read_b128 v[68:71], v10 offset:0
    ds_read_b128 v[72:75], v10 offset:2048
    v_mfma_f32_16x16x32_bf16 v[40:43], v[120:123], v[84:87], v[40:43]
    ds_read_b128 v[76:79], v10 offset:4096
    ds_read_b64_tr_b16 v[112:113], v13 offset:4096
    v_mfma_f32_16x16x32_bf16 v[48:51], v[120:123], v[88:91], v[48:51]
    ds_read_b64_tr_b16 v[114:115], v13 offset:5120
    ds_read_b64_tr_b16 v[116:117], v14 offset:4096
    v_mfma_f32_16x16x32_bf16 v[36:39], v[124:127], v[80:83], v[36:39]
    ds_read_b64_tr_b16 v[118:119], v14 offset:5120
    v_mfma_f32_16x16x32_bf16 v[44:47], v[124:127], v[84:87], v[44:47]
    v_mfma_f32_16x16x32_bf16 v[52:55], v[124:127], v[88:91], v[52:55]
    s_waitcnt lgkmcnt(14)
    v_mfma_f32_16x16x32_bf16 v[32:35], v[128:131], v[92:95], v[32:35]
    v_add_u32 v9, 0x19000, v7
    v_add_u32 v10, 0x19000, v8
    v_add_u32 v13, 0x19000, v11
    v_mfma_f32_16x16x32_bf16 v[40:43], v[128:131], v[96:99], v[40:43]
    v_add_u32 v14, 0x19000, v12
    ds_read_b128 v[80:83], v9 offset:0
    ds_read_b128 v[84:87], v9 offset:2048
    v_mfma_f32_16x16x32_bf16 v[48:51], v[128:131], v[100:103], v[48:51]
    ds_read_b128 v[88:91], v9 offset:4096
    ds_read_b64_tr_b16 v[120:121], v13 offset:0
    ds_read_b64_tr_b16 v[122:123], v13 offset:1024
    v_mfma_f32_16x16x32_bf16 v[36:39], v[132:135], v[92:95], v[36:39]
    ds_read_b64_tr_b16 v[124:125], v14 offset:0
    ds_read_b64_tr_b16 v[126:127], v14 offset:1024
    v_mfma_f32_16x16x32_bf16 v[44:47], v[132:135], v[96:99], v[44:47]
    v_mfma_f32_16x16x32_bf16 v[52:55], v[132:135], v[100:103], v[52:55]
    s_waitcnt lgkmcnt(14)
    v_mfma_f32_16x16x32_bf16 v[32:35], v[104:107], v[56:59], v[32:35]
    ds_read_b128 v[92:95], v10 offset:0
    ds_read_b128 v[96:99], v10 offset:2048
    v_mfma_f32_16x16x32_bf16 v[40:43], v[104:107], v[60:63], v[40:43]
    ds_read_b128 v[100:103], v10 offset:4096
    ds_read_b64_tr_b16 v[128:129], v13 offset:4096
    v_mfma_f32_16x16x32_bf16 v[48:51], v[104:107], v[64:67], v[48:51]
    ds_read_b64_tr_b16 v[130:131], v13 offset:5120
    ds_read_b64_tr_b16 v[132:133], v14 offset:4096
    v_mfma_f32_16x16x32_bf16 v[36:39], v[108:111], v[56:59], v[36:39]
    ds_read_b64_tr_b16 v[134:135], v14 offset:5120
    v_mfma_f32_16x16x32_bf16 v[44:47], v[108:111], v[60:63], v[44:47]
    v_mfma_f32_16x16x32_bf16 v[52:55], v[108:111], v[64:67], v[52:55]
    s_waitcnt lgkmcnt(14)
    v_mfma_f32_16x16x32_bf16 v[32:35], v[112:115], v[68:71], v[32:35]
    s_waitcnt lgkmcnt(0)
    s_barrier
    v_mfma_f32_16x16x32_bf16 v[40:43], v[112:115], v[72:75], v[40:43]
    v_add_u32 v9, 0x1e000, v7
    v_add_u32 v10, 0x1e000, v8
    v_add_u32 v13, 0x1e000, v11
    v_add_u32 v14, 0x1e000, v12
    v_mfma_f32_16x16x32_bf16 v[48:51], v[112:115], v[76:79], v[48:51]
    ds_read_b128 v[56:59], v9 offset:0
    ds_read_b128 v[60:63], v9 offset:2048
    ds_read_b128 v[64:67], v9 offset:4096
    ds_read_b64_tr_b16 v[104:105], v13 offset:0
    v_mfma_f32_16x16x32_bf16 v[36:39], v[116:119], v[68:71], v[36:39]
    ds_read_b64_tr_b16 v[106:107], v13 offset:1024
    ds_read_b64_tr_b16 v[108:109], v14 offset:0
    ds_read_b64_tr_b16 v[110:111], v14 offset:1024
    v_mfma_f32_16x16x32_bf16 v[44:47], v[116:119], v[72:75], v[44:47]
    v_mfma_f32_16x16x32_bf16 v[52:55], v[116:119], v[76:79], v[52:55]
    s_waitcnt lgkmcnt(14)
    v_mfma_f32_16x16x32_bf16 v[32:35], v[120:123], v[80:83], v[32:35]
    ds_read_b128 v[68:71], v10 offset:0
    ds_read_b128 v[72:75], v10 offset:2048
    v_mfma_f32_16x16x32_bf16 v[40:43], v[120:123], v[84:87], v[40:43]
    ds_read_b128 v[76:79], v10 offset:4096
    ds_read_b64_tr_b16 v[112:113], v13 offset:4096
    v_mfma_f32_16x16x32_bf16 v[48:51], v[120:123], v[88:91], v[48:51]
    ds_read_b64_tr_b16 v[114:115], v13 offset:5120
    ds_read_b64_tr_b16 v[116:117], v14 offset:4096
    v_mfma_f32_16x16x32_bf16 v[36:39], v[124:127], v[80:83], v[36:39]
    ds_read_b64_tr_b16 v[118:119], v14 offset:5120
    v_mfma_f32_16x16x32_bf16 v[44:47], v[124:127], v[84:87], v[44:47]
    v_mfma_f32_16x16x32_bf16 v[52:55], v[124:127], v[88:91], v[52:55]
    s_waitcnt lgkmcnt(14)
    v_mfma_f32_16x16x32_bf16 v[32:35], v[128:131], v[92:95], v[32:35]
    v_add_u32 v9, 0x23000, v7
    v_add_u32 v10, 0x23000, v8
    v_add_u32 v13, 0x23000, v11
    v_mfma_f32_16x16x32_bf16 v[40:43], v[128:131], v[96:99], v[40:43]
    v_add_u32 v14, 0x23000, v12
    ds_read_b128 v[80:83], v9 offset:0
    ds_read_b128 v[84:87], v9 offset:2048
    v_mfma_f32_16x16x32_bf16 v[48:51], v[128:131], v[100:103], v[48:51]
    ds_read_b128 v[88:91], v9 offset:4096
    ds_read_b64_tr_b16 v[120:121], v13 offset:0
    ds_read_b64_tr_b16 v[122:123], v13 offset:1024
    v_mfma_f32_16x16x32_bf16 v[36:39], v[132:135], v[92:95], v[36:39]
    ds_read_b64_tr_b16 v[124:125], v14 offset:0
    ds_read_b64_tr_b16 v[126:127], v14 offset:1024
    v_mfma_f32_16x16x32_bf16 v[44:47], v[132:135], v[96:99], v[44:47]
    v_mfma_f32_16x16x32_bf16 v[52:55], v[132:135], v[100:103], v[52:55]
    s_waitcnt lgkmcnt(14)
    v_mfma_f32_16x16x32_bf16 v[32:35], v[104:107], v[56:59], v[32:35]
    ds_read_b128 v[92:95], v10 offset:0
    ds_read_b128 v[96:99], v10 offset:2048
    v_mfma_f32_16x16x32_bf16 v[40:43], v[104:107], v[60:63], v[40:43]
    ds_read_b128 v[100:103], v10 offset:4096
    ds_read_b64_tr_b16 v[128:129], v13 offset:4096
    v_mfma_f32_16x16x32_bf16 v[48:51], v[104:107], v[64:67], v[48:51]
    ds_read_b64_tr_b16 v[130:131], v13 offset:5120
    ds_read_b64_tr_b16 v[132:133], v14 offset:4096
    v_mfma_f32_16x16x32_bf16 v[36:39], v[108:111], v[56:59], v[36:39]
    ds_read_b64_tr_b16 v[134:135], v14 offset:5120
    v_mfma_f32_16x16x32_bf16 v[44:47], v[108:111], v[60:63], v[44:47]
    v_mfma_f32_16x16x32_bf16 v[52:55], v[108:111], v[64:67], v[52:55]
    s_waitcnt lgkmcnt(14)
    v_mfma_f32_16x16x32_bf16 v[32:35], v[112:115], v[68:71], v[32:35]
    s_waitcnt lgkmcnt(0)
    s_barrier
    v_mfma_f32_16x16x32_bf16 v[40:43], v[112:115], v[72:75], v[40:43]
    v_add_u32 v9, 0x0, v7
    v_add_u32 v10, 0x0, v8
    v_add_u32 v13, 0x0, v11
    v_add_u32 v14, 0x0, v12
    v_mfma_f32_16x16x32_bf16 v[48:51], v[112:115], v[76:79], v[48:51]
    ds_read_b128 v[56:59], v9 offset:0
    ds_read_b128 v[60:63], v9 offset:2048
    ds_read_b128 v[64:67], v9 offset:4096
    ds_read_b64_tr_b16 v[104:105], v13 offset:0
    v_mfma_f32_16x16x32_bf16 v[36:39], v[116:119], v[68:71], v[36:39]
    ds_read_b64_tr_b16 v[106:107], v13 offset:1024
    ds_read_b64_tr_b16 v[108:109], v14 offset:0
    ds_read_b64_tr_b16 v[110:111], v14 offset:1024
    v_mfma_f32_16x16x32_bf16 v[44:47], v[116:119], v[72:75], v[44:47]
    v_mfma_f32_16x16x32_bf16 v[52:55], v[116:119], v[76:79], v[52:55]
    s_waitcnt lgkmcnt(14)
    v_mfma_f32_16x16x32_bf16 v[32:35], v[120:123], v[80:83], v[32:35]
    ds_read_b128 v[68:71], v10 offset:0
    ds_read_b128 v[72:75], v10 offset:2048
    v_mfma_f32_16x16x32_bf16 v[40:43], v[120:123], v[84:87], v[40:43]
    ds_read_b128 v[76:79], v10 offset:4096
    ds_read_b64_tr_b16 v[112:113], v13 offset:4096
    v_mfma_f32_16x16x32_bf16 v[48:51], v[120:123], v[88:91], v[48:51]
    ds_read_b64_tr_b16 v[114:115], v13 offset:5120
    ds_read_b64_tr_b16 v[116:117], v14 offset:4096
    v_mfma_f32_16x16x32_bf16 v[36:39], v[124:127], v[80:83], v[36:39]
    ds_read_b64_tr_b16 v[118:119], v14 offset:5120
    v_mfma_f32_16x16x32_bf16 v[44:47], v[124:127], v[84:87], v[44:47]
    v_mfma_f32_16x16x32_bf16 v[52:55], v[124:127], v[88:91], v[52:55]
    s_waitcnt lgkmcnt(14)
    v_mfma_f32_16x16x32_bf16 v[32:35], v[128:131], v[92:95], v[32:35]
    v_add_u32 v9, 0x5000, v7
    v_add_u32 v10, 0x5000, v8
    v_add_u32 v13, 0x5000, v11
    v_mfma_f32_16x16x32_bf16 v[40:43], v[128:131], v[96:99], v[40:43]
    v_add_u32 v14, 0x5000, v12
    ds_read_b128 v[80:83], v9 offset:0
    ds_read_b128 v[84:87], v9 offset:2048
    v_mfma_f32_16x16x32_bf16 v[48:51], v[128:131], v[100:103], v[48:51]
    ds_read_b128 v[88:91], v9 offset:4096
    ds_read_b64_tr_b16 v[120:121], v13 offset:0
    ds_read_b64_tr_b16 v[122:123], v13 offset:1024
    v_mfma_f32_16x16x32_bf16 v[36:39], v[132:135], v[92:95], v[36:39]
    ds_read_b64_tr_b16 v[124:125], v14 offset:0
    ds_read_b64_tr_b16 v[126:127], v14 offset:1024
    v_mfma_f32_16x16x32_bf16 v[44:47], v[132:135], v[96:99], v[44:47]
    v_mfma_f32_16x16x32_bf16 v[52:55], v[132:135], v[100:103], v[52:55]
    s_waitcnt lgkmcnt(14)
    v_mfma_f32_16x16x32_bf16 v[32:35], v[104:107], v[56:59], v[32:35]
    ds_read_b128 v[92:95], v10 offset:0
    ds_read_b128 v[96:99], v10 offset:2048
    v_mfma_f32_16x16x32_bf16 v[40:43], v[104:107], v[60:63], v[40:43]
    ds_read_b128 v[100:103], v10 offset:4096
    ds_read_b64_tr_b16 v[128:129], v13 offset:4096
    v_mfma_f32_16x16x32_bf16 v[48:51], v[104:107], v[64:67], v[48:51]
    ds_read_b64_tr_b16 v[130:131], v13 offset:5120
    ds_read_b64_tr_b16 v[132:133], v14 offset:4096
    v_mfma_f32_16x16x32_bf16 v[36:39], v[108:111], v[56:59], v[36:39]
    ds_read_b64_tr_b16 v[134:135], v14 offset:5120
    v_mfma_f32_16x16x32_bf16 v[44:47], v[108:111], v[60:63], v[44:47]
    v_mfma_f32_16x16x32_bf16 v[52:55], v[108:111], v[64:67], v[52:55]
    s_waitcnt lgkmcnt(14)
    v_mfma_f32_16x16x32_bf16 v[32:35], v[112:115], v[68:71], v[32:35]
    s_waitcnt lgkmcnt(0)
    s_barrier
    v_mfma_f32_16x16x32_bf16 v[40:43], v[112:115], v[72:75], v[40:43]
    v_add_u32 v9, 0xa000, v7
    v_add_u32 v10, 0xa000, v8
    v_add_u32 v13, 0xa000, v11
    v_add_u32 v14, 0xa000, v12
    v_mfma_f32_16x16x32_bf16 v[48:51], v[112:115], v[76:79], v[48:51]
    ds_read_b128 v[56:59], v9 offset:0
    ds_read_b128 v[60:63], v9 offset:2048
    ds_read_b128 v[64:67], v9 offset:4096
    ds_read_b64_tr_b16 v[104:105], v13 offset:0
    v_mfma_f32_16x16x32_bf16 v[36:39], v[116:119], v[68:71], v[36:39]
    ds_read_b64_tr_b16 v[106:107], v13 offset:1024
    ds_read_b64_tr_b16 v[108:109], v14 offset:0
    ds_read_b64_tr_b16 v[110:111], v14 offset:1024
    v_mfma_f32_16x16x32_bf16 v[44:47], v[116:119], v[72:75], v[44:47]
    v_mfma_f32_16x16x32_bf16 v[52:55], v[116:119], v[76:79], v[52:55]
    s_waitcnt lgkmcnt(14)
    v_mfma_f32_16x16x32_bf16 v[32:35], v[120:123], v[80:83], v[32:35]
    ds_read_b128 v[68:71], v10 offset:0
    ds_read_b128 v[72:75], v10 offset:2048
    v_mfma_f32_16x16x32_bf16 v[40:43], v[120:123], v[84:87], v[40:43]
    ds_read_b128 v[76:79], v10 offset:4096
    ds_read_b64_tr_b16 v[112:113], v13 offset:4096
    v_mfma_f32_16x16x32_bf16 v[48:51], v[120:123], v[88:91], v[48:51]
    ds_read_b64_tr_b16 v[114:115], v13 offset:5120
    ds_read_b64_tr_b16 v[116:117], v14 offset:4096
    v_mfma_f32_16x16x32_bf16 v[36:39], v[124:127], v[80:83], v[36:39]
    ds_read_b64_tr_b16 v[118:119], v14 offset:5120
    v_mfma_f32_16x16x32_bf16 v[44:47], v[124:127], v[84:87], v[44:47]
    v_mfma_f32_16x16x32_bf16 v[52:55], v[124:127], v[88:91], v[52:55]
    s_waitcnt lgkmcnt(14)
    v_mfma_f32_16x16x32_bf16 v[32:35], v[128:131], v[92:95], v[32:35]
    v_add_u32 v9, 0xf000, v7
    v_add_u32 v10, 0xf000, v8
    v_add_u32 v13, 0xf000, v11
    v_mfma_f32_16x16x32_bf16 v[40:43], v[128:131], v[96:99], v[40:43]
    v_add_u32 v14, 0xf000, v12
    ds_read_b128 v[80:83], v9 offset:0
    ds_read_b128 v[84:87], v9 offset:2048
    v_mfma_f32_16x16x32_bf16 v[48:51], v[128:131], v[100:103], v[48:51]
    ds_read_b128 v[88:91], v9 offset:4096
    ds_read_b64_tr_b16 v[120:121], v13 offset:0
    ds_read_b64_tr_b16 v[122:123], v13 offset:1024
    v_mfma_f32_16x16x32_bf16 v[36:39], v[132:135], v[92:95], v[36:39]
    ds_read_b64_tr_b16 v[124:125], v14 offset:0
    ds_read_b64_tr_b16 v[126:127], v14 offset:1024
    v_mfma_f32_16x16x32_bf16 v[44:47], v[132:135], v[96:99], v[44:47]
    v_mfma_f32_16x16x32_bf16 v[52:55], v[132:135], v[100:103], v[52:55]
    s_waitcnt lgkmcnt(14)
    v_mfma_f32_16x16x32_bf16 v[32:35], v[104:107], v[56:59], v[32:35]
    ds_read_b128 v[92:95], v10 offset:0
    ds_read_b128 v[96:99], v10 offset:2048
    v_mfma_f32_16x16x32_bf16 v[40:43], v[104:107], v[60:63], v[40:43]
    ds_read_b128 v[100:103], v10 offset:4096
    ds_read_b64_tr_b16 v[128:129], v13 offset:4096
    v_mfma_f32_16x16x32_bf16 v[48:51], v[104:107], v[64:67], v[48:51]
    ds_read_b64_tr_b16 v[130:131], v13 offset:5120
    ds_read_b64_tr_b16 v[132:133], v14 offset:4096
    v_mfma_f32_16x16x32_bf16 v[36:39], v[108:111], v[56:59], v[36:39]
    ds_read_b64_tr_b16 v[134:135], v14 offset:5120
    v_mfma_f32_16x16x32_bf16 v[44:47], v[108:111], v[60:63], v[44:47]
    v_mfma_f32_16x16x32_bf16 v[52:55], v[108:111], v[64:67], v[52:55]
    s_waitcnt lgkmcnt(14)
    v_mfma_f32_16x16x32_bf16 v[32:35], v[112:115], v[68:71], v[32:35]
    s_waitcnt lgkmcnt(0)
    s_barrier
    v_mfma_f32_16x16x32_bf16 v[40:43], v[112:115], v[72:75], v[40:43]
    v_add_u32 v9, 0x14000, v7
    v_add_u32 v10, 0x14000, v8
    v_add_u32 v13, 0x14000, v11
    v_add_u32 v14, 0x14000, v12
    v_mfma_f32_16x16x32_bf16 v[48:51], v[112:115], v[76:79], v[48:51]
    ds_read_b128 v[56:59], v9 offset:0
    ds_read_b128 v[60:63], v9 offset:2048
    ds_read_b128 v[64:67], v9 offset:4096
    ds_read_b64_tr_b16 v[104:105], v13 offset:0
    v_mfma_f32_16x16x32_bf16 v[36:39], v[116:119], v[68:71], v[36:39]
    ds_read_b64_tr_b16 v[106:107], v13 offset:1024
    ds_read_b64_tr_b16 v[108:109], v14 offset:0
    ds_read_b64_tr_b16 v[110:111], v14 offset:1024
    v_mfma_f32_16x16x32_bf16 v[44:47], v[116:119], v[72:75], v[44:47]
    v_mfma_f32_16x16x32_bf16 v[52:55], v[116:119], v[76:79], v[52:55]
    s_waitcnt lgkmcnt(14)
    v_mfma_f32_16x16x32_bf16 v[32:35], v[120:123], v[80:83], v[32:35]
    ds_read_b128 v[68:71], v10 offset:0
    ds_read_b128 v[72:75], v10 offset:2048
    v_mfma_f32_16x16x32_bf16 v[40:43], v[120:123], v[84:87], v[40:43]
    ds_read_b128 v[76:79], v10 offset:4096
    ds_read_b64_tr_b16 v[112:113], v13 offset:4096
    v_mfma_f32_16x16x32_bf16 v[48:51], v[120:123], v[88:91], v[48:51]
    ds_read_b64_tr_b16 v[114:115], v13 offset:5120
    ds_read_b64_tr_b16 v[116:117], v14 offset:4096
    v_mfma_f32_16x16x32_bf16 v[36:39], v[124:127], v[80:83], v[36:39]
    ds_read_b64_tr_b16 v[118:119], v14 offset:5120
    v_mfma_f32_16x16x32_bf16 v[44:47], v[124:127], v[84:87], v[44:47]
    v_mfma_f32_16x16x32_bf16 v[52:55], v[124:127], v[88:91], v[52:55]
    s_waitcnt lgkmcnt(14)
    v_mfma_f32_16x16x32_bf16 v[32:35], v[128:131], v[92:95], v[32:35]
    v_add_u32 v9, 0x19000, v7
    v_add_u32 v10, 0x19000, v8
    v_add_u32 v13, 0x19000, v11
    v_mfma_f32_16x16x32_bf16 v[40:43], v[128:131], v[96:99], v[40:43]
    v_add_u32 v14, 0x19000, v12
    ds_read_b128 v[80:83], v9 offset:0
    ds_read_b128 v[84:87], v9 offset:2048
    v_mfma_f32_16x16x32_bf16 v[48:51], v[128:131], v[100:103], v[48:51]
    ds_read_b128 v[88:91], v9 offset:4096
    ds_read_b64_tr_b16 v[120:121], v13 offset:0
    ds_read_b64_tr_b16 v[122:123], v13 offset:1024
    v_mfma_f32_16x16x32_bf16 v[36:39], v[132:135], v[92:95], v[36:39]
    ds_read_b64_tr_b16 v[124:125], v14 offset:0
    ds_read_b64_tr_b16 v[126:127], v14 offset:1024
    v_mfma_f32_16x16x32_bf16 v[44:47], v[132:135], v[96:99], v[44:47]
    v_mfma_f32_16x16x32_bf16 v[52:55], v[132:135], v[100:103], v[52:55]
    s_waitcnt lgkmcnt(14)
    v_mfma_f32_16x16x32_bf16 v[32:35], v[104:107], v[56:59], v[32:35]
    ds_read_b128 v[92:95], v10 offset:0
    ds_read_b128 v[96:99], v10 offset:2048
    v_mfma_f32_16x16x32_bf16 v[40:43], v[104:107], v[60:63], v[40:43]
    ds_read_b128 v[100:103], v10 offset:4096
    ds_read_b64_tr_b16 v[128:129], v13 offset:4096
    v_mfma_f32_16x16x32_bf16 v[48:51], v[104:107], v[64:67], v[48:51]
    ds_read_b64_tr_b16 v[130:131], v13 offset:5120
    ds_read_b64_tr_b16 v[132:133], v14 offset:4096
    v_mfma_f32_16x16x32_bf16 v[36:39], v[108:111], v[56:59], v[36:39]
    ds_read_b64_tr_b16 v[134:135], v14 offset:5120
    v_mfma_f32_16x16x32_bf16 v[44:47], v[108:111], v[60:63], v[44:47]
    v_mfma_f32_16x16x32_bf16 v[52:55], v[108:111], v[64:67], v[52:55]
    s_waitcnt lgkmcnt(14)
    v_mfma_f32_16x16x32_bf16 v[32:35], v[112:115], v[68:71], v[32:35]
    s_waitcnt lgkmcnt(0)
    s_barrier
    v_mfma_f32_16x16x32_bf16 v[40:43], v[112:115], v[72:75], v[40:43]
    v_add_u32 v9, 0x1e000, v7
    v_add_u32 v10, 0x1e000, v8
    v_add_u32 v13, 0x1e000, v11
    v_add_u32 v14, 0x1e000, v12
    v_mfma_f32_16x16x32_bf16 v[48:51], v[112:115], v[76:79], v[48:51]
    ds_read_b128 v[56:59], v9 offset:0
    ds_read_b128 v[60:63], v9 offset:2048
    ds_read_b128 v[64:67], v9 offset:4096
    ds_read_b64_tr_b16 v[104:105], v13 offset:0
    v_mfma_f32_16x16x32_bf16 v[36:39], v[116:119], v[68:71], v[36:39]
    ds_read_b64_tr_b16 v[106:107], v13 offset:1024
    ds_read_b64_tr_b16 v[108:109], v14 offset:0
    ds_read_b64_tr_b16 v[110:111], v14 offset:1024
    v_mfma_f32_16x16x32_bf16 v[44:47], v[116:119], v[72:75], v[44:47]
    v_mfma_f32_16x16x32_bf16 v[52:55], v[116:119], v[76:79], v[52:55]
    s_waitcnt lgkmcnt(14)
    v_mfma_f32_16x16x32_bf16 v[32:35], v[120:123], v[80:83], v[32:35]
    ds_read_b128 v[68:71], v10 offset:0
    ds_read_b128 v[72:75], v10 offset:2048
    v_mfma_f32_16x16x32_bf16 v[40:43], v[120:123], v[84:87], v[40:43]
    ds_read_b128 v[76:79], v10 offset:4096
    ds_read_b64_tr_b16 v[112:113], v13 offset:4096
    v_mfma_f32_16x16x32_bf16 v[48:51], v[120:123], v[88:91], v[48:51]
    ds_read_b64_tr_b16 v[114:115], v13 offset:5120
    ds_read_b64_tr_b16 v[116:117], v14 offset:4096
    v_mfma_f32_16x16x32_bf16 v[36:39], v[124:127], v[80:83], v[36:39]
    ds_read_b64_tr_b16 v[118:119], v14 offset:5120
    v_mfma_f32_16x16x32_bf16 v[44:47], v[124:127], v[84:87], v[44:47]
    v_mfma_f32_16x16x32_bf16 v[52:55], v[124:127], v[88:91], v[52:55]
    s_waitcnt lgkmcnt(14)
    v_mfma_f32_16x16x32_bf16 v[32:35], v[128:131], v[92:95], v[32:35]
    v_add_u32 v9, 0x23000, v7
    v_add_u32 v10, 0x23000, v8
    v_add_u32 v13, 0x23000, v11
    v_mfma_f32_16x16x32_bf16 v[40:43], v[128:131], v[96:99], v[40:43]
    v_add_u32 v14, 0x23000, v12
    ds_read_b128 v[80:83], v9 offset:0
    ds_read_b128 v[84:87], v9 offset:2048
    v_mfma_f32_16x16x32_bf16 v[48:51], v[128:131], v[100:103], v[48:51]
    ds_read_b128 v[88:91], v9 offset:4096
    ds_read_b64_tr_b16 v[120:121], v13 offset:0
    ds_read_b64_tr_b16 v[122:123], v13 offset:1024
    v_mfma_f32_16x16x32_bf16 v[36:39], v[132:135], v[92:95], v[36:39]
    ds_read_b64_tr_b16 v[124:125], v14 offset:0
    ds_read_b64_tr_b16 v[126:127], v14 offset:1024
    v_mfma_f32_16x16x32_bf16 v[44:47], v[132:135], v[96:99], v[44:47]
    v_mfma_f32_16x16x32_bf16 v[52:55], v[132:135], v[100:103], v[52:55]
    s_waitcnt lgkmcnt(14)
    v_mfma_f32_16x16x32_bf16 v[32:35], v[104:107], v[56:59], v[32:35]
    ds_read_b128 v[92:95], v10 offset:0
    ds_read_b128 v[96:99], v10 offset:2048
    v_mfma_f32_16x16x32_bf16 v[40:43], v[104:107], v[60:63], v[40:43]
    ds_read_b128 v[100:103], v10 offset:4096
    ds_read_b64_tr_b16 v[128:129], v13 offset:4096
    v_mfma_f32_16x16x32_bf16 v[48:51], v[104:107], v[64:67], v[48:51]
    ds_read_b64_tr_b16 v[130:131], v13 offset:5120
    ds_read_b64_tr_b16 v[132:133], v14 offset:4096
    v_mfma_f32_16x16x32_bf16 v[36:39], v[108:111], v[56:59], v[36:39]
    ds_read_b64_tr_b16 v[134:135], v14 offset:5120
    v_mfma_f32_16x16x32_bf16 v[44:47], v[108:111], v[60:63], v[44:47]
    v_mfma_f32_16x16x32_bf16 v[52:55], v[108:111], v[64:67], v[52:55]
    s_waitcnt lgkmcnt(14)
    v_mfma_f32_16x16x32_bf16 v[32:35], v[112:115], v[68:71], v[32:35]
    s_waitcnt lgkmcnt(0)
    s_barrier
    v_mfma_f32_16x16x32_bf16 v[40:43], v[112:115], v[72:75], v[40:43]
    v_add_u32 v9, 0x0, v7
    v_add_u32 v10, 0x0, v8
    v_add_u32 v13, 0x0, v11
    v_add_u32 v14, 0x0, v12
    v_mfma_f32_16x16x32_bf16 v[48:51], v[112:115], v[76:79], v[48:51]
    ds_read_b128 v[56:59], v9 offset:0
    ds_read_b128 v[60:63], v9 offset:2048
    ds_read_b128 v[64:67], v9 offset:4096
    ds_read_b64_tr_b16 v[104:105], v13 offset:0
    v_mfma_f32_16x16x32_bf16 v[36:39], v[116:119], v[68:71], v[36:39]
    ds_read_b64_tr_b16 v[106:107], v13 offset:1024
    ds_read_b64_tr_b16 v[108:109], v14 offset:0
    ds_read_b64_tr_b16 v[110:111], v14 offset:1024
    v_mfma_f32_16x16x32_bf16 v[44:47], v[116:119], v[72:75], v[44:47]
    v_mfma_f32_16x16x32_bf16 v[52:55], v[116:119], v[76:79], v[52:55]
    s_waitcnt lgkmcnt(14)
    v_mfma_f32_16x16x32_bf16 v[32:35], v[120:123], v[80:83], v[32:35]
    ds_read_b128 v[68:71], v10 offset:0
    ds_read_b128 v[72:75], v10 offset:2048
    v_mfma_f32_16x16x32_bf16 v[40:43], v[120:123], v[84:87], v[40:43]
    ds_read_b128 v[76:79], v10 offset:4096
    ds_read_b64_tr_b16 v[112:113], v13 offset:4096
    v_mfma_f32_16x16x32_bf16 v[48:51], v[120:123], v[88:91], v[48:51]
    ds_read_b64_tr_b16 v[114:115], v13 offset:5120
    ds_read_b64_tr_b16 v[116:117], v14 offset:4096
    v_mfma_f32_16x16x32_bf16 v[36:39], v[124:127], v[80:83], v[36:39]
    ds_read_b64_tr_b16 v[118:119], v14 offset:5120
    v_mfma_f32_16x16x32_bf16 v[44:47], v[124:127], v[84:87], v[44:47]
    v_mfma_f32_16x16x32_bf16 v[52:55], v[124:127], v[88:91], v[52:55]
    s_waitcnt lgkmcnt(14)
    v_mfma_f32_16x16x32_bf16 v[32:35], v[128:131], v[92:95], v[32:35]
    v_add_u32 v9, 0x5000, v7
    v_add_u32 v10, 0x5000, v8
    v_add_u32 v13, 0x5000, v11
    v_mfma_f32_16x16x32_bf16 v[40:43], v[128:131], v[96:99], v[40:43]
    v_add_u32 v14, 0x5000, v12
    ds_read_b128 v[80:83], v9 offset:0
    ds_read_b128 v[84:87], v9 offset:2048
    v_mfma_f32_16x16x32_bf16 v[48:51], v[128:131], v[100:103], v[48:51]
    ds_read_b128 v[88:91], v9 offset:4096
    ds_read_b64_tr_b16 v[120:121], v13 offset:0
    ds_read_b64_tr_b16 v[122:123], v13 offset:1024
    v_mfma_f32_16x16x32_bf16 v[36:39], v[132:135], v[92:95], v[36:39]
    ds_read_b64_tr_b16 v[124:125], v14 offset:0
    ds_read_b64_tr_b16 v[126:127], v14 offset:1024
    v_mfma_f32_16x16x32_bf16 v[44:47], v[132:135], v[96:99], v[44:47]
    v_mfma_f32_16x16x32_bf16 v[52:55], v[132:135], v[100:103], v[52:55]
    s_waitcnt lgkmcnt(14)
    v_mfma_f32_16x16x32_bf16 v[32:35], v[104:107], v[56:59], v[32:35]
    ds_read_b128 v[92:95], v10 offset:0
    ds_read_b128 v[96:99], v10 offset:2048
    v_mfma_f32_16x16x32_bf16 v[40:43], v[104:107], v[60:63], v[40:43]
    ds_read_b128 v[100:103], v10 offset:4096
    ds_read_b64_tr_b16 v[128:129], v13 offset:4096
    v_mfma_f32_16x16x32_bf16 v[48:51], v[104:107], v[64:67], v[48:51]
    ds_read_b64_tr_b16 v[130:131], v13 offset:5120
    ds_read_b64_tr_b16 v[132:133], v14 offset:4096
    v_mfma_f32_16x16x32_bf16 v[36:39], v[108:111], v[56:59], v[36:39]
    ds_read_b64_tr_b16 v[134:135], v14 offset:5120
    v_mfma_f32_16x16x32_bf16 v[44:47], v[108:111], v[60:63], v[44:47]
    v_mfma_f32_16x16x32_bf16 v[52:55], v[108:111], v[64:67], v[52:55]
    s_waitcnt lgkmcnt(14)
    v_mfma_f32_16x16x32_bf16 v[32:35], v[112:115], v[68:71], v[32:35]
    s_waitcnt lgkmcnt(0)
    s_barrier
    v_mfma_f32_16x16x32_bf16 v[40:43], v[112:115], v[72:75], v[40:43]
    v_add_u32 v9, 0xa000, v7
    v_add_u32 v10, 0xa000, v8
    v_add_u32 v13, 0xa000, v11
    v_add_u32 v14, 0xa000, v12
    v_mfma_f32_16x16x32_bf16 v[48:51], v[112:115], v[76:79], v[48:51]
    ds_read_b128 v[56:59], v9 offset:0
    ds_read_b128 v[60:63], v9 offset:2048
    ds_read_b128 v[64:67], v9 offset:4096
    ds_read_b64_tr_b16 v[104:105], v13 offset:0
    v_mfma_f32_16x16x32_bf16 v[36:39], v[116:119], v[68:71], v[36:39]
    ds_read_b64_tr_b16 v[106:107], v13 offset:1024
    ds_read_b64_tr_b16 v[108:109], v14 offset:0
    ds_read_b64_tr_b16 v[110:111], v14 offset:1024
    v_mfma_f32_16x16x32_bf16 v[44:47], v[116:119], v[72:75], v[44:47]
    v_mfma_f32_16x16x32_bf16 v[52:55], v[116:119], v[76:79], v[52:55]
    s_waitcnt lgkmcnt(14)
    v_mfma_f32_16x16x32_bf16 v[32:35], v[120:123], v[80:83], v[32:35]
    ds_read_b128 v[68:71], v10 offset:0
    ds_read_b128 v[72:75], v10 offset:2048
    v_mfma_f32_16x16x32_bf16 v[40:43], v[120:123], v[84:87], v[40:43]
    ds_read_b128 v[76:79], v10 offset:4096
    ds_read_b64_tr_b16 v[112:113], v13 offset:4096
    v_mfma_f32_16x16x32_bf16 v[48:51], v[120:123], v[88:91], v[48:51]
    ds_read_b64_tr_b16 v[114:115], v13 offset:5120
    ds_read_b64_tr_b16 v[116:117], v14 offset:4096
    v_mfma_f32_16x16x32_bf16 v[36:39], v[124:127], v[80:83], v[36:39]
    ds_read_b64_tr_b16 v[118:119], v14 offset:5120
    v_mfma_f32_16x16x32_bf16 v[44:47], v[124:127], v[84:87], v[44:47]
    v_mfma_f32_16x16x32_bf16 v[52:55], v[124:127], v[88:91], v[52:55]
    s_waitcnt lgkmcnt(14)
    v_mfma_f32_16x16x32_bf16 v[32:35], v[128:131], v[92:95], v[32:35]
    v_add_u32 v9, 0xf000, v7
    v_add_u32 v10, 0xf000, v8
    v_add_u32 v13, 0xf000, v11
    v_mfma_f32_16x16x32_bf16 v[40:43], v[128:131], v[96:99], v[40:43]
    v_add_u32 v14, 0xf000, v12
    ds_read_b128 v[80:83], v9 offset:0
    ds_read_b128 v[84:87], v9 offset:2048
    v_mfma_f32_16x16x32_bf16 v[48:51], v[128:131], v[100:103], v[48:51]
    ds_read_b128 v[88:91], v9 offset:4096
    ds_read_b64_tr_b16 v[120:121], v13 offset:0
    ds_read_b64_tr_b16 v[122:123], v13 offset:1024
    v_mfma_f32_16x16x32_bf16 v[36:39], v[132:135], v[92:95], v[36:39]
    ds_read_b64_tr_b16 v[124:125], v14 offset:0
    ds_read_b64_tr_b16 v[126:127], v14 offset:1024
    v_mfma_f32_16x16x32_bf16 v[44:47], v[132:135], v[96:99], v[44:47]
    v_mfma_f32_16x16x32_bf16 v[52:55], v[132:135], v[100:103], v[52:55]
    s_waitcnt lgkmcnt(14)
    v_mfma_f32_16x16x32_bf16 v[32:35], v[104:107], v[56:59], v[32:35]
    ds_read_b128 v[92:95], v10 offset:0
    ds_read_b128 v[96:99], v10 offset:2048
    v_mfma_f32_16x16x32_bf16 v[40:43], v[104:107], v[60:63], v[40:43]
    ds_read_b128 v[100:103], v10 offset:4096
    ds_read_b64_tr_b16 v[128:129], v13 offset:4096
    v_mfma_f32_16x16x32_bf16 v[48:51], v[104:107], v[64:67], v[48:51]
    ds_read_b64_tr_b16 v[130:131], v13 offset:5120
    ds_read_b64_tr_b16 v[132:133], v14 offset:4096
    v_mfma_f32_16x16x32_bf16 v[36:39], v[108:111], v[56:59], v[36:39]
    ds_read_b64_tr_b16 v[134:135], v14 offset:5120
    v_mfma_f32_16x16x32_bf16 v[44:47], v[108:111], v[60:63], v[44:47]
    v_mfma_f32_16x16x32_bf16 v[52:55], v[108:111], v[64:67], v[52:55]
    s_waitcnt lgkmcnt(14)
    v_mfma_f32_16x16x32_bf16 v[32:35], v[112:115], v[68:71], v[32:35]
    s_waitcnt lgkmcnt(0)
    s_barrier
    v_mfma_f32_16x16x32_bf16 v[40:43], v[112:115], v[72:75], v[40:43]
    v_add_u32 v9, 0x14000, v7
    v_add_u32 v10, 0x14000, v8
    v_add_u32 v13, 0x14000, v11
    v_add_u32 v14, 0x14000, v12
    v_mfma_f32_16x16x32_bf16 v[48:51], v[112:115], v[76:79], v[48:51]
    ds_read_b128 v[56:59], v9 offset:0
    ds_read_b128 v[60:63], v9 offset:2048
    ds_read_b128 v[64:67], v9 offset:4096
    ds_read_b64_tr_b16 v[104:105], v13 offset:0
    v_mfma_f32_16x16x32_bf16 v[36:39], v[116:119], v[68:71], v[36:39]
    ds_read_b64_tr_b16 v[106:107], v13 offset:1024
    ds_read_b64_tr_b16 v[108:109], v14 offset:0
    ds_read_b64_tr_b16 v[110:111], v14 offset:1024
    v_mfma_f32_16x16x32_bf16 v[44:47], v[116:119], v[72:75], v[44:47]
    v_mfma_f32_16x16x32_bf16 v[52:55], v[116:119], v[76:79], v[52:55]
    s_waitcnt lgkmcnt(14)
    v_mfma_f32_16x16x32_bf16 v[32:35], v[120:123], v[80:83], v[32:35]
    ds_read_b128 v[68:71], v10 offset:0
    ds_read_b128 v[72:75], v10 offset:2048
    v_mfma_f32_16x16x32_bf16 v[40:43], v[120:123], v[84:87], v[40:43]
    ds_read_b128 v[76:79], v10 offset:4096
    ds_read_b64_tr_b16 v[112:113], v13 offset:4096
    v_mfma_f32_16x16x32_bf16 v[48:51], v[120:123], v[88:91], v[48:51]
    ds_read_b64_tr_b16 v[114:115], v13 offset:5120
    ds_read_b64_tr_b16 v[116:117], v14 offset:4096
    v_mfma_f32_16x16x32_bf16 v[36:39], v[124:127], v[80:83], v[36:39]
    ds_read_b64_tr_b16 v[118:119], v14 offset:5120
    v_mfma_f32_16x16x32_bf16 v[44:47], v[124:127], v[84:87], v[44:47]
    v_mfma_f32_16x16x32_bf16 v[52:55], v[124:127], v[88:91], v[52:55]
    s_waitcnt lgkmcnt(14)
    v_mfma_f32_16x16x32_bf16 v[32:35], v[128:131], v[92:95], v[32:35]
    v_add_u32 v9, 0x19000, v7
    v_add_u32 v10, 0x19000, v8
    v_add_u32 v13, 0x19000, v11
    v_mfma_f32_16x16x32_bf16 v[40:43], v[128:131], v[96:99], v[40:43]
    v_add_u32 v14, 0x19000, v12
    ds_read_b128 v[80:83], v9 offset:0
    ds_read_b128 v[84:87], v9 offset:2048
    v_mfma_f32_16x16x32_bf16 v[48:51], v[128:131], v[100:103], v[48:51]
    ds_read_b128 v[88:91], v9 offset:4096
    ds_read_b64_tr_b16 v[120:121], v13 offset:0
    ds_read_b64_tr_b16 v[122:123], v13 offset:1024
    v_mfma_f32_16x16x32_bf16 v[36:39], v[132:135], v[92:95], v[36:39]
    ds_read_b64_tr_b16 v[124:125], v14 offset:0
    ds_read_b64_tr_b16 v[126:127], v14 offset:1024
    v_mfma_f32_16x16x32_bf16 v[44:47], v[132:135], v[96:99], v[44:47]
    v_mfma_f32_16x16x32_bf16 v[52:55], v[132:135], v[100:103], v[52:55]
    s_waitcnt lgkmcnt(14)
    v_mfma_f32_16x16x32_bf16 v[32:35], v[104:107], v[56:59], v[32:35]
    ds_read_b128 v[92:95], v10 offset:0
    ds_read_b128 v[96:99], v10 offset:2048
    v_mfma_f32_16x16x32_bf16 v[40:43], v[104:107], v[60:63], v[40:43]
    ds_read_b128 v[100:103], v10 offset:4096
    ds_read_b64_tr_b16 v[128:129], v13 offset:4096
    v_mfma_f32_16x16x32_bf16 v[48:51], v[104:107], v[64:67], v[48:51]
    ds_read_b64_tr_b16 v[130:131], v13 offset:5120
    ds_read_b64_tr_b16 v[132:133], v14 offset:4096
    v_mfma_f32_16x16x32_bf16 v[36:39], v[108:111], v[56:59], v[36:39]
    ds_read_b64_tr_b16 v[134:135], v14 offset:5120
    v_mfma_f32_16x16x32_bf16 v[44:47], v[108:111], v[60:63], v[44:47]
    v_mfma_f32_16x16x32_bf16 v[52:55], v[108:111], v[64:67], v[52:55]
    s_waitcnt lgkmcnt(14)
    v_mfma_f32_16x16x32_bf16 v[32:35], v[112:115], v[68:71], v[32:35]
    s_waitcnt lgkmcnt(0)
    s_barrier
    v_mfma_f32_16x16x32_bf16 v[40:43], v[112:115], v[72:75], v[40:43]
    v_add_u32 v9, 0x1e000, v7
    v_add_u32 v10, 0x1e000, v8
    v_add_u32 v13, 0x1e000, v11
    v_add_u32 v14, 0x1e000, v12
    v_mfma_f32_16x16x32_bf16 v[48:51], v[112:115], v[76:79], v[48:51]
    ds_read_b128 v[56:59], v9 offset:0
    ds_read_b128 v[60:63], v9 offset:2048
    ds_read_b128 v[64:67], v9 offset:4096
    ds_read_b64_tr_b16 v[104:105], v13 offset:0
    v_mfma_f32_16x16x32_bf16 v[36:39], v[116:119], v[68:71], v[36:39]
    ds_read_b64_tr_b16 v[106:107], v13 offset:1024
    ds_read_b64_tr_b16 v[108:109], v14 offset:0
    ds_read_b64_tr_b16 v[110:111], v14 offset:1024
    v_mfma_f32_16x16x32_bf16 v[44:47], v[116:119], v[72:75], v[44:47]
    v_mfma_f32_16x16x32_bf16 v[52:55], v[116:119], v[76:79], v[52:55]
    s_waitcnt lgkmcnt(14)
    v_mfma_f32_16x16x32_bf16 v[32:35], v[120:123], v[80:83], v[32:35]
    ds_read_b128 v[68:71], v10 offset:0
    ds_read_b128 v[72:75], v10 offset:2048
    v_mfma_f32_16x16x32_bf16 v[40:43], v[120:123], v[84:87], v[40:43]
    ds_read_b128 v[76:79], v10 offset:4096
    ds_read_b64_tr_b16 v[112:113], v13 offset:4096
    v_mfma_f32_16x16x32_bf16 v[48:51], v[120:123], v[88:91], v[48:51]
    ds_read_b64_tr_b16 v[114:115], v13 offset:5120
    ds_read_b64_tr_b16 v[116:117], v14 offset:4096
    v_mfma_f32_16x16x32_bf16 v[36:39], v[124:127], v[80:83], v[36:39]
    ds_read_b64_tr_b16 v[118:119], v14 offset:5120
    v_mfma_f32_16x16x32_bf16 v[44:47], v[124:127], v[84:87], v[44:47]
    v_mfma_f32_16x16x32_bf16 v[52:55], v[124:127], v[88:91], v[52:55]
    s_waitcnt lgkmcnt(14)
    v_mfma_f32_16x16x32_bf16 v[32:35], v[128:131], v[92:95], v[32:35]
    v_add_u32 v9, 0x23000, v7
    v_add_u32 v10, 0x23000, v8
    v_add_u32 v13, 0x23000, v11
    v_mfma_f32_16x16x32_bf16 v[40:43], v[128:131], v[96:99], v[40:43]
    v_add_u32 v14, 0x23000, v12
    ds_read_b128 v[80:83], v9 offset:0
    ds_read_b128 v[84:87], v9 offset:2048
    v_mfma_f32_16x16x32_bf16 v[48:51], v[128:131], v[100:103], v[48:51]
    ds_read_b128 v[88:91], v9 offset:4096
    ds_read_b64_tr_b16 v[120:121], v13 offset:0
    ds_read_b64_tr_b16 v[122:123], v13 offset:1024
    v_mfma_f32_16x16x32_bf16 v[36:39], v[132:135], v[92:95], v[36:39]
    ds_read_b64_tr_b16 v[124:125], v14 offset:0
    ds_read_b64_tr_b16 v[126:127], v14 offset:1024
    v_mfma_f32_16x16x32_bf16 v[44:47], v[132:135], v[96:99], v[44:47]
    v_mfma_f32_16x16x32_bf16 v[52:55], v[132:135], v[100:103], v[52:55]
    s_waitcnt lgkmcnt(14)
    v_mfma_f32_16x16x32_bf16 v[32:35], v[104:107], v[56:59], v[32:35]
    ds_read_b128 v[92:95], v10 offset:0
    ds_read_b128 v[96:99], v10 offset:2048
    v_mfma_f32_16x16x32_bf16 v[40:43], v[104:107], v[60:63], v[40:43]
    ds_read_b128 v[100:103], v10 offset:4096
    ds_read_b64_tr_b16 v[128:129], v13 offset:4096
    v_mfma_f32_16x16x32_bf16 v[48:51], v[104:107], v[64:67], v[48:51]
    ds_read_b64_tr_b16 v[130:131], v13 offset:5120
    ds_read_b64_tr_b16 v[132:133], v14 offset:4096
    v_mfma_f32_16x16x32_bf16 v[36:39], v[108:111], v[56:59], v[36:39]
    ds_read_b64_tr_b16 v[134:135], v14 offset:5120
    v_mfma_f32_16x16x32_bf16 v[44:47], v[108:111], v[60:63], v[44:47]
    v_mfma_f32_16x16x32_bf16 v[52:55], v[108:111], v[64:67], v[52:55]
    s_waitcnt lgkmcnt(14)
    v_mfma_f32_16x16x32_bf16 v[32:35], v[112:115], v[68:71], v[32:35]
    s_waitcnt lgkmcnt(0)
    s_barrier
    v_mfma_f32_16x16x32_bf16 v[40:43], v[112:115], v[72:75], v[40:43]
    v_add_u32 v9, 0x0, v7
    v_add_u32 v10, 0x0, v8
    v_add_u32 v13, 0x0, v11
    v_add_u32 v14, 0x0, v12
    v_mfma_f32_16x16x32_bf16 v[48:51], v[112:115], v[76:79], v[48:51]
    ds_read_b128 v[56:59], v9 offset:0
    ds_read_b128 v[60:63], v9 offset:2048
    ds_read_b128 v[64:67], v9 offset:4096
    ds_read_b64_tr_b16 v[104:105], v13 offset:0
    v_mfma_f32_16x16x32_bf16 v[36:39], v[116:119], v[68:71], v[36:39]
    ds_read_b64_tr_b16 v[106:107], v13 offset:1024
    ds_read_b64_tr_b16 v[108:109], v14 offset:0
    ds_read_b64_tr_b16 v[110:111], v14 offset:1024
    v_mfma_f32_16x16x32_bf16 v[44:47], v[116:119], v[72:75], v[44:47]
    v_mfma_f32_16x16x32_bf16 v[52:55], v[116:119], v[76:79], v[52:55]
    s_waitcnt lgkmcnt(14)
    v_mfma_f32_16x16x32_bf16 v[32:35], v[120:123], v[80:83], v[32:35]
    ds_read_b128 v[68:71], v10 offset:0
    ds_read_b128 v[72:75], v10 offset:2048
    v_mfma_f32_16x16x32_bf16 v[40:43], v[120:123], v[84:87], v[40:43]
    ds_read_b128 v[76:79], v10 offset:4096
    ds_read_b64_tr_b16 v[112:113], v13 offset:4096
    v_mfma_f32_16x16x32_bf16 v[48:51], v[120:123], v[88:91], v[48:51]
    ds_read_b64_tr_b16 v[114:115], v13 offset:5120
    ds_read_b64_tr_b16 v[116:117], v14 offset:4096
    v_mfma_f32_16x16x32_bf16 v[36:39], v[124:127], v[80:83], v[36:39]
    ds_read_b64_tr_b16 v[118:119], v14 offset:5120
    v_mfma_f32_16x16x32_bf16 v[44:47], v[124:127], v[84:87], v[44:47]
    v_mfma_f32_16x16x32_bf16 v[52:55], v[124:127], v[88:91], v[52:55]
    s_waitcnt lgkmcnt(14)
    v_mfma_f32_16x16x32_bf16 v[32:35], v[128:131], v[92:95], v[32:35]
    v_add_u32 v9, 0x5000, v7
    v_add_u32 v10, 0x5000, v8
    v_add_u32 v13, 0x5000, v11
    v_mfma_f32_16x16x32_bf16 v[40:43], v[128:131], v[96:99], v[40:43]
    v_add_u32 v14, 0x5000, v12
    ds_read_b128 v[80:83], v9 offset:0
    ds_read_b128 v[84:87], v9 offset:2048
    v_mfma_f32_16x16x32_bf16 v[48:51], v[128:131], v[100:103], v[48:51]
    ds_read_b128 v[88:91], v9 offset:4096
    ds_read_b64_tr_b16 v[120:121], v13 offset:0
    ds_read_b64_tr_b16 v[122:123], v13 offset:1024
    v_mfma_f32_16x16x32_bf16 v[36:39], v[132:135], v[92:95], v[36:39]
    ds_read_b64_tr_b16 v[124:125], v14 offset:0
    ds_read_b64_tr_b16 v[126:127], v14 offset:1024
    v_mfma_f32_16x16x32_bf16 v[44:47], v[132:135], v[96:99], v[44:47]
    v_mfma_f32_16x16x32_bf16 v[52:55], v[132:135], v[100:103], v[52:55]
    s_waitcnt lgkmcnt(14)
    v_mfma_f32_16x16x32_bf16 v[32:35], v[104:107], v[56:59], v[32:35]
    ds_read_b128 v[92:95], v10 offset:0
    ds_read_b128 v[96:99], v10 offset:2048
    v_mfma_f32_16x16x32_bf16 v[40:43], v[104:107], v[60:63], v[40:43]
    ds_read_b128 v[100:103], v10 offset:4096
    ds_read_b64_tr_b16 v[128:129], v13 offset:4096
    v_mfma_f32_16x16x32_bf16 v[48:51], v[104:107], v[64:67], v[48:51]
    ds_read_b64_tr_b16 v[130:131], v13 offset:5120
    ds_read_b64_tr_b16 v[132:133], v14 offset:4096
    v_mfma_f32_16x16x32_bf16 v[36:39], v[108:111], v[56:59], v[36:39]
    ds_read_b64_tr_b16 v[134:135], v14 offset:5120
    v_mfma_f32_16x16x32_bf16 v[44:47], v[108:111], v[60:63], v[44:47]
    v_mfma_f32_16x16x32_bf16 v[52:55], v[108:111], v[64:67], v[52:55]
    s_waitcnt lgkmcnt(14)
    v_mfma_f32_16x16x32_bf16 v[32:35], v[112:115], v[68:71], v[32:35]
    s_waitcnt lgkmcnt(0)
    s_barrier
    v_mfma_f32_16x16x32_bf16 v[40:43], v[112:115], v[72:75], v[40:43]
    v_add_u32 v9, 0xa000, v7
    v_add_u32 v10, 0xa000, v8
    v_add_u32 v13, 0xa000, v11
    v_add_u32 v14, 0xa000, v12
    v_mfma_f32_16x16x32_bf16 v[48:51], v[112:115], v[76:79], v[48:51]
    ds_read_b128 v[56:59], v9 offset:0
    ds_read_b128 v[60:63], v9 offset:2048
    ds_read_b128 v[64:67], v9 offset:4096
    ds_read_b64_tr_b16 v[104:105], v13 offset:0
    v_mfma_f32_16x16x32_bf16 v[36:39], v[116:119], v[68:71], v[36:39]
    ds_read_b64_tr_b16 v[106:107], v13 offset:1024
    ds_read_b64_tr_b16 v[108:109], v14 offset:0
    ds_read_b64_tr_b16 v[110:111], v14 offset:1024
    v_mfma_f32_16x16x32_bf16 v[44:47], v[116:119], v[72:75], v[44:47]
    v_mfma_f32_16x16x32_bf16 v[52:55], v[116:119], v[76:79], v[52:55]
    s_waitcnt lgkmcnt(14)
    v_mfma_f32_16x16x32_bf16 v[32:35], v[120:123], v[80:83], v[32:35]
    ds_read_b128 v[68:71], v10 offset:0
    ds_read_b128 v[72:75], v10 offset:2048
    v_mfma_f32_16x16x32_bf16 v[40:43], v[120:123], v[84:87], v[40:43]
    ds_read_b128 v[76:79], v10 offset:4096
    ds_read_b64_tr_b16 v[112:113], v13 offset:4096
    v_mfma_f32_16x16x32_bf16 v[48:51], v[120:123], v[88:91], v[48:51]
    ds_read_b64_tr_b16 v[114:115], v13 offset:5120
    ds_read_b64_tr_b16 v[116:117], v14 offset:4096
    v_mfma_f32_16x16x32_bf16 v[36:39], v[124:127], v[80:83], v[36:39]
    ds_read_b64_tr_b16 v[118:119], v14 offset:5120
    v_mfma_f32_16x16x32_bf16 v[44:47], v[124:127], v[84:87], v[44:47]
    v_mfma_f32_16x16x32_bf16 v[52:55], v[124:127], v[88:91], v[52:55]
    s_waitcnt lgkmcnt(14)
    v_mfma_f32_16x16x32_bf16 v[32:35], v[128:131], v[92:95], v[32:35]
    v_mfma_f32_16x16x32_bf16 v[40:43], v[128:131], v[96:99], v[40:43]
    v_mfma_f32_16x16x32_bf16 v[48:51], v[128:131], v[100:103], v[48:51]
    v_mfma_f32_16x16x32_bf16 v[36:39], v[132:135], v[92:95], v[36:39]
    v_mfma_f32_16x16x32_bf16 v[44:47], v[132:135], v[96:99], v[44:47]
    v_mfma_f32_16x16x32_bf16 v[52:55], v[132:135], v[100:103], v[52:55]
    s_waitcnt lgkmcnt(7)
    v_mfma_f32_16x16x32_bf16 v[32:35], v[104:107], v[56:59], v[32:35]
    v_mfma_f32_16x16x32_bf16 v[40:43], v[104:107], v[60:63], v[40:43]
    v_mfma_f32_16x16x32_bf16 v[48:51], v[104:107], v[64:67], v[48:51]
    v_mfma_f32_16x16x32_bf16 v[36:39], v[108:111], v[56:59], v[36:39]
    v_mfma_f32_16x16x32_bf16 v[44:47], v[108:111], v[60:63], v[44:47]
    v_mfma_f32_16x16x32_bf16 v[52:55], v[108:111], v[64:67], v[52:55]
    s_waitcnt lgkmcnt(0)
    v_mfma_f32_16x16x32_bf16 v[32:35], v[112:115], v[68:71], v[32:35]
    v_mfma_f32_16x16x32_bf16 v[40:43], v[112:115], v[72:75], v[40:43]
    v_mfma_f32_16x16x32_bf16 v[48:51], v[112:115], v[76:79], v[48:51]
    v_mfma_f32_16x16x32_bf16 v[36:39], v[116:119], v[68:71], v[36:39]
    v_mfma_f32_16x16x32_bf16 v[44:47], v[116:119], v[72:75], v[44:47]
    v_mfma_f32_16x16x32_bf16 v[52:55], v[116:119], v[76:79], v[52:55]
    s_mul_i32 s31, s38, 6912
    s_mul_i32 s32, s39, 64
    s_add_u32 s31, s31, s32
    s_add_u32 s31, s31, 0x14000
    v_mul_u32_u24 v136, 144, v2
    v_lshl_add_u32 v136, v1, 3, v136
    v_add_u32 v136, s31, v136
    v_cvt_pk_bf16_f32 v32, v32, v33
    v_cvt_pk_bf16_f32 v33, v34, v35
    ds_write_b64 v136, v[32:33] offset:0
    v_cvt_pk_bf16_f32 v40, v40, v41
    v_cvt_pk_bf16_f32 v41, v42, v43
    ds_write_b64 v136, v[40:41] offset:2304
    v_cvt_pk_bf16_f32 v48, v48, v49
    v_cvt_pk_bf16_f32 v49, v50, v51
    ds_write_b64 v136, v[48:49] offset:4608
    v_cvt_pk_bf16_f32 v36, v36, v37
    v_cvt_pk_bf16_f32 v37, v38, v39
    ds_write_b64 v136, v[36:37] offset:32
    v_cvt_pk_bf16_f32 v44, v44, v45
    v_cvt_pk_bf16_f32 v45, v46, v47
    ds_write_b64 v136, v[44:45] offset:2336
    v_cvt_pk_bf16_f32 v52, v52, v53
    v_cvt_pk_bf16_f32 v53, v54, v55
    ds_write_b64 v136, v[52:53] offset:4640
    s_mul_i32 s31, s30, 3456
    s_add_u32 s31, s31, 0x14000
    v_lshrrev_b32 v137, 3, v0
    v_mul_u32_u24 v137, 144, v137
    v_and_b32 v3, 7, v0
    v_lshl_add_u32 v137, v3, 4, v137
    v_add_u32 v137, s31, v137
    s_mov_b32 s31, 0xffff0000
    s_waitcnt lgkmcnt(0)
    s_barrier
    ds_read_b128 v[56:59], v137 offset:0
    ds_read_b128 v[60:63], v137 offset:1152
    ds_read_b128 v[68:71], v137 offset:2304
    s_waitcnt vmcnt(0)
    s_waitcnt lgkmcnt(2)
    v_lshlrev_b32 v3, 16, v56
    v_and_b32 v4, s31, v56
    v_lshlrev_b32 v5, 16, v20
    v_and_b32 v6, s31, v20
    v_add_f32 v3, v3, v5
    v_add_f32 v4, v4, v6
    v_cvt_pk_bf16_f32 v56, v3, v4
    v_lshlrev_b32 v3, 16, v57
    v_and_b32 v4, s31, v57
    v_lshlrev_b32 v5, 16, v21
    v_and_b32 v6, s31, v21
    v_add_f32 v3, v3, v5
    v_add_f32 v4, v4, v6
    v_cvt_pk_bf16_f32 v57, v3, v4
    v_lshlrev_b32 v3, 16, v58
    v_and_b32 v4, s31, v58
    v_lshlrev_b32 v5, 16, v22
    v_and_b32 v6, s31, v22
    v_add_f32 v3, v3, v5
    v_add_f32 v4, v4, v6
    v_cvt_pk_bf16_f32 v58, v3, v4
    v_lshlrev_b32 v3, 16, v59
    v_and_b32 v4, s31, v59
    v_lshlrev_b32 v5, 16, v23
    v_and_b32 v6, s31, v23
    v_add_f32 v3, v3, v5
    v_add_f32 v4, v4, v6
    v_cvt_pk_bf16_f32 v59, v3, v4
    buffer_store_dwordx4 v[56:59], v15, s[12:15], 0 offen sc1
    s_waitcnt lgkmcnt(1)
    v_lshlrev_b32 v3, 16, v60
    v_and_b32 v4, s31, v60
    v_lshlrev_b32 v5, 16, v24
    v_and_b32 v6, s31, v24
    v_add_f32 v3, v3, v5
    v_add_f32 v4, v4, v6
    v_cvt_pk_bf16_f32 v60, v3, v4
    v_lshlrev_b32 v3, 16, v61
    v_and_b32 v4, s31, v61
    v_lshlrev_b32 v5, 16, v25
    v_and_b32 v6, s31, v25
    v_add_f32 v3, v3, v5
    v_add_f32 v4, v4, v6
    v_cvt_pk_bf16_f32 v61, v3, v4
    v_lshlrev_b32 v3, 16, v62
    v_and_b32 v4, s31, v62
    v_lshlrev_b32 v5, 16, v26
    v_and_b32 v6, s31, v26
    v_add_f32 v3, v3, v5
    v_add_f32 v4, v4, v6
    v_cvt_pk_bf16_f32 v62, v3, v4
    v_lshlrev_b32 v3, 16, v63
    v_and_b32 v4, s31, v63
    v_lshlrev_b32 v5, 16, v27
    v_and_b32 v6, s31, v27
    v_add_f32 v3, v3, v5
    v_add_f32 v4, v4, v6
    v_cvt_pk_bf16_f32 v63, v3, v4
    buffer_store_dwordx4 v[60:63], v16, s[12:15], 0 offen sc1
    s_waitcnt lgkmcnt(0)
    v_lshlrev_b32 v3, 16, v68
    v_and_b32 v4, s31, v68
    v_lshlrev_b32 v5, 16, v28
    v_and_b32 v6, s31, v28
    v_add_f32 v3, v3, v5
    v_add_f32 v4, v4, v6
    v_cvt_pk_bf16_f32 v68, v3, v4
    v_lshlrev_b32 v3, 16, v69
    v_and_b32 v4, s31, v69
    v_lshlrev_b32 v5, 16, v29
    v_and_b32 v6, s31, v29
    v_add_f32 v3, v3, v5
    v_add_f32 v4, v4, v6
    v_cvt_pk_bf16_f32 v69, v3, v4
    v_lshlrev_b32 v3, 16, v70
    v_and_b32 v4, s31, v70
    v_lshlrev_b32 v5, 16, v30
    v_and_b32 v6, s31, v30
    v_add_f32 v3, v3, v5
    v_add_f32 v4, v4, v6
    v_cvt_pk_bf16_f32 v70, v3, v4
    v_lshlrev_b32 v3, 16, v71
    v_and_b32 v4, s31, v71
    v_lshlrev_b32 v5, 16, v31
    v_and_b32 v6, s31, v31
    v_add_f32 v3, v3, v5
    v_add_f32 v4, v4, v6
    v_cvt_pk_bf16_f32 v71, v3, v4
    buffer_store_dwordx4 v[68:71], v17, s[12:15], 0 offen sc1
    s_waitcnt vmcnt(0)
    s_barrier
    s_branch w2_kernel_end
w2_kernel_loader:
    s_setprio 1
    s_sub_u32 s30, s30, 4
    v_lshrrev_b32 v5, 3, v0
    v_and_b32 v6, 7, v0
    s_mul_i32 s31, s30, 24
    s_add_u32 s32, s31, 0
    v_add_u32 v1, s32, v5
    v_bfe_u32 v2, v1, 1, 3
    v_xor_b32 v2, v2, v6
    v_add_u32 v1, s40, v1
    v_mul_u32_u24 v1, 3456, v1
    v_lshl_add_u32 v7, v2, 4, v1
    s_add_u32 s32, s31, 8
    v_add_u32 v1, s32, v5
    v_bfe_u32 v2, v1, 1, 3
    v_xor_b32 v2, v2, v6
    v_add_u32 v1, s40, v1
    v_mul_u32_u24 v1, 3456, v1
    v_lshl_add_u32 v8, v2, 4, v1
    s_add_u32 s32, s31, 16
    v_add_u32 v1, s32, v5
    v_bfe_u32 v2, v1, 1, 3
    v_xor_b32 v2, v2, v6
    v_add_u32 v1, s40, v1
    v_mul_u32_u24 v1, 3456, v1
    v_lshl_add_u32 v9, v2, 4, v1
    s_lshl_b32 s31, s30, 4
    s_lshl_b32 s32, s41, 1
    v_add_u32 v1, 0, v0
    v_lshrrev_b32 v2, 3, v1
    v_and_b32 v1, 7, v1
    v_and_b32 v3, 6, v2
    v_xor_b32 v1, v1, v3
    v_and_b32 v3, 3, v2
    v_bfe_u32 v4, v2, 3, 1
    v_lshl_add_u32 v3, v4, 2, v3
    v_bfe_u32 v4, v2, 2, 1
    v_lshl_add_u32 v3, v4, 3, v3
    v_add_u32 v3, s31, v3
    v_mul_u32_u24 v3, 1280, v3
    v_lshl_add_u32 v3, v1, 4, v3
    v_add_u32 v16, s32, v3
    v_add_u32 v1, 64, v0
    v_lshrrev_b32 v2, 3, v1
    v_and_b32 v1, 7, v1
    v_and_b32 v3, 6, v2
    v_xor_b32 v1, v1, v3
    v_and_b32 v3, 3, v2
    v_bfe_u32 v4, v2, 3, 1
    v_lshl_add_u32 v3, v4, 2, v3
    v_bfe_u32 v4, v2, 2, 1
    v_lshl_add_u32 v3, v4, 3, v3
    v_add_u32 v3, s31, v3
    v_mul_u32_u24 v3, 1280, v3
    v_lshl_add_u32 v3, v1, 4, v3
    v_add_u32 v17, s32, v3
    s_mul_i32 s35, s30, 3072
    s_mul_i32 s36, s30, 2048
    s_mul_i32 s54, s54, 0
    s_mul_i32 s55, s55, 0
    s_add_u32 s37, s54, s55
    s_lshl_b32 s33, s37, 7
    s_mul_i32 s34, s37, 81920
    s_waitcnt lgkmcnt(0)
    s_add_u32 s4, s78, 0x1000000
    s_addc_u32 s5, s79, 0
    s_and_b32 s5, s5, 0xffff
    s_mov_b32 s6, 0x6c0000
    s_mov_b32 s7, 0x20000
    s_mov_b32 s8, s72
    s_and_b32 s9, s73, 0xffff
    s_mov_b32 s10, 0x21c000
    s_mov_b32 s11, 0x20000
    s_add_u32 m0, s36, 0x3000
    s_nop 0
    buffer_load_dwordx4 v16, s[8:11], s34 offen lds
    s_add_u32 m0, s36, 0x3400
    s_nop 0
    buffer_load_dwordx4 v17, s[8:11], s34 offen lds
    s_add_u32 s34, s34, 81920
    s_cmp_eq_u32 s34, 2211840
    s_cselect_b32 s34, 0, s34
    s_add_u32 m0, s36, 0x8000
    s_nop 0
    buffer_load_dwordx4 v16, s[8:11], s34 offen lds
    s_add_u32 m0, s36, 0x8400
    s_nop 0
    buffer_load_dwordx4 v17, s[8:11], s34 offen lds
    s_add_u32 s34, s34, 81920
    s_cmp_eq_u32 s34, 2211840
    s_cselect_b32 s34, 0, s34
    s_add_u32 m0, s36, 0xd000
    s_nop 0
    buffer_load_dwordx4 v16, s[8:11], s34 offen lds
    s_add_u32 m0, s36, 0xd400
    s_nop 0
    buffer_load_dwordx4 v17, s[8:11], s34 offen lds
    s_add_u32 s34, s34, 81920
    s_cmp_eq_u32 s34, 2211840
    s_cselect_b32 s34, 0, s34
    s_add_u32 m0, s36, 0x12000
    s_nop 0
    buffer_load_dwordx4 v16, s[8:11], s34 offen lds
    s_add_u32 m0, s36, 0x12400
    s_nop 0
    buffer_load_dwordx4 v17, s[8:11], s34 offen lds
    s_add_u32 s34, s34, 81920
    s_cmp_eq_u32 s34, 2211840
    s_cselect_b32 s34, 0, s34
    s_add_u32 m0, s36, 0x17000
    s_nop 0
    buffer_load_dwordx4 v16, s[8:11], s34 offen lds
    s_add_u32 m0, s36, 0x17400
    s_nop 0
    buffer_load_dwordx4 v17, s[8:11], s34 offen lds
    s_add_u32 s34, s34, 81920
    s_cmp_eq_u32 s34, 2211840
    s_cselect_b32 s34, 0, s34
    s_add_u32 m0, s36, 0x1c000
    s_nop 0
    buffer_load_dwordx4 v16, s[8:11], s34 offen lds
    s_add_u32 m0, s36, 0x1c400
    s_nop 0
    buffer_load_dwordx4 v17, s[8:11], s34 offen lds
    s_add_u32 s34, s34, 81920
    s_cmp_eq_u32 s34, 2211840
    s_cselect_b32 s34, 0, s34
    s_barrier
    s_add_u32 m0, s35, 0x0
    s_nop 0
    buffer_load_dwordx4 v7, s[4:7], s33 offen sc1 lds
    s_add_u32 m0, s35, 0x400
    s_nop 0
    buffer_load_dwordx4 v8, s[4:7], s33 offen sc1 lds
    s_add_u32 m0, s35, 0x800
    s_nop 0
    buffer_load_dwordx4 v9, s[4:7], s33 offen sc1 lds
    s_add_u32 s33, s33, 128
    s_cmp_eq_u32 s33, 3456
    s_cselect_b32 s33, 0, s33
    s_add_u32 m0, s35, 0x5000
    s_nop 0
    buffer_load_dwordx4 v7, s[4:7], s33 offen sc1 lds
    s_add_u32 m0, s35, 0x5400
    s_nop 0
    buffer_load_dwordx4 v8, s[4:7], s33 offen sc1 lds
    s_add_u32 m0, s35, 0x5800
    s_nop 0
    buffer_load_dwordx4 v9, s[4:7], s33 offen sc1 lds
    s_add_u32 s33, s33, 128
    s_cmp_eq_u32 s33, 3456
    s_cselect_b32 s33, 0, s33
    s_add_u32 m0, s35, 0xa000
    s_nop 0
    buffer_load_dwordx4 v7, s[4:7], s33 offen sc1 lds
    s_add_u32 m0, s35, 0xa400
    s_nop 0
    buffer_load_dwordx4 v8, s[4:7], s33 offen sc1 lds
    s_add_u32 m0, s35, 0xa800
    s_nop 0
    buffer_load_dwordx4 v9, s[4:7], s33 offen sc1 lds
    s_add_u32 s33, s33, 128
    s_cmp_eq_u32 s33, 3456
    s_cselect_b32 s33, 0, s33
    s_add_u32 m0, s35, 0xf000
    s_nop 0
    buffer_load_dwordx4 v7, s[4:7], s33 offen sc1 lds
    s_add_u32 m0, s35, 0xf400
    s_nop 0
    buffer_load_dwordx4 v8, s[4:7], s33 offen sc1 lds
    s_add_u32 m0, s35, 0xf800
    s_nop 0
    buffer_load_dwordx4 v9, s[4:7], s33 offen sc1 lds
    s_add_u32 s33, s33, 128
    s_cmp_eq_u32 s33, 3456
    s_cselect_b32 s33, 0, s33
    s_add_u32 m0, s35, 0x14000
    s_nop 0
    buffer_load_dwordx4 v7, s[4:7], s33 offen sc1 lds
    s_add_u32 m0, s35, 0x14400
    s_nop 0
    buffer_load_dwordx4 v8, s[4:7], s33 offen sc1 lds
    s_add_u32 m0, s35, 0x14800
    s_nop 0
    buffer_load_dwordx4 v9, s[4:7], s33 offen sc1 lds
    s_add_u32 s33, s33, 128
    s_cmp_eq_u32 s33, 3456
    s_cselect_b32 s33, 0, s33
    s_add_u32 m0, s35, 0x19000
    s_nop 0
    buffer_load_dwordx4 v7, s[4:7], s33 offen sc1 lds
    s_add_u32 m0, s35, 0x19400
    s_nop 0
    buffer_load_dwordx4 v8, s[4:7], s33 offen sc1 lds
    s_add_u32 m0, s35, 0x19800
    s_nop 0
    buffer_load_dwordx4 v9, s[4:7], s33 offen sc1 lds
    s_add_u32 s33, s33, 128
    s_cmp_eq_u32 s33, 3456
    s_cselect_b32 s33, 0, s33
    s_waitcnt vmcnt(12)
    s_barrier
    s_add_u32 m0, s36, 0x21000
    s_nop 0
    buffer_load_dwordx4 v16, s[8:11], s34 offen lds
    s_add_u32 m0, s36, 0x21400
    s_nop 0
    buffer_load_dwordx4 v17, s[8:11], s34 offen lds
    s_add_u32 s34, s34, 81920
    s_cmp_eq_u32 s34, 2211840
    s_cselect_b32 s34, 0, s34
    s_add_u32 m0, s35, 0x1e000
    s_nop 0
    buffer_load_dwordx4 v7, s[4:7], s33 offen sc1 lds
    s_add_u32 m0, s35, 0x1e400
    s_nop 0
    buffer_load_dwordx4 v8, s[4:7], s33 offen sc1 lds
    s_add_u32 m0, s35, 0x1e800
    s_nop 0
    buffer_load_dwordx4 v9, s[4:7], s33 offen sc1 lds
    s_add_u32 s33, s33, 128
    s_cmp_eq_u32 s33, 3456
    s_cselect_b32 s33, 0, s33
    s_add_u32 m0, s36, 0x26000
    s_nop 0
    buffer_load_dwordx4 v16, s[8:11], s34 offen lds
    s_add_u32 m0, s36, 0x26400
    s_nop 0
    buffer_load_dwordx4 v17, s[8:11], s34 offen lds
    s_add_u32 s34, s34, 81920
    s_cmp_eq_u32 s34, 2211840
    s_cselect_b32 s34, 0, s34
    s_add_u32 m0, s35, 0x23000
    s_nop 0
    buffer_load_dwordx4 v7, s[4:7], s33 offen sc1 lds
    s_add_u32 m0, s35, 0x23400
    s_nop 0
    buffer_load_dwordx4 v8, s[4:7], s33 offen sc1 lds
    s_add_u32 m0, s35, 0x23800
    s_nop 0
    buffer_load_dwordx4 v9, s[4:7], s33 offen sc1 lds
    s_add_u32 s33, s33, 128
    s_cmp_eq_u32 s33, 3456
    s_cselect_b32 s33, 0, s33
    s_waitcnt vmcnt(16)
    s_barrier
    s_add_u32 m0, s36, 0x3000
    s_nop 0
    buffer_load_dwordx4 v16, s[8:11], s34 offen lds
    s_add_u32 m0, s36, 0x3400
    s_nop 0
    buffer_load_dwordx4 v17, s[8:11], s34 offen lds
    s_add_u32 s34, s34, 81920
    s_cmp_eq_u32 s34, 2211840
    s_cselect_b32 s34, 0, s34
    s_add_u32 m0, s35, 0x0
    s_nop 0
    buffer_load_dwordx4 v7, s[4:7], s33 offen sc1 lds
    s_add_u32 m0, s35, 0x400
    s_nop 0
    buffer_load_dwordx4 v8, s[4:7], s33 offen sc1 lds
    s_add_u32 m0, s35, 0x800
    s_nop 0
    buffer_load_dwordx4 v9, s[4:7], s33 offen sc1 lds
    s_add_u32 s33, s33, 128
    s_cmp_eq_u32 s33, 3456
    s_cselect_b32 s33, 0, s33
    s_add_u32 m0, s36, 0x8000
    s_nop 0
    buffer_load_dwordx4 v16, s[8:11], s34 offen lds
    s_add_u32 m0, s36, 0x8400
    s_nop 0
    buffer_load_dwordx4 v17, s[8:11], s34 offen lds
    s_add_u32 s34, s34, 81920
    s_cmp_eq_u32 s34, 2211840
    s_cselect_b32 s34, 0, s34
    s_add_u32 m0, s35, 0x5000
    s_nop 0
    buffer_load_dwordx4 v7, s[4:7], s33 offen sc1 lds
    s_add_u32 m0, s35, 0x5400
    s_nop 0
    buffer_load_dwordx4 v8, s[4:7], s33 offen sc1 lds
    s_add_u32 m0, s35, 0x5800
    s_nop 0
    buffer_load_dwordx4 v9, s[4:7], s33 offen sc1 lds
    s_add_u32 s33, s33, 128
    s_cmp_eq_u32 s33, 3456
    s_cselect_b32 s33, 0, s33
    s_waitcnt vmcnt(20)
    s_barrier
    s_add_u32 m0, s36, 0xd000
    s_nop 0
    buffer_load_dwordx4 v16, s[8:11], s34 offen lds
    s_add_u32 m0, s36, 0xd400
    s_nop 0
    buffer_load_dwordx4 v17, s[8:11], s34 offen lds
    s_add_u32 s34, s34, 81920
    s_cmp_eq_u32 s34, 2211840
    s_cselect_b32 s34, 0, s34
    s_add_u32 m0, s35, 0xa000
    s_nop 0
    buffer_load_dwordx4 v7, s[4:7], s33 offen sc1 lds
    s_add_u32 m0, s35, 0xa400
    s_nop 0
    buffer_load_dwordx4 v8, s[4:7], s33 offen sc1 lds
    s_add_u32 m0, s35, 0xa800
    s_nop 0
    buffer_load_dwordx4 v9, s[4:7], s33 offen sc1 lds
    s_add_u32 s33, s33, 128
    s_cmp_eq_u32 s33, 3456
    s_cselect_b32 s33, 0, s33
    s_add_u32 m0, s36, 0x12000
    s_nop 0
    buffer_load_dwordx4 v16, s[8:11], s34 offen lds
    s_add_u32 m0, s36, 0x12400
    s_nop 0
    buffer_load_dwordx4 v17, s[8:11], s34 offen lds
    s_add_u32 s34, s34, 81920
    s_cmp_eq_u32 s34, 2211840
    s_cselect_b32 s34, 0, s34
    s_add_u32 m0, s35, 0xf000
    s_nop 0
    buffer_load_dwordx4 v7, s[4:7], s33 offen sc1 lds
    s_add_u32 m0, s35, 0xf400
    s_nop 0
    buffer_load_dwordx4 v8, s[4:7], s33 offen sc1 lds
    s_add_u32 m0, s35, 0xf800
    s_nop 0
    buffer_load_dwordx4 v9, s[4:7], s33 offen sc1 lds
    s_add_u32 s33, s33, 128
    s_cmp_eq_u32 s33, 3456
    s_cselect_b32 s33, 0, s33
    s_waitcnt vmcnt(20)
    s_barrier
    s_add_u32 m0, s36, 0x17000
    s_nop 0
    buffer_load_dwordx4 v16, s[8:11], s34 offen lds
    s_add_u32 m0, s36, 0x17400
    s_nop 0
    buffer_load_dwordx4 v17, s[8:11], s34 offen lds
    s_add_u32 s34, s34, 81920
    s_cmp_eq_u32 s34, 2211840
    s_cselect_b32 s34, 0, s34
    s_add_u32 m0, s35, 0x14000
    s_nop 0
    buffer_load_dwordx4 v7, s[4:7], s33 offen sc1 lds
    s_add_u32 m0, s35, 0x14400
    s_nop 0
    buffer_load_dwordx4 v8, s[4:7], s33 offen sc1 lds
    s_add_u32 m0, s35, 0x14800
    s_nop 0
    buffer_load_dwordx4 v9, s[4:7], s33 offen sc1 lds
    s_add_u32 s33, s33, 128
    s_cmp_eq_u32 s33, 3456
    s_cselect_b32 s33, 0, s33
    s_add_u32 m0, s36, 0x1c000
    s_nop 0
    buffer_load_dwordx4 v16, s[8:11], s34 offen lds
    s_add_u32 m0, s36, 0x1c400
    s_nop 0
    buffer_load_dwordx4 v17, s[8:11], s34 offen lds
    s_add_u32 s34, s34, 81920
    s_cmp_eq_u32 s34, 2211840
    s_cselect_b32 s34, 0, s34
    s_add_u32 m0, s35, 0x19000
    s_nop 0
    buffer_load_dwordx4 v7, s[4:7], s33 offen sc1 lds
    s_add_u32 m0, s35, 0x19400
    s_nop 0
    buffer_load_dwordx4 v8, s[4:7], s33 offen sc1 lds
    s_add_u32 m0, s35, 0x19800
    s_nop 0
    buffer_load_dwordx4 v9, s[4:7], s33 offen sc1 lds
    s_add_u32 s33, s33, 128
    s_cmp_eq_u32 s33, 3456
    s_cselect_b32 s33, 0, s33
    s_waitcnt vmcnt(20)
    s_barrier
    s_add_u32 m0, s36, 0x21000
    s_nop 0
    buffer_load_dwordx4 v16, s[8:11], s34 offen lds
    s_add_u32 m0, s36, 0x21400
    s_nop 0
    buffer_load_dwordx4 v17, s[8:11], s34 offen lds
    s_add_u32 s34, s34, 81920
    s_cmp_eq_u32 s34, 2211840
    s_cselect_b32 s34, 0, s34
    s_add_u32 m0, s35, 0x1e000
    s_nop 0
    buffer_load_dwordx4 v7, s[4:7], s33 offen sc1 lds
    s_add_u32 m0, s35, 0x1e400
    s_nop 0
    buffer_load_dwordx4 v8, s[4:7], s33 offen sc1 lds
    s_add_u32 m0, s35, 0x1e800
    s_nop 0
    buffer_load_dwordx4 v9, s[4:7], s33 offen sc1 lds
    s_add_u32 s33, s33, 128
    s_cmp_eq_u32 s33, 3456
    s_cselect_b32 s33, 0, s33
    s_add_u32 m0, s36, 0x26000
    s_nop 0
    buffer_load_dwordx4 v16, s[8:11], s34 offen lds
    s_add_u32 m0, s36, 0x26400
    s_nop 0
    buffer_load_dwordx4 v17, s[8:11], s34 offen lds
    s_add_u32 s34, s34, 81920
    s_cmp_eq_u32 s34, 2211840
    s_cselect_b32 s34, 0, s34
    s_add_u32 m0, s35, 0x23000
    s_nop 0
    buffer_load_dwordx4 v7, s[4:7], s33 offen sc1 lds
    s_add_u32 m0, s35, 0x23400
    s_nop 0
    buffer_load_dwordx4 v8, s[4:7], s33 offen sc1 lds
    s_add_u32 m0, s35, 0x23800
    s_nop 0
    buffer_load_dwordx4 v9, s[4:7], s33 offen sc1 lds
    s_add_u32 s33, s33, 128
    s_cmp_eq_u32 s33, 3456
    s_cselect_b32 s33, 0, s33
    s_waitcnt vmcnt(20)
    s_barrier
    s_add_u32 m0, s36, 0x3000
    s_nop 0
    buffer_load_dwordx4 v16, s[8:11], s34 offen lds
    s_add_u32 m0, s36, 0x3400
    s_nop 0
    buffer_load_dwordx4 v17, s[8:11], s34 offen lds
    s_add_u32 s34, s34, 81920
    s_cmp_eq_u32 s34, 2211840
    s_cselect_b32 s34, 0, s34
    s_add_u32 m0, s35, 0x0
    s_nop 0
    buffer_load_dwordx4 v7, s[4:7], s33 offen sc1 lds
    s_add_u32 m0, s35, 0x400
    s_nop 0
    buffer_load_dwordx4 v8, s[4:7], s33 offen sc1 lds
    s_add_u32 m0, s35, 0x800
    s_nop 0
    buffer_load_dwordx4 v9, s[4:7], s33 offen sc1 lds
    s_add_u32 s33, s33, 128
    s_cmp_eq_u32 s33, 3456
    s_cselect_b32 s33, 0, s33
    s_add_u32 m0, s36, 0x8000
    s_nop 0
    buffer_load_dwordx4 v16, s[8:11], s34 offen lds
    s_add_u32 m0, s36, 0x8400
    s_nop 0
    buffer_load_dwordx4 v17, s[8:11], s34 offen lds
    s_add_u32 s34, s34, 81920
    s_cmp_eq_u32 s34, 2211840
    s_cselect_b32 s34, 0, s34
    s_add_u32 m0, s35, 0x5000
    s_nop 0
    buffer_load_dwordx4 v7, s[4:7], s33 offen sc1 lds
    s_add_u32 m0, s35, 0x5400
    s_nop 0
    buffer_load_dwordx4 v8, s[4:7], s33 offen sc1 lds
    s_add_u32 m0, s35, 0x5800
    s_nop 0
    buffer_load_dwordx4 v9, s[4:7], s33 offen sc1 lds
    s_add_u32 s33, s33, 128
    s_cmp_eq_u32 s33, 3456
    s_cselect_b32 s33, 0, s33
    s_waitcnt vmcnt(20)
    s_barrier
    s_add_u32 m0, s36, 0xd000
    s_nop 0
    buffer_load_dwordx4 v16, s[8:11], s34 offen lds
    s_add_u32 m0, s36, 0xd400
    s_nop 0
    buffer_load_dwordx4 v17, s[8:11], s34 offen lds
    s_add_u32 s34, s34, 81920
    s_cmp_eq_u32 s34, 2211840
    s_cselect_b32 s34, 0, s34
    s_add_u32 m0, s35, 0xa000
    s_nop 0
    buffer_load_dwordx4 v7, s[4:7], s33 offen sc1 lds
    s_add_u32 m0, s35, 0xa400
    s_nop 0
    buffer_load_dwordx4 v8, s[4:7], s33 offen sc1 lds
    s_add_u32 m0, s35, 0xa800
    s_nop 0
    buffer_load_dwordx4 v9, s[4:7], s33 offen sc1 lds
    s_add_u32 s33, s33, 128
    s_cmp_eq_u32 s33, 3456
    s_cselect_b32 s33, 0, s33
    s_add_u32 m0, s36, 0x12000
    s_nop 0
    buffer_load_dwordx4 v16, s[8:11], s34 offen lds
    s_add_u32 m0, s36, 0x12400
    s_nop 0
    buffer_load_dwordx4 v17, s[8:11], s34 offen lds
    s_add_u32 s34, s34, 81920
    s_cmp_eq_u32 s34, 2211840
    s_cselect_b32 s34, 0, s34
    s_add_u32 m0, s35, 0xf000
    s_nop 0
    buffer_load_dwordx4 v7, s[4:7], s33 offen sc1 lds
    s_add_u32 m0, s35, 0xf400
    s_nop 0
    buffer_load_dwordx4 v8, s[4:7], s33 offen sc1 lds
    s_add_u32 m0, s35, 0xf800
    s_nop 0
    buffer_load_dwordx4 v9, s[4:7], s33 offen sc1 lds
    s_add_u32 s33, s33, 128
    s_cmp_eq_u32 s33, 3456
    s_cselect_b32 s33, 0, s33
    s_waitcnt vmcnt(20)
    s_barrier
    s_add_u32 m0, s36, 0x17000
    s_nop 0
    buffer_load_dwordx4 v16, s[8:11], s34 offen lds
    s_add_u32 m0, s36, 0x17400
    s_nop 0
    buffer_load_dwordx4 v17, s[8:11], s34 offen lds
    s_add_u32 s34, s34, 81920
    s_cmp_eq_u32 s34, 2211840
    s_cselect_b32 s34, 0, s34
    s_add_u32 m0, s35, 0x14000
    s_nop 0
    buffer_load_dwordx4 v7, s[4:7], s33 offen sc1 lds
    s_add_u32 m0, s35, 0x14400
    s_nop 0
    buffer_load_dwordx4 v8, s[4:7], s33 offen sc1 lds
    s_add_u32 m0, s35, 0x14800
    s_nop 0
    buffer_load_dwordx4 v9, s[4:7], s33 offen sc1 lds
    s_add_u32 s33, s33, 128
    s_cmp_eq_u32 s33, 3456
    s_cselect_b32 s33, 0, s33
    s_add_u32 m0, s36, 0x1c000
    s_nop 0
    buffer_load_dwordx4 v16, s[8:11], s34 offen lds
    s_add_u32 m0, s36, 0x1c400
    s_nop 0
    buffer_load_dwordx4 v17, s[8:11], s34 offen lds
    s_add_u32 s34, s34, 81920
    s_cmp_eq_u32 s34, 2211840
    s_cselect_b32 s34, 0, s34
    s_add_u32 m0, s35, 0x19000
    s_nop 0
    buffer_load_dwordx4 v7, s[4:7], s33 offen sc1 lds
    s_add_u32 m0, s35, 0x19400
    s_nop 0
    buffer_load_dwordx4 v8, s[4:7], s33 offen sc1 lds
    s_add_u32 m0, s35, 0x19800
    s_nop 0
    buffer_load_dwordx4 v9, s[4:7], s33 offen sc1 lds
    s_add_u32 s33, s33, 128
    s_cmp_eq_u32 s33, 3456
    s_cselect_b32 s33, 0, s33
    s_waitcnt vmcnt(20)
    s_barrier
    s_add_u32 m0, s36, 0x21000
    s_nop 0
    buffer_load_dwordx4 v16, s[8:11], s34 offen lds
    s_add_u32 m0, s36, 0x21400
    s_nop 0
    buffer_load_dwordx4 v17, s[8:11], s34 offen lds
    s_add_u32 s34, s34, 81920
    s_cmp_eq_u32 s34, 2211840
    s_cselect_b32 s34, 0, s34
    s_add_u32 m0, s35, 0x1e000
    s_nop 0
    buffer_load_dwordx4 v7, s[4:7], s33 offen sc1 lds
    s_add_u32 m0, s35, 0x1e400
    s_nop 0
    buffer_load_dwordx4 v8, s[4:7], s33 offen sc1 lds
    s_add_u32 m0, s35, 0x1e800
    s_nop 0
    buffer_load_dwordx4 v9, s[4:7], s33 offen sc1 lds
    s_add_u32 s33, s33, 128
    s_cmp_eq_u32 s33, 3456
    s_cselect_b32 s33, 0, s33
    s_add_u32 m0, s36, 0x26000
    s_nop 0
    buffer_load_dwordx4 v16, s[8:11], s34 offen lds
    s_add_u32 m0, s36, 0x26400
    s_nop 0
    buffer_load_dwordx4 v17, s[8:11], s34 offen lds
    s_add_u32 s34, s34, 81920
    s_cmp_eq_u32 s34, 2211840
    s_cselect_b32 s34, 0, s34
    s_add_u32 m0, s35, 0x23000
    s_nop 0
    buffer_load_dwordx4 v7, s[4:7], s33 offen sc1 lds
    s_add_u32 m0, s35, 0x23400
    s_nop 0
    buffer_load_dwordx4 v8, s[4:7], s33 offen sc1 lds
    s_add_u32 m0, s35, 0x23800
    s_nop 0
    buffer_load_dwordx4 v9, s[4:7], s33 offen sc1 lds
    s_add_u32 s33, s33, 128
    s_cmp_eq_u32 s33, 3456
    s_cselect_b32 s33, 0, s33
    s_waitcnt vmcnt(20)
    s_barrier
    s_add_u32 m0, s36, 0x3000
    s_nop 0
    buffer_load_dwordx4 v16, s[8:11], s34 offen lds
    s_add_u32 m0, s36, 0x3400
    s_nop 0
    buffer_load_dwordx4 v17, s[8:11], s34 offen lds
    s_add_u32 s34, s34, 81920
    s_cmp_eq_u32 s34, 2211840
    s_cselect_b32 s34, 0, s34
    s_add_u32 m0, s35, 0x0
    s_nop 0
    buffer_load_dwordx4 v7, s[4:7], s33 offen sc1 lds
    s_add_u32 m0, s35, 0x400
    s_nop 0
    buffer_load_dwordx4 v8, s[4:7], s33 offen sc1 lds
    s_add_u32 m0, s35, 0x800
    s_nop 0
    buffer_load_dwordx4 v9, s[4:7], s33 offen sc1 lds
    s_add_u32 s33, s33, 128
    s_cmp_eq_u32 s33, 3456
    s_cselect_b32 s33, 0, s33
    s_add_u32 m0, s36, 0x8000
    s_nop 0
    buffer_load_dwordx4 v16, s[8:11], s34 offen lds
    s_add_u32 m0, s36, 0x8400
    s_nop 0
    buffer_load_dwordx4 v17, s[8:11], s34 offen lds
    s_add_u32 s34, s34, 81920
    s_cmp_eq_u32 s34, 2211840
    s_cselect_b32 s34, 0, s34
    s_add_u32 m0, s35, 0x5000
    s_nop 0
    buffer_load_dwordx4 v7, s[4:7], s33 offen sc1 lds
    s_add_u32 m0, s35, 0x5400
    s_nop 0
    buffer_load_dwordx4 v8, s[4:7], s33 offen sc1 lds
    s_add_u32 m0, s35, 0x5800
    s_nop 0
    buffer_load_dwordx4 v9, s[4:7], s33 offen sc1 lds
    s_add_u32 s33, s33, 128
    s_cmp_eq_u32 s33, 3456
    s_cselect_b32 s33, 0, s33
    s_waitcnt vmcnt(20)
    s_barrier
    s_add_u32 m0, s36, 0xd000
    s_nop 0
    buffer_load_dwordx4 v16, s[8:11], s34 offen lds
    s_add_u32 m0, s36, 0xd400
    s_nop 0
    buffer_load_dwordx4 v17, s[8:11], s34 offen lds
    s_add_u32 s34, s34, 81920
    s_cmp_eq_u32 s34, 2211840
    s_cselect_b32 s34, 0, s34
    s_add_u32 m0, s35, 0xa000
    s_nop 0
    buffer_load_dwordx4 v7, s[4:7], s33 offen sc1 lds
    s_add_u32 m0, s35, 0xa400
    s_nop 0
    buffer_load_dwordx4 v8, s[4:7], s33 offen sc1 lds
    s_add_u32 m0, s35, 0xa800
    s_nop 0
    buffer_load_dwordx4 v9, s[4:7], s33 offen sc1 lds
    s_add_u32 s33, s33, 128
    s_cmp_eq_u32 s33, 3456
    s_cselect_b32 s33, 0, s33
    s_waitcnt vmcnt(15)
    s_barrier
    s_waitcnt vmcnt(5)
    s_barrier
    s_waitcnt vmcnt(0)
    s_barrier
    s_barrier
    s_barrier
w2_kernel_end:
    s_setprio 0
mega_end:
    s_endpgm
.section .rodata,"a"
.p2align 6
.amdhsa_kernel sequential_preLN__sliding_block__dense_activation_relu__prompt_kernel
  .amdhsa_next_free_vgpr 256
  .amdhsa_next_free_sgpr 102
  .amdhsa_accum_offset 256
  .amdhsa_group_segment_fixed_size 0
  .amdhsa_kernarg_size 72
  .amdhsa_user_sgpr_count 2
  .amdhsa_user_sgpr_kernarg_segment_ptr 1
  .amdhsa_system_sgpr_workgroup_id_x 1
.end_amdhsa_kernel
```
